```python
import torch

def _softmax(x, axis=-1):
    return torch.softmax(x, dim=axis)
def _gelu(x):
    return torch.nn.functional.gelu(x, approximate="tanh")
def _silu(x):
    return torch.nn.functional.silu(x)
def _sigmoid(x):
    return torch.sigmoid(x)
def _layernorm(x, axis=-1, eps=1e-5):
    m = x.mean(dim=axis, keepdim=True)
    v = x.var(dim=axis, keepdim=True, unbiased=False)
    return (x - m) / torch.sqrt(v + eps)
def _scatter_add(tgt, idx, src, axis=0):
    return tgt.clone().index_add_(axis, idx, src)
def _segment_sum(src, seg, n):
    out = torch.zeros((n,) + src.shape[1:], dtype=src.dtype)
    return out.index_add_(0, seg, src)
def _pad(x, pw):
    flat = tuple(v for pair in reversed(pw) for v in pair)
    return torch.nn.functional.pad(x, flat)

kernel_name = 'gated_mix__linear_attn_block__mixer_token_mlp__prompt'

def setup_inputs():

    _w = (lambda a: (lambda t: t.to(torch.bfloat16) if t.is_floating_point() else t)(torch.as_tensor(a)))
    def _A_setup():
        B, S, D = 1, 2048, 640
        return {
            "x": _w((lambda *s: torch.randn(*s, dtype=torch.bfloat16) * 0.05)(B, S, D)),
            "wqkv": _w((lambda *s: torch.randn(*s, dtype=torch.bfloat16) * 0.4)(D, 3 * D)),
            "wo": _w((lambda *s: torch.randn(*s, dtype=torch.bfloat16) * 0.05)(D, D)),
        }
    _A_in = _A_setup()

    def _B_setup():
        B, S, D, F = 1, 2048, 640, 1536
        return {
            "x": _w((lambda *s: torch.randn(*s, dtype=torch.bfloat16) * 0.05)(B, S, D)),
            "w1": _w((lambda *s: torch.randn(*s, dtype=torch.bfloat16) * 0.4)(S, F) * (S ** -0.5)),
            "b1": _w((lambda *s: torch.randn(*s, dtype=torch.bfloat16) * 3.2)(F) * 0.02),
            "w2": _w((lambda *s: torch.randn(*s, dtype=torch.bfloat16) * 0.05)(F, S) * (F ** -0.5)),
            "b2": _w((lambda *s: torch.randn(*s, dtype=torch.bfloat16) * 0.1)(S) * 0.02),
        }
    _B_in = _B_setup()

    return {
        "A_x": _A_in["x"],
        "A_wqkv": _A_in["wqkv"],
        "A_wo": _A_in["wo"],
        "B_x": _B_in["x"],
        "B_w1": _B_in["w1"],
        "B_b1": _B_in["b1"],
        "B_w2": _B_in["w2"],
        "B_b2": _B_in["b2"],
        "gate_w": _w((lambda *s: torch.randn(*s, dtype=torch.bfloat16) * 0.05)(640) * 16.0),
    }

def reference(A_x, A_wqkv, A_wo, B_x, B_w1, B_b1, B_w2, B_b2, gate_w):
    def _A_ref(x, wqkv, wo):
        B, S, D = x.shape
        H = 32; Dh = D // H
        qkv = (lambda x, *d: x.permute(*d))((x @ wqkv).reshape(B, S, 3, H, Dh), 2, 0, 3, 1, 4)
        q, k, v = qkv[0], qkv[1], qkv[2]
        phi = lambda t: torch.where(t > 0, t + 1, torch.exp(t)) + 1e-6
        pq, pk = phi(q), phi(k)
        kv = torch.einsum("bhsd,bhse->bhde", pk, v)
        z = torch.einsum("bhsd->bhd", pk)
        num = torch.einsum("bhqd,bhde->bhqe", pq, kv)
        den = torch.einsum("bhqd,bhd->bhq", pq, z)[..., None] + 1e-6
        o = num / den
        return (lambda x, *d: x.permute(*d))(o, 0, 2, 1, 3).reshape(B, S, D) @ wo

    def _B_ref(x, w1, b1, w2, b2):
        B, S, D = x.shape
        h = _layernorm(x, axis=-1)
        u = torch.einsum("bsd,sf->bdf", h, w1) + b1
        u = _gelu(u)
        y = torch.einsum("bdf,fs->bds", u, w2) + b2
        return (lambda x, *d: x.permute(*d))(y, 0, 2, 1)

    x = A_x
    g = _sigmoid((x * gate_w).sum(-1, keepdims=True))
    a = _A_ref(x, A_wqkv, A_wo)
    b = _B_ref(x, B_w1, B_b1, B_w2, B_b2)
    return g * a + (1 - g) * b
```

```asm
; @launch grid=(256,1,1) block=(256,1,1) lds=163840
.amdgcn_target "amdgcn-amd-amdhsa--gfx950"
.text
.globl gated_mix__linear_attn_block__mixer_token_mlp__prompt_kernel
.p2align 8
.type gated_mix__linear_attn_block__mixer_token_mlp__prompt_kernel,@function
gated_mix__linear_attn_block__mixer_token_mlp__prompt_kernel:
    s_cmp_ge_u32 s2, 256
    s_cbranch_scc1 k_end
    s_load_dwordx16 s[4:19], s[0:1], 0
    s_load_dwordx8 s[20:27], s[0:1], 64
    s_getpc_b64 s[86:87]
    v_lshlrev_b32_e64 v2, 7, v0
    s_mov_b64 exec, 0xff
    global_load_dword a255, v2, s[86:87] offset:128
    s_mov_b64 exec, -1
    v_lshrrev_b32 v2, 6, v0
    v_and_b32 v1, 63, v0
    v_readfirstlane_b32 s68, v2
    s_and_b32 s81, s2, 7
    s_lshr_b32 s82, s2, 3
    s_lshr_b32 s83, s81, 1
    s_and_b32 s84, s81, 1
    s_cmp_ge_u32 s82, 16
    s_cbranch_scc1 r_notkv
    s_and_b32 s85, s82, 3
    s_lshl_b32 s86, s83, 2
    s_add_u32 s69, s85, s86
    s_lshr_b32 s85, s82, 2
    s_lshl_b32 s86, s84, 2
    s_add_u32 s70, s85, s86
    s_lshr_b32 s96, s68, 1
    s_and_b32 s97, s68, 1
    v_lshrrev_b32 v2, 3, v1
    s_lshl_b32 s85, s68, 5
    v_add_u32_e64 v2, s85, v2
    v_mul_u32_u24 v2, 1280, v2
    v_lshrrev_b32 v3, 4, v1
    v_and_b32 v4, 7, v1
    v_xor_b32_e64 v4, v4, v3
    v_lshl_add_u32 v16, v4, 4, v2
    v_xor_b32_e64 v4, 4, v4
    v_lshl_add_u32 v6, v4, 4, v2
    v_add_u32 v17, 9216, v6
    v_add_u32 v18, 18432, v16
    v_add_u32 v19, 27648, v6
    s_mul_i32 s76, s69, 163840
    s_mov_b32 s77, 0
    s_and_b32 s85, s82, 3
    s_lshl_b32 s85, s85, 2
    s_lshr_b32 s85, 0x8530, s85
    s_and_b32 s85, s85, 15
    s_and_b32 s86, s82, 12
    s_lshr_b32 s86, 0x8530, s86
    s_and_b32 s86, s86, 15
    s_add_u32 s85, s85, s86
    s_add_u32 s85, s85, s83
    s_add_u32 s85, s85, s84
    s_mul_i32 s86, s85, 26
    s_lshr_b32 s86, s86, 8
    s_mul_i32 s86, s86, 10
    s_sub_u32 s85, s85, s86
    s_mul_i32 s77, s85, 245760
    s_lshl_b32 s85, s85, 7
    s_add_u32 s76, s76, s85
    s_lshl_b32 s80, s68, 12
    s_mul_i32 s98, s68, 5120
    s_add_u32 s98, s98, 16384
    s_mov_b32 s79, 73728
    s_waitcnt lgkmcnt(0)
    s_mov_b64 s[28:29], s[4:5]
    s_mov_b32 s30, 0x280000
    s_mov_b32 s31, 0x20000
    s_mov_b64 s[32:33], s[6:7]
    s_mov_b32 s34, 0x258000
    s_mov_b32 s35, 0x20000
    s_add_u32 m0, s79, s80
    s_nop 0
    s_nop 0
    buffer_load_dwordx4 v16, s[28:31], s76 offen offset:0 lds
    buffer_load_dwordx4 v17, s[28:31], s76 offen offset:1024 lds
    buffer_load_dwordx4 v18, s[28:31], s76 offen offset:2048 lds
    buffer_load_dwordx4 v19, s[28:31], s76 offen offset:3072 lds
    s_mul_i32 s86, s70, 160
    s_add_u32 s86, s86, 1280
    s_mul_i32 s85, s68, 61440
    s_add_u32 s85, s85, s86
    s_movk_i32 s89, -20
    v_mul_u32_u24 v3, 3277, v1
    v_lshrrev_b32_e64 v3, 16, v3
    v_mad_i32_i24 v4, v3, s89, v1
    v_lshrrev_b32 v5, 2, v3
    v_and_b32 v5, 2, v5
    v_xor_b32 v4, v4, v5
    s_mov_b32 s87, s85
    v_mul_u32_u24 v3, 3840, v3
    v_lshl_add_u32 v3, v4, 4, v3
    v_cmp_le_u32_e64 vcc, 10, v4
    v_add_u32 v5, 1120, v3
    v_add_u32 v3, s87, v3
    v_add_u32 v5, s87, v5
    v_cndmask_b32 v20, v3, v5, vcc
    v_add_u32 v2, 64, v1
    v_mul_u32_u24 v3, 3277, v2
    v_lshrrev_b32_e64 v3, 16, v3
    v_mad_i32_i24 v4, v3, s89, v2
    v_lshrrev_b32 v5, 2, v3
    v_and_b32 v5, 2, v5
    v_xor_b32_e64 v4, v4, v5
    s_sub_u32 s87, s85, 1024
    v_mul_u32_u24 v3, 3840, v3
    v_lshl_add_u32 v3, v4, 4, v3
    v_cmp_le_u32_e64 vcc, 10, v4
    v_add_u32 v5, 1120, v3
    v_add_u32 v3, s87, v3
    v_add_u32 v5, s87, v5
    v_cndmask_b32_e64 v21, v3, v5, vcc
    v_add_u32 v2, 128, v1
    v_mul_u32_u24 v3, 3277, v2
    v_lshrrev_b32_e64 v3, 16, v3
    v_mad_i32_i24 v4, v3, s89, v2
    v_lshrrev_b32 v5, 2, v3
    v_and_b32 v5, 2, v5
    v_xor_b32_e64 v4, v4, v5
    s_sub_u32 s87, s85, 2048
    v_mul_u32_u24 v3, 3840, v3
    v_lshl_add_u32 v3, v4, 4, v3
    v_cmp_le_u32_e64 vcc, 10, v4
    v_add_u32 v5, 1120, v3
    v_add_u32 v3, s87, v3
    v_add_u32 v5, s87, v5
    v_cndmask_b32_e64 v22, v3, v5, vcc
    v_add_u32 v2, 192, v1
    v_mul_u32_u24 v3, 3277, v2
    v_lshrrev_b32_e64 v3, 16, v3
    v_mad_i32_i24 v4, v3, s89, v2
    v_lshrrev_b32 v5, 2, v3
    v_and_b32 v5, 2, v5
    v_xor_b32_e64 v4, v4, v5
    s_sub_u32 s87, s85, 3072
    v_mul_u32_u24 v3, 3840, v3
    v_lshl_add_u32 v3, v4, 4, v3
    v_cmp_le_u32_e64 vcc, 10, v4
    v_add_u32 v5, 1120, v3
    v_add_u32 v3, s87, v3
    v_add_u32 v5, s87, v5
    v_cndmask_b32_e64 v23, v3, v5, vcc
    v_add_u32 v2, 256, v1
    v_mul_u32_u24 v3, 3277, v2
    v_lshrrev_b32_e64 v3, 16, v3
    v_mad_i32_i24 v4, v3, s89, v2
    v_lshrrev_b32 v5, 2, v3
    v_and_b32 v5, 2, v5
    v_xor_b32 v4, v4, v5
    s_mov_b32 s87, s85
    v_mul_u32_u24 v3, 3840, v3
    v_lshl_add_u32 v3, v4, 4, v3
    v_cmp_le_u32_e64 vcc, 10, v4
    v_add_u32 v5, 1120, v3
    v_add_u32 v3, s87, v3
    v_add_u32 v5, s87, v5
    v_cndmask_b32_e64 v24, v3, v5, vcc
    s_add_u32 m0, s79, s98
    s_nop 0
    buffer_load_dwordx4 v20, s[32:35], s77 offen offset:0 lds
    buffer_load_dwordx4 v21, s[32:35], s77 offen offset:1024 lds
    buffer_load_dwordx4 v22, s[32:35], s77 offen offset:2048 lds
    buffer_load_dwordx4 v23, s[32:35], s77 offen offset:3072 lds
    s_add_u32 m0, m0, 4096
    s_nop 0
    s_nop 0
    buffer_load_dwordx4 v24, s[32:35], s77 offen lds
    s_add_u32 s76, s76, 128
    s_add_u32 s77, s77, 245760
    s_cmp_eq_u32 s77, 2457600
    s_cselect_b32 s85, 1280, 0
    s_cselect_b32 s77, 0, s77
    s_sub_u32 s76, s76, s85
    s_add_u32 s79, s79, 36864
    s_cmp_eq_u32 s79, 147456
    s_cselect_b32 s79, 0, s79
    s_add_u32 s86, s26, 0x974000
    s_addc_u32 s87, s27, 0
    s_load_dword s3, s[86:87], 0
    s_lshr_b32 s85, s82, 2
    s_lshl_b32 s88, s83, 3
    s_add_u32 s73, s85, s88
    s_and_b32 s85, s82, 3
    s_lshl_b32 s88, s84, 2
    s_add_u32 s74, s85, s88
    s_lshr_b32 s85, s82, 3
    s_lshl_b32 s85, s85, 3
    s_add_u32 s73, s85, s81
    s_and_b32 s74, s82, 7
    s_sub_u32 s85, s82, 8
    s_cmp_lt_u32 s82, 16
    s_cselect_b32 s85, s82, s85
    s_and_b32 s89, s85, 3
    s_add_u32 s71, s89, s88
    s_lshr_b32 s85, s85, 2
    s_lshl_b32 s88, s85, 2
    s_add_u32 s72, s83, s88
    s_lshr_b32 s88, s85, 2
    s_lshl_b32 s85, s85, 1
    s_add_u32 s85, s85, s88
    s_lshl_b32 s85, s85, 1
    s_mul_i32 s89, s89, 4
    s_add_u32 s85, s85, s89
    s_and_b32 s99, s85, 15
    s_mov_b64 s[36:37], s[26:27]
    s_mov_b32 s38, 0x982080
    s_mov_b32 s39, 0x20000
    s_mov_b64 s[40:41], s[12:13]
    s_mov_b32 s42, 0x600000
    s_mov_b32 s43, 0x20000
    s_mov_b64 s[56:57], s[14:15]
    s_mov_b32 s58, 0xc00
    s_mov_b32 s59, 0x20000
    s_mov_b64 s[44:45], s[16:17]
    s_mov_b32 s46, 0x600000
    s_mov_b32 s47, 0x20000
    s_mov_b64 s[60:61], s[18:19]
    s_mov_b32 s62, 0x1000
    s_mov_b32 s63, 0x20000
    s_mov_b64 s[48:49], s[22:23]
    s_mov_b32 s50, 0x280000
    s_mov_b32 s51, 0x20000
    s_mov_b64 s[12:13], s[40:41]
    s_mov_b64 s[14:15], s[42:43]
    s_mul_i32 s7, s68, 1572864
    s_lshl_b32 s85, s72, 7
    s_add_u32 s7, s7, s85
    s_add_u32 s8, s7, 1572864
    s_mul_i32 s85, s99, 98304
    s_add_u32 s4, s7, s85
    s_mul_i32 s9, s68, 655360
    s_mul_i32 s85, s71, 5120
    s_add_u32 s9, s9, s85
    s_add_u32 s10, s9, 655360
    s_mul_i32 s85, s99, 40960
    s_add_u32 s5, s9, s85
    s_mov_b32 s11, 98304
    s_lshl_b32 s6, s68, 14
    s_and_b32 s85, s82, 3
    s_mul_i32 s85, s85, 3
    s_lshr_b32 s86, s82, 2
    s_mul_i32 s86, s86, 3
    s_lshr_b32 s86, s86, 1
    s_add_u32 s85, s85, s86
    s_cmp_ge_u32 s85, 12
    s_cselect_b32 s86, 12, 0
    s_sub_u32 s85, s85, s86
    s_add_u32 s85, s73, s74
    s_and_b32 s85, s85, 1
    s_mul_i32 s85, s85, 6
    s_mul_i32 s18, s68, 1572864
    s_lshl_b32 s86, s73, 7
    s_add_u32 s18, s18, s86
    s_add_u32 s19, s18, 1572864
    s_lshl_b32 s86, s85, 17
    s_add_u32 s17, s18, s86
    s_mul_i32 s21, s68, 491520
    s_mul_i32 s86, s74, 5120
    s_add_u32 s21, s21, s86
    s_add_u32 s21, s21, 0x280000
    s_add_u32 s22, s21, 491520
    s_mul_i32 s86, s85, 40960
    s_add_u32 s20, s21, s86
    v_lshlrev_b32 v37, 4, v1
    v_add_u32 v38, 4096, v37
    v_lshrrev_b32 v2, 2, v1
    v_lshrrev_b32 v3, 1, v2
    v_and_b32 v3, 3, v3
    v_lshlrev_b32 v2, 7, v2
    v_lshl_add_u32 v2, v3, 5, v2
    v_and_b32_e64 v3, 3, v1
    v_lshl_add_u32 v2, v3, 3, v2
    v_add_u32 v39, s6, v2
    v_xor_b32 v40, 32, v39
    v_xor_b32_e64 v41, 64, v39
    v_xor_b32 v42, 96, v39
    v_lshrrev_b32 v2, 3, v1
    v_lshrrev_b32 v3, 4, v1
    v_lshlrev_b32 v3, 1, v3
    v_and_b32 v4, 7, v1
    v_xor_b32 v3, v3, v4
    v_lshlrev_b32 v3, 4, v3
    v_mul_u32_u24 v4, 3072, v2
    v_add_u32_e64 v33, v3, v4
    v_add_u32 v34, 23552, v33
    v_add_u32 v35, 47104, v33
    v_add_u32 v36, 70656, v33
    v_mul_u32_u24 v4, 4096, v2
    v_add_u32_e64 v43, v3, v4
    v_add_u32 v44, 31744, v43
    v_add_u32 v45, 63488, v43
    v_add_u32 v46, 95232, v43
    v_and_b32 v13, 15, v1
    s_mul_i32 s85, s68, 16
    v_add_lshl_u32 v13, v13, s85, 7
    v_lshlrev_b32_e64 v15, 7, v1
    s_mov_b32 s24, 0x974080
    s_mov_b32 s25, 0x97a080
    s_waitcnt lgkmcnt(0)
    s_mul_i32 s16, s3, 0x41C64E6D
    s_add_u32 s16, s16, 0x3C6EF35F
    v_lshrrev_b32 v12, 4, v1
    v_lshlrev_b32 v12, 3, v12
    s_and_b32 s85, s68, 1
    s_lshl_b32 s23, s72, 1
    s_add_u32 s23, s23, s85
    s_lshl_b32 s23, s23, 6
    s_lshl_b32 s85, s70, 1
    s_add_u32 s85, s85, s97
    s_lshl_b32 s86, s85, 4
    s_add_u32 s86, s86, s69
    s_lshl_b32 s87, s86, 8
    s_mul_i32 s26, s86, 3200
    s_sub_u32 s87, s87, s26
    s_add_u32 s87, s87, 0xd8000
    s_lshr_b32 s87, s87, 4
    s_add_u32 s26, s26, 0x7a8000
    v_mov_b32 v2, 0x7ff00000
    s_cmp_eq_u32 s96, 0
    s_mov_b32 s92, 0xfff0fff0
    s_cselect_b32 s92, 0x0, s92
    s_mov_b32 s93, 0xfff0fff0
    s_cselect_b32 s93, 0xffffffff, s93
    s_mov_b32 s88, 112
    s_cselect_b32 s88, 0, s88
    v_mov_b32_e64 v246, s88
    v_mbcnt_lo_u32_b32 v246, s92, v246
    v_mbcnt_hi_u32_b32 v246, s93, v246
    v_lshlrev_b32_e64 v246, 4, v246
    v_cndmask_b32 v246, v2, v246, s[92:93]
    s_cmp_eq_u32 s96, 0
    s_mov_b32 s92, 0x0
    s_cselect_b32 s92, 0xffffffff, s92
    s_mov_b32 s93, 0xff0000
    s_cselect_b32 s93, 0xffff, s93
    s_mov_b32 s88, 160
    s_cselect_b32 s88, 32, s88
    v_mov_b32_e64 v247, s88
    v_mbcnt_lo_u32_b32 v247, s92, v247
    v_mbcnt_hi_u32_b32 v247, s93, v247
    v_lshlrev_b32_e64 v247, 4, v247
    v_cndmask_b32 v247, v2, v247, s[92:93]
    s_cmp_eq_u32 s96, 0
    s_mov_b32 s92, 0xff00ff
    s_cselect_b32 s92, 0x0, s92
    s_mov_b32 s93, 0xff00ff
    s_cselect_b32 s93, 0xf000f, s93
    s_mov_b32 s88, 168
    s_cselect_b32 s88, 80, s88
    v_mov_b32_e64 v248, s88
    v_mbcnt_lo_u32_b32 v248, s92, v248
    v_mbcnt_hi_u32_b32 v248, s93, v248
    v_lshlrev_b32_e64 v248, 4, v248
    v_cndmask_b32 v248, v2, v248, s[92:93]
    s_cmp_eq_u32 s96, 0
    s_mov_b32 s92, 0xffff
    s_cselect_b32 s92, 0xf000f, s92
    s_mov_b32 s93, 0x0
    s_cselect_b32 s93, 0xfff0000f, s93
    s_cselect_b32 s88, 88, s87
    v_mov_b32_e64 v249, s88
    v_mbcnt_lo_u32_b32 v249, s92, v249
    v_mbcnt_hi_u32_b32 v249, s93, v249
    v_lshlrev_b32_e64 v249, 4, v249
    v_cndmask_b32 v249, v2, v249, s[92:93]
    s_mul_i32 s85, s68, 8448
    s_add_u32 s85, s85, 65536
    v_add_u32_e64 v250, s85, v37
    v_lshl_add_u32 v251, v1, 2, s85
    s_mul_i32 s85, s97, 8448
    s_lshl_b32 s86, s96, 12
    s_add_u32 s85, s85, s86
    s_add_u32 s85, s85, 65536
    v_add_u32 v252, s85, v37
    v_and_b32 v2, 15, v1
    v_cmp_gt_u32 s[92:93], 8, v2
    v_cmp_lt_u32 s[64:65], 15, v1
    v_cmp_lt_u32 s[66:67], 31, v1
    s_lshl_b32 s85, s81, 4
    s_add_u32 s85, s85, s82
    s_lshl_b32 s85, s85, 2
    s_add_u32 s85, s85, s68
    s_lshl_b32 s27, s85, 13
    s_lshl_b32 s3, s69, 3
    s_add_u32 s3, s3, s70
    s_lshl_b32 s3, s3, 7
    s_add_u32 s3, s3, 0x976080
    v_and_b32 v2, 15, v1
    v_lshrrev_b32 v3, 4, v1
    v_lshrrev_b32 v4, 1, v2
    v_xor_b32 v4, v4, v3
    v_lshlrev_b32_e64 v4, 4, v4
    v_lshl_add_u32 v4, v2, 7, v4
    s_lshl_b32 s85, s96, 13
    v_add_u32 v208, s85, v4
    v_xor_b32 v209, 64, v208
    v_lshrrev_b32 v4, 2, v2
    v_lshl_add_u32 v4, v3, 3, v4
    v_mul_u32_u24 v4, 320, v4
    v_and_b32_e64 v5, 1, v1
    v_lshl_add_u32 v4, v5, 3, v4
    v_add_u32 v4, 16384, v4
    v_bfe_u32 v5, v1, 1, 1
    v_and_b32 v6, 1, v3
    v_lshlrev_b32 v6, 1, v6
    s_mul_i32 s85, s97, 5
    s_add_u32 s86, s85, 0
    v_add_u32 v7, s86, v5
    v_xor_b32 v7, v7, v6
    v_lshl_add_u32 v210, v7, 4, v4
    s_add_u32 s86, s85, 2
    v_add_u32 v7, s86, v5
    v_xor_b32_e64 v7, v7, v6
    v_lshl_add_u32 v211, v7, 4, v4
    s_add_u32 s86, s85, 4
    v_mad_u32_u24 v7, v5, 6, s86
    v_xor_b32 v7, v7, v6
    v_lshl_add_u32 v212, v7, 4, v4
    s_add_u32 s86, s85, 11
    v_add_u32 v7, s86, v5
    v_xor_b32_e64 v7, v7, v6
    v_lshl_add_u32 v213, v7, 4, v4
    s_add_u32 s86, s85, 13
    v_add_u32 v7, s86, v5
    v_xor_b32_e64 v7, v7, v6
    v_lshl_add_u32 v214, v7, 4, v4
    v_mov_b64 v[48:49], 0
    v_mov_b64 v[50:51], 0
    v_mov_b64 v[52:53], 0
    v_mov_b64 v[54:55], 0
    v_mov_b64 v[56:57], 0
    v_mov_b64 v[58:59], 0
    v_mov_b64 v[60:61], 0
    v_mov_b64 v[62:63], 0
    v_mov_b64 v[64:65], 0
    v_mov_b64 v[66:67], 0
    v_mov_b64 v[68:69], 0
    v_mov_b64 v[70:71], 0
    v_mov_b64 v[72:73], 0
    v_mov_b64 v[74:75], 0
    v_mov_b64 v[76:77], 0
    v_mov_b64 v[78:79], 0
    v_mov_b64 v[80:81], 0
    v_mov_b64 v[82:83], 0
    v_mov_b64 v[84:85], 0
    v_mov_b64 v[86:87], 0
    v_mov_b64 v[88:89], 0
    v_mov_b64 v[90:91], 0
    v_mov_b64 v[92:93], 0
    v_mov_b64 v[94:95], 0
    v_mov_b64 v[96:97], 0
    v_mov_b64 v[98:99], 0
    v_mov_b64 v[100:101], 0
    v_mov_b64 v[102:103], 0
    v_mov_b64 v[104:105], 0
    v_mov_b64 v[106:107], 0
    v_mov_b64 v[108:109], 0
    v_mov_b64 v[110:111], 0
    v_mov_b64 v[112:113], 0
    v_mov_b64 v[114:115], 0
    v_mov_b64 v[116:117], 0
    v_mov_b64 v[118:119], 0
    v_mov_b64 v[120:121], 0
    v_mov_b64 v[122:123], 0
    v_mov_b64 v[124:125], 0
    v_mov_b64 v[126:127], 0
    s_mov_b32 s78, 73728
    s_mov_b32 s75, 0
    v_add_u32 v215, s78, v208
    v_add_u32 v216, s78, v209
    v_add_u32 v217, s78, v210
    v_add_u32 v218, s78, v211
    v_add_u32 v219, s78, v212
    v_add_u32 v220, s78, v213
    v_add_u32 v221, s78, v214
    s_add_u32 m0, s79, s80
    s_nop 0
    buffer_load_dwordx4 v16, s[28:31], s76 offen offset:0 lds
    buffer_load_dwordx4 v17, s[28:31], s76 offen offset:1024 lds
    buffer_load_dwordx4 v18, s[28:31], s76 offen offset:2048 lds
    buffer_load_dwordx4 v19, s[28:31], s76 offen offset:3072 lds
    s_add_u32 m0, s79, s98
    s_nop 0
    buffer_load_dwordx4 v20, s[32:35], s77 offen offset:0 lds
    buffer_load_dwordx4 v21, s[32:35], s77 offen offset:1024 lds
    buffer_load_dwordx4 v22, s[32:35], s77 offen offset:2048 lds
    buffer_load_dwordx4 v23, s[32:35], s77 offen offset:3072 lds
    s_add_u32 m0, m0, 4096
    s_nop 0
    s_nop 0
    buffer_load_dwordx4 v24, s[32:35], s77 offen lds
    s_add_u32 s76, s76, 128
    s_add_u32 s77, s77, 245760
    s_cmp_eq_u32 s77, 2457600
    s_cselect_b32 s85, 1280, 0
    s_cselect_b32 s77, 0, s77
    s_sub_u32 s76, s76, s85
    s_add_u32 s79, s79, 36864
    s_cmp_eq_u32 s79, 147456
    s_cselect_b32 s79, 0, s79
    s_waitcnt vmcnt(9)
    s_barrier
    s_nop 0
    ds_read_b64_tr_b16 a[128:129], v217 offset:0
    ds_read_b64_tr_b16 a[130:131], v217 offset:1280
    ds_read_b128 a[112:115], v215 offset:0
    ds_read_b128 a[116:119], v215 offset:2048
    ds_read_b128 a[120:123], v215 offset:4096
    ds_read_b128 a[124:127], v215 offset:6144
    ds_read_b64_tr_b16 a[132:133], v218 offset:0
    ds_read_b64_tr_b16 a[134:135], v218 offset:1280
    ds_read_b64_tr_b16 a[136:137], v219 offset:0
    ds_read_b64_tr_b16 a[138:139], v219 offset:1280
    ds_read_b64_tr_b16 a[140:141], v220 offset:0
    ds_read_b64_tr_b16 a[142:143], v220 offset:1280
    ds_read_b64_tr_b16 a[144:145], v221 offset:0
    ds_read_b64_tr_b16 a[146:147], v221 offset:1280
    s_add_u32 m0, s79, s80
    s_nop 0
    buffer_load_dwordx4 v16, s[28:31], s76 offen offset:0 lds
    buffer_load_dwordx4 v17, s[28:31], s76 offen offset:1024 lds
    buffer_load_dwordx4 v18, s[28:31], s76 offen offset:2048 lds
    buffer_load_dwordx4 v19, s[28:31], s76 offen offset:3072 lds
    s_add_u32 m0, s79, s98
    s_nop 0
    buffer_load_dwordx4 v20, s[32:35], s77 offen offset:0 lds
    s_branch kv_mid
.p2align 3
kv_loop:
kv_noblk:
    s_waitcnt vmcnt(9) lgkmcnt(0)
    s_barrier
    v_mfma_f32_16x16x32_bf16 v[48:51], a[148:151], a[164:167], v[48:51]
    ds_read_b64_tr_b16 a[128:129], v217 offset:0
    ds_read_b64_tr_b16 a[130:131], v217 offset:1280
    v_mfma_f32_16x16x32_bf16 v[68:71], a[152:155], a[164:167], v[68:71]
    ds_read_b128 a[112:115], v215 offset:0
    ds_read_b128 a[116:119], v215 offset:2048
    v_mfma_f32_16x16x32_bf16 v[88:91], a[156:159], a[164:167], v[88:91]
    ds_read_b128 a[120:123], v215 offset:4096
    ds_read_b128 a[124:127], v215 offset:6144
    s_add_u32 m0, s79, s80
    s_nop 0
    v_mfma_f32_16x16x32_bf16 v[108:111], a[160:163], a[164:167], v[108:111]
    ds_read_b64_tr_b16 a[132:133], v218 offset:0
    ds_read_b64_tr_b16 a[134:135], v218 offset:1280
    buffer_load_dwordx4 v16, s[28:31], s76 offen offset:0 lds
    v_mfma_f32_16x16x32_bf16 v[52:55], a[148:151], a[168:171], v[52:55]
    ds_read_b64_tr_b16 a[136:137], v219 offset:0
    ds_read_b64_tr_b16 a[138:139], v219 offset:1280
    v_mfma_f32_16x16x32_bf16 v[72:75], a[152:155], a[168:171], v[72:75]
    ds_read_b64_tr_b16 a[140:141], v220 offset:0
    v_mfma_f32_16x16x32_bf16 v[92:95], a[156:159], a[168:171], v[92:95]
    ds_read_b64_tr_b16 a[142:143], v220 offset:1280
    v_mfma_f32_16x16x32_bf16 v[112:115], a[160:163], a[168:171], v[112:115]
    ds_read_b64_tr_b16 a[144:145], v221 offset:0
    buffer_load_dwordx4 v17, s[28:31], s76 offen offset:1024 lds
    v_mfma_f32_16x16x32_bf16 v[56:59], a[148:151], a[172:175], v[56:59]
    ds_read_b64_tr_b16 a[146:147], v221 offset:1280
    v_mfma_f32_16x16x32_bf16 v[76:79], a[152:155], a[172:175], v[76:79]
    v_mfma_f32_16x16x32_bf16 v[96:99], a[156:159], a[172:175], v[96:99]
    v_mfma_f32_16x16x32_bf16 v[116:119], a[160:163], a[172:175], v[116:119]
    buffer_load_dwordx4 v18, s[28:31], s76 offen offset:2048 lds
    v_mfma_f32_16x16x32_bf16 v[60:63], a[148:151], a[176:179], v[60:63]
    v_mfma_f32_16x16x32_bf16 v[80:83], a[152:155], a[176:179], v[80:83]
    v_mfma_f32_16x16x32_bf16 v[100:103], a[156:159], a[176:179], v[100:103]
    v_mfma_f32_16x16x32_bf16 v[120:123], a[160:163], a[176:179], v[120:123]
    buffer_load_dwordx4 v19, s[28:31], s76 offen offset:3072 lds
    v_mfma_f32_16x16x32_bf16 v[64:67], a[148:151], a[180:183], v[64:67]
    v_mfma_f32_16x16x32_bf16 v[84:87], a[152:155], a[180:183], v[84:87]
    v_mfma_f32_16x16x32_bf16 v[104:107], a[156:159], a[180:183], v[104:107]
    s_add_u32 m0, s79, s98
    v_mfma_f32_16x16x32_bf16 v[124:127], a[160:163], a[180:183], v[124:127]
    buffer_load_dwordx4 v20, s[32:35], s77 offen offset:0 lds
kv_mid:
    s_waitcnt lgkmcnt(0)
    v_mfma_f32_16x16x32_bf16 v[48:51], a[112:115], a[128:131], v[48:51]
    ds_read_b64_tr_b16 a[164:165], v217 offset:10240
    ds_read_b64_tr_b16 a[166:167], v217 offset:11520
    v_mfma_f32_16x16x32_bf16 v[68:71], a[116:119], a[128:131], v[68:71]
    ds_read_b128 a[148:151], v216 offset:0
    ds_read_b128 a[152:155], v216 offset:2048
    v_mfma_f32_16x16x32_bf16 v[88:91], a[120:123], a[128:131], v[88:91]
    ds_read_b128 a[156:159], v216 offset:4096
    ds_read_b128 a[160:163], v216 offset:6144
    buffer_load_dwordx4 v21, s[32:35], s77 offen offset:1024 lds
    v_mfma_f32_16x16x32_bf16 v[108:111], a[124:127], a[128:131], v[108:111]
    ds_read_b64_tr_b16 a[168:169], v218 offset:10240
    ds_read_b64_tr_b16 a[170:171], v218 offset:11520
    v_mfma_f32_16x16x32_bf16 v[52:55], a[112:115], a[132:135], v[52:55]
    ds_read_b64_tr_b16 a[172:173], v219 offset:10240
    ds_read_b64_tr_b16 a[174:175], v219 offset:11520
    v_mfma_f32_16x16x32_bf16 v[72:75], a[116:119], a[132:135], v[72:75]
    ds_read_b64_tr_b16 a[176:177], v220 offset:10240
    v_mfma_f32_16x16x32_bf16 v[92:95], a[120:123], a[132:135], v[92:95]
    ds_read_b64_tr_b16 a[178:179], v220 offset:11520
    buffer_load_dwordx4 v22, s[32:35], s77 offen offset:2048 lds
    v_mfma_f32_16x16x32_bf16 v[112:115], a[124:127], a[132:135], v[112:115]
    ds_read_b64_tr_b16 a[180:181], v221 offset:10240
    v_mfma_f32_16x16x32_bf16 v[56:59], a[112:115], a[136:139], v[56:59]
    ds_read_b64_tr_b16 a[182:183], v221 offset:11520
    v_mfma_f32_16x16x32_bf16 v[76:79], a[116:119], a[136:139], v[76:79]
    s_add_u32 s78, s78, 36864
    s_cmp_eq_u32 s78, 147456
    v_mfma_f32_16x16x32_bf16 v[96:99], a[120:123], a[136:139], v[96:99]
    buffer_load_dwordx4 v23, s[32:35], s77 offen offset:3072 lds
    s_cselect_b32 s78, 0, s78
    v_mfma_f32_16x16x32_bf16 v[116:119], a[124:127], a[136:139], v[116:119]
    v_add_u32 v215, s78, v208
    v_add_u32_e64 v216, s78, v209
    v_mfma_f32_16x16x32_bf16 v[60:63], a[112:115], a[140:143], v[60:63]
    s_add_u32 m0, m0, 4096
    v_add_u32_e64 v217, s78, v210
    v_mfma_f32_16x16x32_bf16 v[80:83], a[116:119], a[140:143], v[80:83]
    buffer_load_dwordx4 v24, s[32:35], s77 offen lds
    v_add_u32_e64 v218, s78, v211
    v_mfma_f32_16x16x32_bf16 v[100:103], a[120:123], a[140:143], v[100:103]
    v_add_u32 v219, s78, v212
    v_add_u32 v220, s78, v213
    v_mfma_f32_16x16x32_bf16 v[120:123], a[124:127], a[140:143], v[120:123]
    v_add_u32_e64 v221, s78, v214
    s_add_u32 s76, s76, 128
    v_mfma_f32_16x16x32_bf16 v[64:67], a[112:115], a[144:147], v[64:67]
    s_add_u32 s77, s77, 245760
    s_cmp_eq_u32 s77, 2457600
    v_mfma_f32_16x16x32_bf16 v[84:87], a[116:119], a[144:147], v[84:87]
    s_cselect_b32 s85, 1280, 0
    s_cselect_b32 s77, 0, s77
    v_mfma_f32_16x16x32_bf16 v[104:107], a[120:123], a[144:147], v[104:107]
    s_sub_u32 s76, s76, s85
    s_add_u32 s79, s79, 36864
    v_mfma_f32_16x16x32_bf16 v[124:127], a[124:127], a[144:147], v[124:127]
    s_cmp_eq_u32 s79, 147456
    s_cselect_b32 s79, 0, s79
    s_add_u32 s75, s75, 1
    s_cmp_lt_u32 s75, 6
    s_cbranch_scc1 kv_loop
.p2align 3
kv_loop2:
    s_waitcnt vmcnt(9) lgkmcnt(0)
    s_barrier
    v_mfma_f32_16x16x32_bf16 v[48:51], a[148:151], a[164:167], v[48:51]
    ds_read_b64_tr_b16 a[128:129], v217 offset:0
    ds_read_b64_tr_b16 a[130:131], v217 offset:1280
    v_mfma_f32_16x16x32_bf16 v[68:71], a[152:155], a[164:167], v[68:71]
    ds_read_b128 a[112:115], v215 offset:0
    ds_read_b128 a[116:119], v215 offset:2048
    v_mfma_f32_16x16x32_bf16 v[88:91], a[156:159], a[164:167], v[88:91]
    ds_read_b128 a[120:123], v215 offset:4096
    ds_read_b128 a[124:127], v215 offset:6144
    s_add_u32 m0, s79, s80
    s_nop 0
    v_mfma_f32_16x16x32_bf16 v[108:111], a[160:163], a[164:167], v[108:111]
    ds_read_b64_tr_b16 a[132:133], v218 offset:0
    ds_read_b64_tr_b16 a[134:135], v218 offset:1280
    buffer_load_dwordx4 v16, s[28:31], s76 offen offset:0 lds
    v_mfma_f32_16x16x32_bf16 v[52:55], a[148:151], a[168:171], v[52:55]
    ds_read_b64_tr_b16 a[136:137], v219 offset:0
    ds_read_b64_tr_b16 a[138:139], v219 offset:1280
    v_mfma_f32_16x16x32_bf16 v[72:75], a[152:155], a[168:171], v[72:75]
    ds_read_b64_tr_b16 a[140:141], v220 offset:0
    v_mfma_f32_16x16x32_bf16 v[92:95], a[156:159], a[168:171], v[92:95]
    ds_read_b64_tr_b16 a[142:143], v220 offset:1280
    v_mfma_f32_16x16x32_bf16 v[112:115], a[160:163], a[168:171], v[112:115]
    ds_read_b64_tr_b16 a[144:145], v221 offset:0
    buffer_load_dwordx4 v17, s[28:31], s76 offen offset:1024 lds
    v_mfma_f32_16x16x32_bf16 v[56:59], a[148:151], a[172:175], v[56:59]
    ds_read_b64_tr_b16 a[146:147], v221 offset:1280
    v_mfma_f32_16x16x32_bf16 v[76:79], a[152:155], a[172:175], v[76:79]
    v_mfma_f32_16x16x32_bf16 v[96:99], a[156:159], a[172:175], v[96:99]
    v_mfma_f32_16x16x32_bf16 v[116:119], a[160:163], a[172:175], v[116:119]
    buffer_load_dwordx4 v18, s[28:31], s76 offen offset:2048 lds
    v_mfma_f32_16x16x32_bf16 v[60:63], a[148:151], a[176:179], v[60:63]
    v_mfma_f32_16x16x32_bf16 v[80:83], a[152:155], a[176:179], v[80:83]
    v_mfma_f32_16x16x32_bf16 v[100:103], a[156:159], a[176:179], v[100:103]
    v_mfma_f32_16x16x32_bf16 v[120:123], a[160:163], a[176:179], v[120:123]
    buffer_load_dwordx4 v19, s[28:31], s76 offen offset:3072 lds
    v_mfma_f32_16x16x32_bf16 v[64:67], a[148:151], a[180:183], v[64:67]
    v_mfma_f32_16x16x32_bf16 v[84:87], a[152:155], a[180:183], v[84:87]
    v_mfma_f32_16x16x32_bf16 v[104:107], a[156:159], a[180:183], v[104:107]
    s_add_u32 m0, s79, s98
    v_mfma_f32_16x16x32_bf16 v[124:127], a[160:163], a[180:183], v[124:127]
    buffer_load_dwordx4 v20, s[32:35], s77 offen offset:0 nt lds
    s_waitcnt lgkmcnt(0)
    v_mfma_f32_16x16x32_bf16 v[48:51], a[112:115], a[128:131], v[48:51]
    ds_read_b64_tr_b16 a[164:165], v217 offset:10240
    ds_read_b64_tr_b16 a[166:167], v217 offset:11520
    v_mfma_f32_16x16x32_bf16 v[68:71], a[116:119], a[128:131], v[68:71]
    ds_read_b128 a[148:151], v216 offset:0
    ds_read_b128 a[152:155], v216 offset:2048
    v_mfma_f32_16x16x32_bf16 v[88:91], a[120:123], a[128:131], v[88:91]
    ds_read_b128 a[156:159], v216 offset:4096
    ds_read_b128 a[160:163], v216 offset:6144
    buffer_load_dwordx4 v21, s[32:35], s77 offen offset:1024 nt lds
    v_mfma_f32_16x16x32_bf16 v[108:111], a[124:127], a[128:131], v[108:111]
    ds_read_b64_tr_b16 a[168:169], v218 offset:10240
    ds_read_b64_tr_b16 a[170:171], v218 offset:11520
    v_mfma_f32_16x16x32_bf16 v[52:55], a[112:115], a[132:135], v[52:55]
    ds_read_b64_tr_b16 a[172:173], v219 offset:10240
    ds_read_b64_tr_b16 a[174:175], v219 offset:11520
    v_mfma_f32_16x16x32_bf16 v[72:75], a[116:119], a[132:135], v[72:75]
    ds_read_b64_tr_b16 a[176:177], v220 offset:10240
    v_mfma_f32_16x16x32_bf16 v[92:95], a[120:123], a[132:135], v[92:95]
    ds_read_b64_tr_b16 a[178:179], v220 offset:11520
    buffer_load_dwordx4 v22, s[32:35], s77 offen offset:2048 nt lds
    v_mfma_f32_16x16x32_bf16 v[112:115], a[124:127], a[132:135], v[112:115]
    ds_read_b64_tr_b16 a[180:181], v221 offset:10240
    v_mfma_f32_16x16x32_bf16 v[56:59], a[112:115], a[136:139], v[56:59]
    ds_read_b64_tr_b16 a[182:183], v221 offset:11520
    v_mfma_f32_16x16x32_bf16 v[76:79], a[116:119], a[136:139], v[76:79]
    s_add_u32 s78, s78, 36864
    s_cmp_eq_u32 s78, 147456
    v_mfma_f32_16x16x32_bf16 v[96:99], a[120:123], a[136:139], v[96:99]
    buffer_load_dwordx4 v23, s[32:35], s77 offen offset:3072 nt lds
    s_cselect_b32 s78, 0, s78
    v_mfma_f32_16x16x32_bf16 v[116:119], a[124:127], a[136:139], v[116:119]
    v_add_u32 v215, s78, v208
    v_add_u32_e64 v216, s78, v209
    v_mfma_f32_16x16x32_bf16 v[60:63], a[112:115], a[140:143], v[60:63]
    s_add_u32 m0, m0, 4096
    v_add_u32_e64 v217, s78, v210
    v_mfma_f32_16x16x32_bf16 v[80:83], a[116:119], a[140:143], v[80:83]
    buffer_load_dwordx4 v24, s[32:35], s77 offen nt lds
    v_add_u32_e64 v218, s78, v211
    v_mfma_f32_16x16x32_bf16 v[100:103], a[120:123], a[140:143], v[100:103]
    v_add_u32 v219, s78, v212
    v_add_u32 v220, s78, v213
    v_mfma_f32_16x16x32_bf16 v[120:123], a[124:127], a[140:143], v[120:123]
    v_add_u32_e64 v221, s78, v214
    s_add_u32 s76, s76, 128
    v_mfma_f32_16x16x32_bf16 v[64:67], a[112:115], a[144:147], v[64:67]
    s_add_u32 s77, s77, 245760
    s_cmp_eq_u32 s77, 2457600
    v_mfma_f32_16x16x32_bf16 v[84:87], a[116:119], a[144:147], v[84:87]
    s_cselect_b32 s85, 1280, 0
    s_cselect_b32 s77, 0, s77
    v_mfma_f32_16x16x32_bf16 v[104:107], a[120:123], a[144:147], v[104:107]
    s_sub_u32 s76, s76, s85
    s_add_u32 s79, s79, 36864
    v_mfma_f32_16x16x32_bf16 v[124:127], a[124:127], a[144:147], v[124:127]
    s_cmp_eq_u32 s79, 147456
    s_cselect_b32 s79, 0, s79
    s_add_u32 s75, s75, 1
    s_cmp_lt_u32 s75, 8
    s_cbranch_scc1 kv_loop2
    s_waitcnt vmcnt(9) lgkmcnt(0)
    s_barrier
    v_mfma_f32_16x16x32_bf16 v[48:51], a[148:151], a[164:167], v[48:51]
    ds_read_b64_tr_b16 a[128:129], v217 offset:0
    ds_read_b64_tr_b16 a[130:131], v217 offset:1280
    v_mfma_f32_16x16x32_bf16 v[68:71], a[152:155], a[164:167], v[68:71]
    ds_read_b128 a[112:115], v215 offset:0
    ds_read_b128 a[116:119], v215 offset:2048
    v_mfma_f32_16x16x32_bf16 v[88:91], a[156:159], a[164:167], v[88:91]
    ds_read_b128 a[120:123], v215 offset:4096
    ds_read_b128 a[124:127], v215 offset:6144
    buffer_load_dword v14, v13, s[36:39], s24 offen sc1
    v_mfma_f32_16x16x32_bf16 v[108:111], a[160:163], a[164:167], v[108:111]
    ds_read_b64_tr_b16 a[132:133], v218 offset:0
    ds_read_b64_tr_b16 a[134:135], v218 offset:1280
    v_mfma_f32_16x16x32_bf16 v[52:55], a[148:151], a[168:171], v[52:55]
    ds_read_b64_tr_b16 a[136:137], v219 offset:0
    ds_read_b64_tr_b16 a[138:139], v219 offset:1280
    v_mfma_f32_16x16x32_bf16 v[72:75], a[152:155], a[168:171], v[72:75]
    ds_read_b64_tr_b16 a[140:141], v220 offset:0
    buffer_load_dwordx2 v[242:243], v12, s[56:59], s23 offen offset:0
    v_mfma_f32_16x16x32_bf16 v[92:95], a[156:159], a[168:171], v[92:95]
    ds_read_b64_tr_b16 a[142:143], v220 offset:1280
    v_mfma_f32_16x16x32_bf16 v[112:115], a[160:163], a[168:171], v[112:115]
    ds_read_b64_tr_b16 a[144:145], v221 offset:0
    v_mfma_f32_16x16x32_bf16 v[56:59], a[148:151], a[172:175], v[56:59]
    ds_read_b64_tr_b16 a[146:147], v221 offset:1280
    buffer_load_dwordx2 v[244:245], v12, s[56:59], s23 offen offset:32
    v_mfma_f32_16x16x32_bf16 v[76:79], a[152:155], a[172:175], v[76:79]
    v_mfma_f32_16x16x32_bf16 v[96:99], a[156:159], a[172:175], v[96:99]
    s_add_u32 m0, s6, 0
    s_nop 0
    v_mfma_f32_16x16x32_bf16 v[116:119], a[160:163], a[172:175], v[116:119]
    buffer_load_dwordx4 v33, s[12:15], s4 offen offset:0 lds
    v_mfma_f32_16x16x32_bf16 v[60:63], a[148:151], a[176:179], v[60:63]
    v_mfma_f32_16x16x32_bf16 v[80:83], a[152:155], a[176:179], v[80:83]
    v_mfma_f32_16x16x32_bf16 v[100:103], a[156:159], a[176:179], v[100:103]
    buffer_load_dwordx4 v34, s[12:15], s4 offen offset:1024 lds
    v_mfma_f32_16x16x32_bf16 v[120:123], a[160:163], a[176:179], v[120:123]
    v_mfma_f32_16x16x32_bf16 v[64:67], a[148:151], a[180:183], v[64:67]
    v_mfma_f32_16x16x32_bf16 v[84:87], a[152:155], a[180:183], v[84:87]
    buffer_load_dwordx4 v35, s[12:15], s4 offen offset:2048 lds
    v_mfma_f32_16x16x32_bf16 v[104:107], a[156:159], a[180:183], v[104:107]
    v_mfma_f32_16x16x32_bf16 v[124:127], a[160:163], a[180:183], v[124:127]
    s_waitcnt lgkmcnt(0)
    s_nop 0
    v_mfma_f32_16x16x32_bf16 v[48:51], a[112:115], a[128:131], v[48:51]
    ds_read_b64_tr_b16 a[164:165], v217 offset:10240
    ds_read_b64_tr_b16 a[166:167], v217 offset:11520
    v_mfma_f32_16x16x32_bf16 v[68:71], a[116:119], a[128:131], v[68:71]
    ds_read_b128 a[148:151], v216 offset:0
    ds_read_b128 a[152:155], v216 offset:2048
    v_mfma_f32_16x16x32_bf16 v[88:91], a[120:123], a[128:131], v[88:91]
    ds_read_b128 a[156:159], v216 offset:4096
    ds_read_b128 a[160:163], v216 offset:6144
    buffer_load_dwordx4 v36, s[12:15], s4 offen offset:3072 lds
    s_add_u32 s4, s4, s11
    s_cmp_eq_u32 s4, s8
    s_cselect_b32 s4, s7, s4
    s_nop 0
    v_mfma_f32_16x16x32_bf16 v[108:111], a[124:127], a[128:131], v[108:111]
    ds_read_b64_tr_b16 a[168:169], v218 offset:10240
    ds_read_b64_tr_b16 a[170:171], v218 offset:11520
    v_mfma_f32_16x16x32_bf16 v[52:55], a[112:115], a[132:135], v[52:55]
    ds_read_b64_tr_b16 a[172:173], v219 offset:10240
    ds_read_b64_tr_b16 a[174:175], v219 offset:11520
    s_add_u32 m0, s6, 4096
    v_mfma_f32_16x16x32_bf16 v[72:75], a[116:119], a[132:135], v[72:75]
    ds_read_b64_tr_b16 a[176:177], v220 offset:10240
    buffer_load_dwordx4 v33, s[12:15], s4 offen offset:0 lds
    v_mfma_f32_16x16x32_bf16 v[92:95], a[120:123], a[132:135], v[92:95]
    ds_read_b64_tr_b16 a[178:179], v220 offset:11520
    v_mfma_f32_16x16x32_bf16 v[112:115], a[124:127], a[132:135], v[112:115]
    ds_read_b64_tr_b16 a[180:181], v221 offset:10240
    v_mfma_f32_16x16x32_bf16 v[56:59], a[112:115], a[136:139], v[56:59]
    ds_read_b64_tr_b16 a[182:183], v221 offset:11520
    buffer_load_dwordx4 v34, s[12:15], s4 offen offset:1024 lds
    v_mfma_f32_16x16x32_bf16 v[76:79], a[116:119], a[136:139], v[76:79]
    s_add_u32 s78, s78, 36864
    s_cmp_eq_u32 s78, 147456
    v_mfma_f32_16x16x32_bf16 v[96:99], a[120:123], a[136:139], v[96:99]
    s_cselect_b32 s78, 0, s78
    v_add_u32 v215, s78, v208
    v_mfma_f32_16x16x32_bf16 v[116:119], a[124:127], a[136:139], v[116:119]
    buffer_load_dwordx4 v35, s[12:15], s4 offen offset:2048 lds
    v_add_u32_e64 v216, s78, v209
    v_mfma_f32_16x16x32_bf16 v[60:63], a[112:115], a[140:143], v[60:63]
    v_add_u32 v217, s78, v210
    v_add_u32 v218, s78, v211
    v_mfma_f32_16x16x32_bf16 v[80:83], a[116:119], a[140:143], v[80:83]
    v_add_u32 v219, s78, v212
    v_add_u32 v220, s78, v213
    v_mfma_f32_16x16x32_bf16 v[100:103], a[120:123], a[140:143], v[100:103]
    buffer_load_dwordx4 v36, s[12:15], s4 offen offset:3072 lds
    s_add_u32 s4, s4, s11
    s_cmp_eq_u32 s4, s8
    s_cselect_b32 s4, s7, s4
    v_mfma_f32_16x16x32_bf16 v[120:123], a[124:127], a[140:143], v[120:123]
    v_add_u32 v221, s78, v214
    v_mfma_f32_16x16x32_bf16 v[64:67], a[112:115], a[144:147], v[64:67]
    v_mfma_f32_16x16x32_bf16 v[84:87], a[116:119], a[144:147], v[84:87]
    v_mfma_f32_16x16x32_bf16 v[104:107], a[120:123], a[144:147], v[104:107]
    v_mfma_f32_16x16x32_bf16 v[124:127], a[124:127], a[144:147], v[124:127]
    s_waitcnt vmcnt(8) lgkmcnt(0)
    v_cmp_ne_u32_e64 vcc, s16, v14
    s_cbranch_vccz pln_ok
    s_mov_b32 s98, 0
pln_spin:
    s_add_u32 s98, s98, 1
    s_cmp_gt_u32 s98, 0x80000
    s_cbranch_scc1 pln_ok
    s_sleep 1
    buffer_load_dword v14, v13, s[36:39], s24 offen sc1
    s_waitcnt vmcnt(0)
    v_cmp_ne_u32 vcc, s16, v14
    s_cbranch_vccnz pln_spin
pln_ok:
    s_barrier
    v_mfma_f32_16x16x32_bf16 v[48:51], a[148:151], a[164:167], v[48:51]
    ds_read_b64_tr_b16 a[128:129], v217 offset:0
    ds_read_b64_tr_b16 a[130:131], v217 offset:1280
    v_mfma_f32_16x16x32_bf16 v[68:71], a[152:155], a[164:167], v[68:71]
    ds_read_b128 a[112:115], v215 offset:0
    ds_read_b128 a[116:119], v215 offset:2048
    s_add_u32 m0, s6, 8192
    v_mfma_f32_16x16x32_bf16 v[88:91], a[156:159], a[164:167], v[88:91]
    ds_read_b128 a[120:123], v215 offset:4096
    ds_read_b128 a[124:127], v215 offset:6144
    buffer_load_dwordx4 v33, s[12:15], s4 offen offset:0 lds
    v_mfma_f32_16x16x32_bf16 v[108:111], a[160:163], a[164:167], v[108:111]
    ds_read_b64_tr_b16 a[132:133], v218 offset:0
    ds_read_b64_tr_b16 a[134:135], v218 offset:1280
    v_mfma_f32_16x16x32_bf16 v[52:55], a[148:151], a[168:171], v[52:55]
    ds_read_b64_tr_b16 a[136:137], v219 offset:0
    ds_read_b64_tr_b16 a[138:139], v219 offset:1280
    v_mfma_f32_16x16x32_bf16 v[72:75], a[152:155], a[168:171], v[72:75]
    ds_read_b64_tr_b16 a[140:141], v220 offset:0
    buffer_load_dwordx4 v34, s[12:15], s4 offen offset:1024 lds
    v_mfma_f32_16x16x32_bf16 v[92:95], a[156:159], a[168:171], v[92:95]
    ds_read_b64_tr_b16 a[142:143], v220 offset:1280
    v_mfma_f32_16x16x32_bf16 v[112:115], a[160:163], a[168:171], v[112:115]
    ds_read_b64_tr_b16 a[144:145], v221 offset:0
    v_mfma_f32_16x16x32_bf16 v[56:59], a[148:151], a[172:175], v[56:59]
    ds_read_b64_tr_b16 a[146:147], v221 offset:1280
    buffer_load_dwordx4 v35, s[12:15], s4 offen offset:2048 lds
    v_mfma_f32_16x16x32_bf16 v[76:79], a[152:155], a[172:175], v[76:79]
    v_mfma_f32_16x16x32_bf16 v[96:99], a[156:159], a[172:175], v[96:99]
    v_mfma_f32_16x16x32_bf16 v[116:119], a[160:163], a[172:175], v[116:119]
    buffer_load_dwordx4 v36, s[12:15], s4 offen offset:3072 lds
    s_add_u32 s4, s4, s11
    s_cmp_eq_u32 s4, s8
    s_cselect_b32 s4, s7, s4
    s_nop 0
    v_mfma_f32_16x16x32_bf16 v[60:63], a[148:151], a[176:179], v[60:63]
    v_mfma_f32_16x16x32_bf16 v[80:83], a[152:155], a[176:179], v[80:83]
    v_mfma_f32_16x16x32_bf16 v[100:103], a[156:159], a[176:179], v[100:103]
    v_mfma_f32_16x16x32_bf16 v[120:123], a[160:163], a[176:179], v[120:123]
    v_mfma_f32_16x16x32_bf16 v[64:67], a[148:151], a[180:183], v[64:67]
    v_mfma_f32_16x16x32_bf16 v[84:87], a[152:155], a[180:183], v[84:87]
    v_mfma_f32_16x16x32_bf16 v[104:107], a[156:159], a[180:183], v[104:107]
    v_mfma_f32_16x16x32_bf16 v[124:127], a[160:163], a[180:183], v[124:127]
    s_waitcnt lgkmcnt(0)
    s_nop 0
    v_mfma_f32_16x16x32_bf16 v[48:51], a[112:115], a[128:131], v[48:51]
    ds_read_b64_tr_b16 a[164:165], v217 offset:10240
    ds_read_b64_tr_b16 a[166:167], v217 offset:11520
    v_mfma_f32_16x16x32_bf16 v[68:71], a[116:119], a[128:131], v[68:71]
    ds_read_b128 a[148:151], v216 offset:0
    ds_read_b128 a[152:155], v216 offset:2048
    v_mfma_f32_16x16x32_bf16 v[88:91], a[120:123], a[128:131], v[88:91]
    ds_read_b128 a[156:159], v216 offset:4096
    ds_read_b128 a[160:163], v216 offset:6144
    v_mfma_f32_16x16x32_bf16 v[108:111], a[124:127], a[128:131], v[108:111]
    ds_read_b64_tr_b16 a[168:169], v218 offset:10240
    ds_read_b64_tr_b16 a[170:171], v218 offset:11520
    v_mfma_f32_16x16x32_bf16 v[52:55], a[112:115], a[132:135], v[52:55]
    ds_read_b64_tr_b16 a[172:173], v219 offset:10240
    ds_read_b64_tr_b16 a[174:175], v219 offset:11520
    v_mfma_f32_16x16x32_bf16 v[72:75], a[116:119], a[132:135], v[72:75]
    ds_read_b64_tr_b16 a[176:177], v220 offset:10240
    v_mfma_f32_16x16x32_bf16 v[92:95], a[120:123], a[132:135], v[92:95]
    ds_read_b64_tr_b16 a[178:179], v220 offset:11520
    v_mfma_f32_16x16x32_bf16 v[112:115], a[124:127], a[132:135], v[112:115]
    ds_read_b64_tr_b16 a[180:181], v221 offset:10240
    v_mfma_f32_16x16x32_bf16 v[56:59], a[112:115], a[136:139], v[56:59]
    ds_read_b64_tr_b16 a[182:183], v221 offset:11520
    v_mfma_f32_16x16x32_bf16 v[76:79], a[116:119], a[136:139], v[76:79]
    s_add_u32 s78, s78, 36864
    s_cmp_eq_u32 s78, 147456
    v_mfma_f32_16x16x32_bf16 v[96:99], a[120:123], a[136:139], v[96:99]
    s_cselect_b32 s78, 0, s78
    v_add_u32 v215, s78, v208
    v_mfma_f32_16x16x32_bf16 v[116:119], a[124:127], a[136:139], v[116:119]
    v_add_u32 v216, s78, v209
    v_add_u32 v217, s78, v210
    v_mfma_f32_16x16x32_bf16 v[60:63], a[112:115], a[140:143], v[60:63]
    v_add_u32 v218, s78, v211
    v_add_u32 v219, s78, v212
    v_mfma_f32_16x16x32_bf16 v[80:83], a[116:119], a[140:143], v[80:83]
    v_add_u32 v220, s78, v213
    v_add_u32 v221, s78, v214
    v_mfma_f32_16x16x32_bf16 v[100:103], a[120:123], a[140:143], v[100:103]
    v_mfma_f32_16x16x32_bf16 v[120:123], a[124:127], a[140:143], v[120:123]
    v_mfma_f32_16x16x32_bf16 v[64:67], a[112:115], a[144:147], v[64:67]
    v_mfma_f32_16x16x32_bf16 v[84:87], a[116:119], a[144:147], v[84:87]
    v_mfma_f32_16x16x32_bf16 v[104:107], a[120:123], a[144:147], v[104:107]
    v_mfma_f32_16x16x32_bf16 v[124:127], a[124:127], a[144:147], v[124:127]
    s_waitcnt lgkmcnt(0)
    s_nop 0
    v_mfma_f32_16x16x32_bf16 v[48:51], a[148:151], a[164:167], v[48:51]
    s_mov_b32 s88, 0x3fb8aa3b
    s_mov_b32 s89, 0x3fb8aa3b
    v_mov_b32 v208, 0x3f803f80
    v_mov_b32 v209, 0x3f803f80
    v_mov_b32 v210, 0x3f803f80
    v_mov_b32 v211, 0x3f803f80
    v_mfma_f32_16x16x32_bf16 v[52:55], a[148:151], a[168:171], v[52:55]
    v_mfma_f32_16x16x32_bf16 v[56:59], a[148:151], a[172:175], v[56:59]
    v_mfma_f32_16x16x32_bf16 v[60:63], a[148:151], a[176:179], v[60:63]
    v_mfma_f32_16x16x32_bf16 v[64:67], a[148:151], a[180:183], v[64:67]
    v_mfma_f32_16x16x32_bf16 v[68:71], a[152:155], a[164:167], v[68:71]
    v_mfma_f32_16x16x32_bf16 v[72:75], a[152:155], a[168:171], v[72:75]
    v_mfma_f32_16x16x32_bf16 v[76:79], a[152:155], a[172:175], v[76:79]
    v_mfma_f32_16x16x32_bf16 v[80:83], a[152:155], a[176:179], v[80:83]
    v_mfma_f32_16x16x32_bf16 v[84:87], a[152:155], a[180:183], v[84:87]
    v_pk_mul_f32 v[212:213], v[48:49], s[88:89]
    v_pk_mul_f32 v[214:215], v[50:51], s[88:89]
    v_mfma_f32_16x16x32_bf16 v[88:91], a[156:159], a[164:167], v[88:91]
    v_exp_f32 v212, v212 clamp
    v_exp_f32 v213, v213 clamp
    v_mfma_f32_16x16x32_bf16 v[92:95], a[156:159], a[168:171], v[92:95]
    v_exp_f32 v214, v214 clamp
    v_exp_f32 v215, v215 clamp
    v_mfma_f32_16x16x32_bf16 v[96:99], a[156:159], a[172:175], v[96:99]
    v_max_f32 v48, 0x358637bd, v48
    v_max_f32 v49, 0x358637bd, v49
    v_mfma_f32_16x16x32_bf16 v[100:103], a[156:159], a[176:179], v[100:103]
    v_max_f32 v50, 0x358637bd, v50
    v_max_f32 v51, 0x358637bd, v51
    v_mfma_f32_16x16x32_bf16 v[104:107], a[156:159], a[180:183], v[104:107]
    v_pk_add_f32 v[48:49], v[48:49], v[212:213]
    v_pk_add_f32 v[50:51], v[50:51], v[214:215]
    v_mfma_f32_16x16x32_bf16 v[108:111], a[160:163], a[164:167], v[108:111]
    v_pk_mul_f32 v[212:213], v[52:53], s[88:89]
    v_pk_mul_f32 v[214:215], v[54:55], s[88:89]
    v_mfma_f32_16x16x32_bf16 v[112:115], a[160:163], a[168:171], v[112:115]
    v_exp_f32 v212, v212 clamp
    v_exp_f32 v213, v213 clamp
    v_mfma_f32_16x16x32_bf16 v[116:119], a[160:163], a[172:175], v[116:119]
    v_exp_f32 v214, v214 clamp
    v_exp_f32 v215, v215 clamp
    v_mfma_f32_16x16x32_bf16 v[120:123], a[160:163], a[176:179], v[120:123]
    v_max_f32 v52, 0x358637bd, v52
    v_max_f32 v53, 0x358637bd, v53
    v_mfma_f32_16x16x32_bf16 v[124:127], a[160:163], a[180:183], v[124:127]
    v_max_f32 v54, 0x358637bd, v54
    v_max_f32 v55, 0x358637bd, v55
    v_pk_add_f32 v[52:53], v[52:53], v[212:213]
    v_pk_add_f32 v[54:55], v[54:55], v[214:215]
    v_pk_mul_f32 v[212:213], v[56:57], s[88:89]
    v_pk_mul_f32 v[214:215], v[58:59], s[88:89]
    v_exp_f32 v212, v212 clamp
    v_exp_f32 v213, v213 clamp
    v_exp_f32 v214, v214 clamp
    v_exp_f32 v215, v215 clamp
    v_max_f32 v216, 0x358637bd, v56
    v_max_f32 v217, 0x358637bd, v57
    v_max_f32 v218, 0x358637bd, v58
    v_max_f32 v219, 0x358637bd, v59
    v_pk_add_f32 v[216:217], v[216:217], v[212:213]
    v_pk_add_f32 v[218:219], v[218:219], v[214:215]
    v_cndmask_b32 v56, v56, v216, s[92:93]
    v_cndmask_b32 v57, v57, v217, s[92:93]
    v_cndmask_b32 v58, v58, v218, s[92:93]
    v_cndmask_b32 v59, v59, v219, s[92:93]
    v_cvt_pk_bf16_f32 v128, v48, v49
    v_cvt_pk_bf16_f32 v129, v50, v51
    v_cvt_pk_bf16_f32 v136, v52, v53
    v_cvt_pk_bf16_f32 v137, v54, v55
    v_cvt_pk_bf16_f32 v144, v56, v57
    v_cvt_pk_bf16_f32 v145, v58, v59
    buffer_load_dwordx4 a[0:3], v37, s[36:39], s5 offen offset:0 sc1
    v_cvt_pk_bf16_f32 v152, v60, v61
    v_cvt_pk_bf16_f32 v153, v62, v63
    v_cvt_pk_bf16_f32 v160, v64, v65
    v_cvt_pk_bf16_f32 v161, v66, v67
    v_pk_mul_f32 v[212:213], v[68:69], s[88:89]
    v_pk_mul_f32 v[214:215], v[70:71], s[88:89]
    v_exp_f32 v212, v212 clamp
    v_exp_f32 v213, v213 clamp
    v_exp_f32 v214, v214 clamp
    v_exp_f32 v215, v215 clamp
    v_max_f32 v68, 0x358637bd, v68
    v_max_f32 v69, 0x358637bd, v69
    v_max_f32 v70, 0x358637bd, v70
    buffer_load_dwordx4 a[4:7], v37, s[36:39], s5 offen offset:1024 sc1
    v_max_f32 v71, 0x358637bd, v71
    v_pk_add_f32 v[68:69], v[68:69], v[212:213]
    v_pk_add_f32 v[70:71], v[70:71], v[214:215]
    v_pk_mul_f32 v[212:213], v[72:73], s[88:89]
    v_pk_mul_f32 v[214:215], v[74:75], s[88:89]
    v_exp_f32 v212, v212 clamp
    v_exp_f32 v213, v213 clamp
    v_exp_f32 v214, v214 clamp
    v_exp_f32 v215, v215 clamp
    v_max_f32 v72, 0x358637bd, v72
    v_max_f32 v73, 0x358637bd, v73
    v_max_f32 v74, 0x358637bd, v74
    v_max_f32 v75, 0x358637bd, v75
    buffer_load_dwordx4 a[8:11], v37, s[36:39], s5 offen offset:2048 sc1
    v_pk_add_f32 v[72:73], v[72:73], v[212:213]
    v_pk_add_f32 v[74:75], v[74:75], v[214:215]
    v_pk_mul_f32 v[212:213], v[76:77], s[88:89]
    v_pk_mul_f32 v[214:215], v[78:79], s[88:89]
    v_exp_f32 v212, v212 clamp
    v_exp_f32 v213, v213 clamp
    v_exp_f32 v214, v214 clamp
    v_exp_f32 v215, v215 clamp
    v_max_f32 v216, 0x358637bd, v76
    v_max_f32 v217, 0x358637bd, v77
    v_max_f32 v218, 0x358637bd, v78
    v_max_f32 v219, 0x358637bd, v79
    v_pk_add_f32 v[216:217], v[216:217], v[212:213]
    buffer_load_dwordx4 a[12:15], v37, s[36:39], s5 offen offset:3072 sc1
    v_pk_add_f32 v[218:219], v[218:219], v[214:215]
    v_cndmask_b32 v76, v76, v216, s[92:93]
    v_cndmask_b32 v77, v77, v217, s[92:93]
    v_cndmask_b32 v78, v78, v218, s[92:93]
    v_cndmask_b32 v79, v79, v219, s[92:93]
    v_cvt_pk_bf16_f32 v130, v68, v69
    v_cvt_pk_bf16_f32 v131, v70, v71
    v_cvt_pk_bf16_f32 v138, v72, v73
    v_cvt_pk_bf16_f32 v139, v74, v75
    v_cvt_pk_bf16_f32 v146, v76, v77
    v_cvt_pk_bf16_f32 v147, v78, v79
    v_cvt_pk_bf16_f32 v154, v80, v81
    v_cvt_pk_bf16_f32 v155, v82, v83
    buffer_load_dwordx4 a[16:19], v38, s[36:39], s5 offen offset:0 sc1
    s_add_u32 s5, s5, 40960
    s_cmp_eq_u32 s5, s10
    s_cselect_b32 s5, s9, s5
    v_cvt_pk_bf16_f32 v162, v84, v85
    v_cvt_pk_bf16_f32 v163, v86, v87
    v_pk_mul_f32 v[212:213], v[88:89], s[88:89]
    v_pk_mul_f32 v[214:215], v[90:91], s[88:89]
    v_exp_f32 v212, v212 clamp
    v_mfma_f32_16x16x32_bf16 v[196:199], v[208:211], v[128:131], 0
    v_exp_f32 v213, v213 clamp
    v_exp_f32 v214, v214 clamp
    v_exp_f32 v215, v215 clamp
    v_max_f32 v88, 0x358637bd, v88
    v_mfma_f32_16x16x32_bf16 v[200:203], v[208:211], v[136:139], 0
    v_max_f32 v89, 0x358637bd, v89
    v_max_f32 v90, 0x358637bd, v90
    buffer_load_dwordx4 a[20:23], v37, s[36:39], s5 offen offset:0 sc1
    v_max_f32 v91, 0x358637bd, v91
    v_pk_add_f32 v[88:89], v[88:89], v[212:213]
    v_mfma_f32_16x16x32_bf16 v[204:207], v[208:211], v[144:147], 0
    v_pk_add_f32 v[90:91], v[90:91], v[214:215]
    v_pk_mul_f32 v[212:213], v[92:93], s[88:89]
    v_pk_mul_f32 v[214:215], v[94:95], s[88:89]
    v_exp_f32 v212, v212 clamp
    v_mfma_f32_16x16x32_bf16 v[168:171], v[144:147], v[128:131], 0
    v_exp_f32 v213, v213 clamp
    v_exp_f32 v214, v214 clamp
    v_exp_f32 v215, v215 clamp
    v_max_f32 v92, 0x358637bd, v92
    v_mfma_f32_16x16x32_bf16 v[172:175], v[152:155], v[128:131], 0
    buffer_load_dwordx4 a[24:27], v37, s[36:39], s5 offen offset:1024 sc1
    v_max_f32 v93, 0x358637bd, v93
    v_max_f32 v94, 0x358637bd, v94
    v_max_f32 v95, 0x358637bd, v95
    v_pk_add_f32 v[92:93], v[92:93], v[212:213]
    v_mfma_f32_16x16x32_bf16 v[176:179], v[144:147], v[136:139], 0
    v_pk_add_f32 v[94:95], v[94:95], v[214:215]
    v_pk_mul_f32 v[212:213], v[96:97], s[88:89]
    v_pk_mul_f32 v[214:215], v[98:99], s[88:89]
    v_exp_f32 v212, v212 clamp
    v_mfma_f32_16x16x32_bf16 v[180:183], v[152:155], v[136:139], 0
    v_exp_f32 v213, v213 clamp
    v_exp_f32 v214, v214 clamp
    v_exp_f32 v215, v215 clamp
    buffer_load_dwordx4 a[28:31], v37, s[36:39], s5 offen offset:2048 sc1
    v_max_f32 v216, 0x358637bd, v96
    v_mfma_f32_16x16x32_bf16 v[184:187], v[160:163], v[136:139], 0
    v_max_f32 v217, 0x358637bd, v97
    v_max_f32 v218, 0x358637bd, v98
    v_max_f32 v219, 0x358637bd, v99
    v_pk_add_f32 v[216:217], v[216:217], v[212:213]
    v_mfma_f32_16x16x32_bf16 v[188:191], v[152:155], v[144:147], 0
    v_pk_add_f32 v[218:219], v[218:219], v[214:215]
    v_cndmask_b32 v96, v96, v216, s[92:93]
    v_cndmask_b32 v97, v97, v217, s[92:93]
    v_cndmask_b32 v98, v98, v218, s[92:93]
    v_mfma_f32_16x16x32_bf16 v[192:195], v[160:163], v[144:147], 0
    v_cndmask_b32 v99, v99, v219, s[92:93]
    buffer_load_dwordx4 a[32:35], v37, s[36:39], s5 offen offset:3072 sc1
    v_cvt_pk_bf16_f32 v132, v88, v89
    v_cvt_pk_bf16_f32 v133, v90, v91
    v_cvt_pk_bf16_f32 v140, v92, v93
    v_cvt_pk_bf16_f32 v141, v94, v95
    v_cvt_pk_bf16_f32 v148, v96, v97
    v_cvt_pk_bf16_f32 v149, v98, v99
    v_cvt_pk_bf16_f32 v156, v100, v101
    v_cvt_pk_bf16_f32 v157, v102, v103
    v_cvt_pk_bf16_f32 v164, v104, v105
    v_cvt_pk_bf16_f32 v165, v106, v107
    v_pk_mul_f32 v[212:213], v[108:109], s[88:89]
    v_pk_mul_f32 v[214:215], v[110:111], s[88:89]
    v_exp_f32 v212, v212 clamp
    buffer_load_dwordx4 a[36:39], v38, s[36:39], s5 offen offset:0 sc1
    s_add_u32 s5, s5, 40960
    s_cmp_eq_u32 s5, s10
    s_cselect_b32 s5, s9, s5
    v_exp_f32 v213, v213 clamp
    v_exp_f32 v214, v214 clamp
    v_exp_f32 v215, v215 clamp
    v_max_f32 v108, 0x358637bd, v108
    v_max_f32 v109, 0x358637bd, v109
    v_max_f32 v110, 0x358637bd, v110
    v_max_f32 v111, 0x358637bd, v111
    v_pk_add_f32 v[108:109], v[108:109], v[212:213]
    v_pk_add_f32 v[110:111], v[110:111], v[214:215]
    v_pk_mul_f32 v[212:213], v[112:113], s[88:89]
    v_pk_mul_f32 v[214:215], v[114:115], s[88:89]
    v_exp_f32 v212, v212 clamp
    v_exp_f32 v213, v213 clamp
    buffer_load_dwordx4 a[40:43], v37, s[36:39], s5 offen offset:0 sc1
    v_exp_f32 v214, v214 clamp
    v_exp_f32 v215, v215 clamp
    v_max_f32 v112, 0x358637bd, v112
    v_max_f32 v113, 0x358637bd, v113
    v_max_f32 v114, 0x358637bd, v114
    v_max_f32 v115, 0x358637bd, v115
    v_pk_add_f32 v[112:113], v[112:113], v[212:213]
    v_pk_add_f32 v[114:115], v[114:115], v[214:215]
    v_pk_mul_f32 v[212:213], v[116:117], s[88:89]
    v_pk_mul_f32 v[214:215], v[118:119], s[88:89]
    v_exp_f32 v212, v212 clamp
    v_exp_f32 v213, v213 clamp
    v_exp_f32 v214, v214 clamp
    buffer_load_dwordx4 a[44:47], v37, s[36:39], s5 offen offset:1024 sc1
    v_exp_f32 v215, v215 clamp
    v_max_f32 v216, 0x358637bd, v116
    v_max_f32 v217, 0x358637bd, v117
    v_max_f32 v218, 0x358637bd, v118
    v_max_f32 v219, 0x358637bd, v119
    v_pk_add_f32 v[216:217], v[216:217], v[212:213]
    v_pk_add_f32 v[218:219], v[218:219], v[214:215]
    v_cndmask_b32 v116, v116, v216, s[92:93]
    v_cndmask_b32 v117, v117, v217, s[92:93]
    v_cndmask_b32 v118, v118, v218, s[92:93]
    v_cndmask_b32 v119, v119, v219, s[92:93]
    v_cvt_pk_bf16_f32 v134, v108, v109
    v_cvt_pk_bf16_f32 v135, v110, v111
    buffer_load_dwordx4 a[48:51], v37, s[36:39], s5 offen offset:2048 sc1
    v_cvt_pk_bf16_f32 v142, v112, v113
    v_cvt_pk_bf16_f32 v143, v114, v115
    v_cvt_pk_bf16_f32 v150, v116, v117
    v_cvt_pk_bf16_f32 v151, v118, v119
    v_cvt_pk_bf16_f32 v158, v120, v121
    v_cvt_pk_bf16_f32 v159, v122, v123
    v_cvt_pk_bf16_f32 v166, v124, v125
    v_cvt_pk_bf16_f32 v167, v126, v127
    s_nop 1
    s_nop 0
    v_mfma_f32_16x16x32_bf16 v[196:199], v[208:211], v[132:135], v[196:199]
    v_mfma_f32_16x16x32_bf16 v[200:203], v[208:211], v[140:143], v[200:203]
    v_mfma_f32_16x16x32_bf16 v[204:207], v[208:211], v[148:151], v[204:207]
    v_mfma_f32_16x16x32_bf16 v[168:171], v[148:151], v[132:135], v[168:171]
    v_mfma_f32_16x16x32_bf16 v[172:175], v[156:159], v[132:135], v[172:175]
    v_mfma_f32_16x16x32_bf16 v[176:179], v[148:151], v[140:143], v[176:179]
    v_mfma_f32_16x16x32_bf16 v[180:183], v[156:159], v[140:143], v[180:183]
    v_mfma_f32_16x16x32_bf16 v[184:187], v[164:167], v[140:143], v[184:187]
    v_mfma_f32_16x16x32_bf16 v[188:191], v[156:159], v[148:151], v[188:191]
    v_mfma_f32_16x16x32_bf16 v[192:195], v[164:167], v[148:151], v[192:195]
    s_nop 0
    s_nop 0
    v_cndmask_b32 v196, v196, v200, s[64:65]
    v_cndmask_b32 v196, v196, v204, s[66:67]
    ds_write_b32 v251, v196 offset:7168
    ds_write_b128 v250, v[168:171] offset:0
    ds_write_b128 v250, v[172:175] offset:1024
    ds_write_b128 v250, v[176:179] offset:2048
    ds_write_b128 v250, v[180:183] offset:3072
    ds_write_b128 v250, v[184:187] offset:4096
    ds_write_b128 v250, v[188:191] offset:5120
    ds_write_b128 v250, v[192:195] offset:6144
    s_waitcnt lgkmcnt(0)
    s_barrier
    ds_read_b128 v[128:131], v252 offset:0
    ds_read_b128 v[132:135], v252 offset:16896
    ds_read_b128 v[136:139], v252 offset:1024
    ds_read_b128 v[140:143], v252 offset:17920
    ds_read_b128 v[144:147], v252 offset:2048
    ds_read_b128 v[148:151], v252 offset:18944
    ds_read_b128 v[152:155], v252 offset:3072
    ds_read_b128 v[156:159], v252 offset:19968
    s_waitcnt lgkmcnt(0)
    s_nop 0
    v_pk_add_f32 v[128:129], v[128:129], v[132:133]
    v_pk_add_f32 v[130:131], v[130:131], v[134:135]
    v_pk_add_f32 v[136:137], v[136:137], v[140:141]
    v_pk_add_f32 v[138:139], v[138:139], v[142:143]
    v_pk_add_f32 v[144:145], v[144:145], v[148:149]
    v_pk_add_f32 v[146:147], v[146:147], v[150:151]
    v_pk_add_f32 v[152:153], v[152:153], v[156:157]
    v_pk_add_f32 v[154:155], v[154:155], v[158:159]
    buffer_store_dwordx4 v[128:131], v246, s[36:39], s26 offen sc1
    buffer_store_dwordx4 v[136:139], v247, s[36:39], s26 offen sc1
    buffer_store_dwordx4 v[144:147], v248, s[36:39], s26 offen sc1
    buffer_store_dwordx4 v[152:155], v249, s[36:39], s26 offen sc1
    buffer_load_dwordx4 a[52:55], v37, s[36:39], s5 offen offset:3072 sc1
    buffer_load_dwordx4 a[56:59], v38, s[36:39], s5 offen offset:0 sc1
    s_add_u32 s5, s5, 40960
    s_cmp_eq_u32 s5, s10
    s_cselect_b32 s5, s9, s5
    s_waitcnt vmcnt(19)
    s_nop 0
    ds_read_b64_tr_b16 a[80:81], v39 offset:0
    ds_read_b64_tr_b16 a[82:83], v39 offset:2048
    ds_read_b64_tr_b16 a[84:85], v40 offset:0
    ds_read_b64_tr_b16 a[86:87], v40 offset:2048
    ds_read_b64_tr_b16 a[88:89], v41 offset:0
    ds_read_b64_tr_b16 a[90:91], v41 offset:2048
    ds_read_b64_tr_b16 a[92:93], v42 offset:0
    ds_read_b64_tr_b16 a[94:95], v42 offset:2048
    s_waitcnt vmcnt(2)
    s_barrier
    s_cmp_lg_u32 s68, 0
    s_cbranch_scc1 g1_pub1
    v_mov_b32 v2, s16
    v_lshlrev_b32_e64 v3, 2, v1
    s_mov_b32 exec_hi, 0
    buffer_store_dword v2, v3, s[36:39], s3 offen sc1
    s_mov_b32 exec_hi, -1
g1_pub1:
    s_waitcnt vmcnt(14) lgkmcnt(0)
    s_add_u32 m0, s6, 12288
    v_mfma_f32_16x16x32_bf16 a[112:115], a[80:83], a[0:3], 0
    v_and_b32 v2, 15, v1
    v_lshrrev_b32 v3, 4, v1
    v_xor_b32_e64 v4, v2, v3
    buffer_load_dwordx4 v33, s[12:15], s4 offen offset:0 lds
    v_mfma_f32_16x16x32_bf16 a[132:135], a[84:87], a[0:3], 0
    v_lshlrev_b32_e64 v4, 4, v4
    v_lshl_add_u32 v4, v2, 8, v4
    s_mul_i32 s85, s68, 20480
    buffer_load_dwordx4 v34, s[12:15], s4 offen offset:1024 lds
    v_mfma_f32_16x16x32_bf16 a[152:155], a[88:91], a[0:3], 0
    s_add_u32 s85, s85, 65536
    v_add_u32 v224, s85, v4
    v_xor_b32 v225, 64, v224
    buffer_load_dwordx4 v35, s[12:15], s4 offen offset:2048 lds
    v_mfma_f32_16x16x32_bf16 a[172:175], a[92:95], a[0:3], 0
    v_xor_b32 v226, 128, v224
    v_xor_b32 v227, 192, v224
    s_and_b32 s85, s68, 1
    buffer_load_dwordx4 v36, s[12:15], s4 offen offset:3072 lds
    buffer_load_dwordx4 a[60:63], v37, s[36:39], s5 offen offset:0 sc1
    v_mfma_f32_16x16x32_bf16 a[116:119], a[80:83], a[4:7], 0
    s_lshr_b32 s86, s68, 1
    s_lshl_b32 s87, s85, 7
    v_xor_b32 v4, s87, v4
    ds_read_b64_tr_b16 a[96:97], v39 offset:4096
    v_mfma_f32_16x16x32_bf16 a[136:139], a[84:87], a[4:7], 0
    s_lshl_b32 s87, s86, 12
    s_add_u32 s87, s87, 65536
    v_add_u32 v228, s87, v4
    ds_read_b64_tr_b16 a[98:99], v39 offset:6144
    v_mfma_f32_16x16x32_bf16 a[156:159], a[88:91], a[4:7], 0
    v_xor_b32_e64 v229, 64, v228
    v_add_u32 v230, 40960, v228
    v_add_u32 v231, 40960, v229
    ds_read_b64_tr_b16 a[100:101], v40 offset:4096
    v_mfma_f32_16x16x32_bf16 a[176:179], a[92:95], a[4:7], 0
    s_lshl_b32 s87, s72, 1
    s_add_u32 s87, s87, s85
    s_mul_i32 s87, s87, 40
    ds_read_b64_tr_b16 a[102:103], v40 offset:6144
    buffer_load_dwordx4 a[64:67], v37, s[36:39], s5 offen offset:1024 sc1
    v_mfma_f32_16x16x32_bf16 a[120:123], a[80:83], a[8:11], 0
    s_mul_i32 s88, s71, 5
    s_add_u32 s87, s87, s88
    s_add_u32 s87, s87, s86
    ds_read_b64_tr_b16 a[104:105], v41 offset:4096
    v_mfma_f32_16x16x32_bf16 a[140:143], a[84:87], a[8:11], 0
    s_lshl_b32 s87, s87, 10
    s_nop 0
    s_add_u32 s52, s87, 0x280000
    s_add_u32 s53, s52, 4096
    ds_read_b64_tr_b16 a[106:107], v41 offset:6144
    v_mfma_f32_16x16x32_bf16 a[160:163], a[88:91], a[8:11], 0
    s_mov_b32 s90, 0xbdd2d3e8
    s_mov_b32 s91, 0xbdd2d3e8
    v_mov_b32 v232, 0xc0135761
    ds_read_b64_tr_b16 a[108:109], v42 offset:4096
    v_mfma_f32_16x16x32_bf16 a[180:183], a[92:95], a[8:11], 0
    v_mov_b32 v233, 0xc0135761
    s_and_b32 s94, s74, 3
    s_lshl_b32 s94, s94, 1
    ds_read_b64_tr_b16 a[110:111], v42 offset:6144
    buffer_load_dwordx4 a[68:71], v37, s[36:39], s5 offen offset:2048 sc1
    v_mfma_f32_16x16x32_bf16 a[124:127], a[80:83], a[12:15], 0
    s_and_b32 s89, s73, 7
    s_add_u32 s94, s94, s89
    s_mul_i32 s89, s94, 52
    s_add_u32 s4, s4, s11
    s_cmp_eq_u32 s4, s8
    s_cselect_b32 s4, s7, s4
    v_mfma_f32_16x16x32_bf16 a[144:147], a[84:87], a[12:15], 0
    s_lshr_b32 s89, s89, 8
    s_mul_i32 s89, s89, 5
    s_sub_u32 s94, s94, s89
    v_mfma_f32_16x16x32_bf16 a[164:167], a[88:91], a[12:15], 0
    s_add_u32 s94, s73, s74
    s_and_b32 s94, s94, 1
    s_mul_i32 s94, s94, 3
    v_mfma_f32_16x16x32_bf16 a[184:187], a[92:95], a[12:15], 0
    s_mul_i32 s86, s68, 5
    s_add_u32 s86, s86, s94
    s_mul_i32 s54, s73, 20
    buffer_load_dwordx4 a[72:75], v37, s[36:39], s5 offen offset:3072 sc1
    v_mfma_f32_16x16x32_bf16 a[128:131], a[80:83], a[16:19], 0
    s_add_u32 s54, s54, s86
    s_lshl_b32 s54, s54, 12
    s_add_u32 s54, s54, 0x460000
    v_mfma_f32_16x16x32_bf16 a[148:151], a[84:87], a[16:19], 0
    s_mul_i32 s55, s86, 40960
    s_mul_i32 s89, s74, 5120
    s_add_u32 s55, s55, s89
    v_mfma_f32_16x16x32_bf16 a[168:171], a[88:91], a[16:19], 0
    s_add_u32 s55, s55, 0x6e0000
    v_mfma_f32_16x16x32_bf16 a[188:191], a[92:95], a[16:19], 0
    buffer_load_dwordx4 a[76:79], v38, s[36:39], s5 offen offset:0 sc1
    s_add_u32 s5, s5, 40960
    s_cmp_eq_u32 s5, s10
    s_cselect_b32 s5, s9, s5
    s_waitcnt vmcnt(18) lgkmcnt(0)
    v_and_b32 v5, 15, v1
    v_lshlrev_b32 v6, 2, v5
    s_lshl_b32 s23, s73, 8
    s_add_u32 s23, s23, 0x972000
    buffer_load_dword v8, v6, s[36:39], s23 offen offset:0 sc1
    buffer_load_dword v9, v6, s[36:39], s23 offen offset:64 sc1
    buffer_load_dword v10, v6, s[36:39], s23 offen offset:128 sc1
    buffer_load_dword v11, v6, s[36:39], s23 offen offset:192 sc1
    v_lshlrev_b32 v6, 1, v5
    s_lshl_b32 s23, s73, 7
    s_cmp_eq_u32 s68, 0
    s_cselect_b32 s23, s23, 0x40000000
    buffer_load_ushort v29, v6, s[60:63], s23 offen offset:0
    buffer_load_ushort v30, v6, s[60:63], s23 offen offset:32
    buffer_load_ushort v31, v6, s[60:63], s23 offen offset:64
    buffer_load_ushort v32, v6, s[60:63], s23 offen offset:96
    s_add_u32 m0, s6, 0
    s_nop 0
    v_mfma_f32_16x16x32_bf16 a[112:115], a[96:99], a[20:23], a[112:115]
    buffer_load_dwordx4 v33, s[12:15], s4 offen offset:0 lds
    v_mfma_f32_16x16x32_bf16 a[132:135], a[100:103], a[20:23], a[132:135]
    buffer_load_dwordx4 v34, s[12:15], s4 offen offset:1024 lds
    v_mfma_f32_16x16x32_bf16 a[152:155], a[104:107], a[20:23], a[152:155]
    buffer_load_dwordx4 v35, s[12:15], s4 offen offset:2048 lds
    v_mfma_f32_16x16x32_bf16 a[172:175], a[108:111], a[20:23], a[172:175]
    buffer_load_dwordx4 v36, s[12:15], s4 offen offset:3072 lds
    buffer_load_dwordx4 a[0:3], v37, s[36:39], s5 offen offset:0 sc1
    v_mfma_f32_16x16x32_bf16 a[116:119], a[96:99], a[24:27], a[116:119]
    ds_read_b64_tr_b16 a[80:81], v39 offset:8192
    v_mfma_f32_16x16x32_bf16 a[136:139], a[100:103], a[24:27], a[136:139]
    ds_read_b64_tr_b16 a[82:83], v39 offset:10240
    v_mfma_f32_16x16x32_bf16 a[156:159], a[104:107], a[24:27], a[156:159]
    ds_read_b64_tr_b16 a[84:85], v40 offset:8192
    v_mfma_f32_16x16x32_bf16 a[176:179], a[108:111], a[24:27], a[176:179]
    ds_read_b64_tr_b16 a[86:87], v40 offset:10240
    buffer_load_dwordx4 a[4:7], v37, s[36:39], s5 offen offset:1024 sc1
    v_mfma_f32_16x16x32_bf16 a[120:123], a[96:99], a[28:31], a[120:123]
    ds_read_b64_tr_b16 a[88:89], v41 offset:8192
    v_mfma_f32_16x16x32_bf16 a[140:143], a[100:103], a[28:31], a[140:143]
    ds_read_b64_tr_b16 a[90:91], v41 offset:10240
    v_mfma_f32_16x16x32_bf16 a[160:163], a[104:107], a[28:31], a[160:163]
    ds_read_b64_tr_b16 a[92:93], v42 offset:8192
    v_mfma_f32_16x16x32_bf16 a[180:183], a[108:111], a[28:31], a[180:183]
    ds_read_b64_tr_b16 a[94:95], v42 offset:10240
    buffer_load_dwordx4 a[8:11], v37, s[36:39], s5 offen offset:2048 sc1
    v_mfma_f32_16x16x32_bf16 a[124:127], a[96:99], a[32:35], a[124:127]
    s_add_u32 s4, s4, s11
    s_cmp_eq_u32 s4, s8
    s_cselect_b32 s4, s7, s4
    s_nop 0
    v_mfma_f32_16x16x32_bf16 a[144:147], a[100:103], a[32:35], a[144:147]
    v_mfma_f32_16x16x32_bf16 a[164:167], a[104:107], a[32:35], a[164:167]
    v_mfma_f32_16x16x32_bf16 a[184:187], a[108:111], a[32:35], a[184:187]
    buffer_load_dwordx4 a[12:15], v37, s[36:39], s5 offen offset:3072 sc1
    v_mfma_f32_16x16x32_bf16 a[128:131], a[96:99], a[36:39], a[128:131]
    v_mfma_f32_16x16x32_bf16 a[148:151], a[100:103], a[36:39], a[148:151]
    v_mfma_f32_16x16x32_bf16 a[168:171], a[104:107], a[36:39], a[168:171]
    v_mfma_f32_16x16x32_bf16 a[188:191], a[108:111], a[36:39], a[188:191]
    buffer_load_dwordx4 a[16:19], v38, s[36:39], s5 offen offset:0 sc1
    s_add_u32 s5, s5, 40960
    s_cmp_eq_u32 s5, s10
    s_cselect_b32 s5, s9, s5
    s_waitcnt vmcnt(22) lgkmcnt(0)
    s_add_u32 m0, s6, 4096
    v_mfma_f32_16x16x32_bf16 a[112:115], a[80:83], a[40:43], a[112:115]
    v_min_u32 v12, 23, v1
    v_lshlrev_b32_e64 v12, 7, v12
    s_mul_i32 s23, s74, 3072
    s_add_u32 s23, s23, 0x97c080
    buffer_load_dwordx4 v33, s[12:15], s4 offen offset:0 lds
    v_mfma_f32_16x16x32_bf16 a[132:135], a[84:87], a[40:43], a[132:135]
    v_and_b32 v5, 15, v1
    v_lshrrev_b32 v6, 4, v1
    v_mul_u32_u24 v4, 336, v5
    v_lshl_add_u32 v4, v6, 4, v4
    buffer_load_dwordx4 v34, s[12:15], s4 offen offset:1024 lds
    v_mfma_f32_16x16x32_bf16 a[152:155], a[88:91], a[40:43], a[152:155]
    s_mul_i32 s85, s68, 21504
    s_add_u32 s85, s85, 65536
    v_add_u32_e64 v4, s85, v4
    s_mul_i32 s85, s68, 5376
    buffer_load_dwordx4 v35, s[12:15], s4 offen offset:2048 lds
    v_mfma_f32_16x16x32_bf16 a[172:175], a[92:95], a[40:43], a[172:175]
    s_add_u32 s85, s85, 65536
    s_lshl_b32 s95, s73, 2
    s_add_u32 s95, s95, s68
    s_mul_i32 s95, s95, 20480
    buffer_load_dwordx4 v36, s[12:15], s4 offen offset:3072 lds
    buffer_load_dwordx4 a[20:23], v37, s[36:39], s5 offen offset:0 sc1
    v_mfma_f32_16x16x32_bf16 a[116:119], a[80:83], a[44:47], a[116:119]
    s_mul_i32 s87, s74, 160
    s_add_u32 s95, s95, s87
    v_add_u32 v5, 0, v1
    v_mul_u32_u24 v6, 3277, v5
    ds_read_b64_tr_b16 a[96:97], v39 offset:12288
    v_mfma_f32_16x16x32_bf16 a[136:139], a[84:87], a[44:47], a[136:139]
    v_lshrrev_b32 v6, 16, v6
    v_mul_u32_u24 v7, 20, v6
    v_sub_u32_e64 v7, v5, v7
    v_mul_u32_u24 v16, 336, v6
    ds_read_b64_tr_b16 a[98:99], v39 offset:14336
    v_mfma_f32_16x16x32_bf16 a[156:159], a[88:91], a[44:47], a[156:159]
    v_lshl_add_u32 v16, v7, 4, v16
    v_add_u32_e64 v16, s85, v16
    v_mul_u32_u24 v24, 1280, v6
    v_lshl_add_u32 v24, v7, 3, v24
    ds_read_b64_tr_b16 a[100:101], v40 offset:12288
    v_mfma_f32_16x16x32_bf16 a[176:179], a[92:95], a[44:47], a[176:179]
    v_add_u32_e64 v5, 64, v1
    v_mul_u32_u24 v6, 3277, v5
    v_lshrrev_b32 v6, 16, v6
    v_mul_u32_u24 v7, 20, v6
    ds_read_b64_tr_b16 a[102:103], v40 offset:14336
    buffer_load_dwordx4 a[24:27], v37, s[36:39], s5 offen offset:1024 sc1
    v_mfma_f32_16x16x32_bf16 a[120:123], a[80:83], a[48:51], a[120:123]
    v_sub_u32_e64 v7, v5, v7
    v_mul_u32_u24 v17, 336, v6
    v_lshl_add_u32 v17, v7, 4, v17
    v_add_u32_e64 v17, s85, v17
    ds_read_b64_tr_b16 a[104:105], v41 offset:12288
    v_mfma_f32_16x16x32_bf16 a[140:143], a[84:87], a[48:51], a[140:143]
    v_mul_u32_u24 v25, 1280, v6
    v_lshl_add_u32 v25, v7, 3, v25
    v_add_u32 v5, 128, v1
    v_mul_u32_u24 v6, 3277, v5
    ds_read_b64_tr_b16 a[106:107], v41 offset:14336
    v_mfma_f32_16x16x32_bf16 a[160:163], a[88:91], a[48:51], a[160:163]
    v_lshrrev_b32 v6, 16, v6
    v_mul_u32_u24 v7, 20, v6
    v_sub_u32_e64 v7, v5, v7
    v_mul_u32_u24 v18, 336, v6
    ds_read_b64_tr_b16 a[108:109], v42 offset:12288
    v_mfma_f32_16x16x32_bf16 a[180:183], a[92:95], a[48:51], a[180:183]
    v_lshl_add_u32 v18, v7, 4, v18
    v_add_u32_e64 v18, s85, v18
    v_mul_u32_u24 v26, 1280, v6
    v_lshl_add_u32 v26, v7, 3, v26
    ds_read_b64_tr_b16 a[110:111], v42 offset:14336
    buffer_load_dwordx4 a[28:31], v37, s[36:39], s5 offen offset:2048 sc1
    v_mfma_f32_16x16x32_bf16 a[124:127], a[80:83], a[52:55], a[124:127]
    v_add_u32 v5, 192, v1
    v_mul_u32_u24 v6, 3277, v5
    v_lshrrev_b32 v6, 16, v6
    v_mul_u32_u24_e64 v7, 20, v6
    s_add_u32 s4, s4, s11
    s_cmp_eq_u32 s4, s8
    s_cselect_b32 s4, s7, s4
    v_mfma_f32_16x16x32_bf16 a[144:147], a[84:87], a[52:55], a[144:147]
    v_sub_u32_e64 v7, v5, v7
    v_mul_u32_u24 v19, 336, v6
    v_lshl_add_u32 v19, v7, 4, v19
    v_add_u32_e64 v19, s85, v19
    v_mfma_f32_16x16x32_bf16 a[164:167], a[88:91], a[52:55], a[164:167]
    v_mul_u32_u24 v27, 1280, v6
    v_lshl_add_u32 v27, v7, 3, v27
    v_add_u32 v5, 256, v1
    v_mul_u32_u24 v6, 3277, v5
    v_mfma_f32_16x16x32_bf16 a[184:187], a[92:95], a[52:55], a[184:187]
    v_lshrrev_b32 v6, 16, v6
    v_mul_u32_u24 v7, 20, v6
    v_sub_u32_e64 v7, v5, v7
    v_mul_u32_u24 v20, 336, v6
    buffer_load_dwordx4 a[32:35], v37, s[36:39], s5 offen offset:3072 sc1
    v_mfma_f32_16x16x32_bf16 a[128:131], a[80:83], a[56:59], a[128:131]
    v_lshl_add_u32 v20, v7, 4, v20
    v_add_u32_e64 v20, s85, v20
    v_mul_u32_u24 v28, 1280, v6
    v_lshl_add_u32 v28, v7, 3, v28
    v_mfma_f32_16x16x32_bf16 a[148:151], a[84:87], a[56:59], a[148:151]
    s_mul_i32 s85, s68, 21504
    s_add_u32 s85, s85, 65536
    v_add_u32 v250, s85, v37
    s_sub_u32 s85, s85, s6
    v_mfma_f32_16x16x32_bf16 a[168:171], a[88:91], a[56:59], a[168:171]
    v_add_u32 v246, s85, v39
    v_add_u32 v247, s85, v40
    v_add_u32 v248, s85, v41
    v_add_u32 v249, s85, v42
    v_mfma_f32_16x16x32_bf16 a[188:191], a[92:95], a[56:59], a[188:191]
    buffer_load_dwordx4 a[36:39], v38, s[36:39], s5 offen offset:0 sc1
    s_add_u32 s5, s5, 40960
    s_cmp_eq_u32 s5, s10
    s_cselect_b32 s5, s9, s5
    s_waitcnt vmcnt(14) lgkmcnt(0)
    s_add_u32 m0, s6, 8192
    v_mfma_f32_16x16x32_bf16 a[112:115], a[96:99], a[60:63], a[112:115]
    v_sub_f32 v8, 1.0, v8
    buffer_load_dwordx4 v33, s[12:15], s4 offen offset:0 lds
    v_mfma_f32_16x16x32_bf16 a[132:135], a[100:103], a[60:63], a[132:135]
    v_sub_f32_e64 v9, 1.0, v9
    buffer_load_dwordx4 v34, s[12:15], s4 offen offset:1024 lds
    v_mfma_f32_16x16x32_bf16 a[152:155], a[104:107], a[60:63], a[152:155]
    v_sub_f32_e64 v10, 1.0, v10
    buffer_load_dwordx4 v35, s[12:15], s4 offen offset:2048 lds
    v_mfma_f32_16x16x32_bf16 a[172:175], a[108:111], a[60:63], a[172:175]
    v_sub_f32_e64 v11, 1.0, v11
    buffer_load_dwordx4 v36, s[12:15], s4 offen offset:3072 lds
    buffer_load_dwordx4 a[40:43], v37, s[36:39], s5 offen offset:0 sc1
    v_mfma_f32_16x16x32_bf16 a[116:119], a[96:99], a[64:67], a[116:119]
    ds_read_b64_tr_b16 a[80:81], v39 offset:0
    v_mfma_f32_16x16x32_bf16 a[136:139], a[100:103], a[64:67], a[136:139]
    ds_read_b64_tr_b16 a[82:83], v39 offset:2048
    v_mfma_f32_16x16x32_bf16 a[156:159], a[104:107], a[64:67], a[156:159]
    ds_read_b64_tr_b16 a[84:85], v40 offset:0
    v_mfma_f32_16x16x32_bf16 a[176:179], a[108:111], a[64:67], a[176:179]
    ds_read_b64_tr_b16 a[86:87], v40 offset:2048
    buffer_load_dwordx4 a[44:47], v37, s[36:39], s5 offen offset:1024 sc1
    v_mfma_f32_16x16x32_bf16 a[120:123], a[96:99], a[68:71], a[120:123]
    ds_read_b64_tr_b16 a[88:89], v41 offset:0
    v_mfma_f32_16x16x32_bf16 a[140:143], a[100:103], a[68:71], a[140:143]
    ds_read_b64_tr_b16 a[90:91], v41 offset:2048
    v_mfma_f32_16x16x32_bf16 a[160:163], a[104:107], a[68:71], a[160:163]
    ds_read_b64_tr_b16 a[92:93], v42 offset:0
    v_mfma_f32_16x16x32_bf16 a[180:183], a[108:111], a[68:71], a[180:183]
    ds_read_b64_tr_b16 a[94:95], v42 offset:2048
    buffer_load_dwordx4 a[48:51], v37, s[36:39], s5 offen offset:2048 sc1
    v_mfma_f32_16x16x32_bf16 a[124:127], a[96:99], a[72:75], a[124:127]
    s_add_u32 s4, s4, s11
    s_cmp_eq_u32 s4, s8
    s_cselect_b32 s4, s7, s4
    s_nop 0
    v_mfma_f32_16x16x32_bf16 a[144:147], a[100:103], a[72:75], a[144:147]
    v_mfma_f32_16x16x32_bf16 a[164:167], a[104:107], a[72:75], a[164:167]
    v_mfma_f32_16x16x32_bf16 a[184:187], a[108:111], a[72:75], a[184:187]
    buffer_load_dwordx4 a[52:55], v37, s[36:39], s5 offen offset:3072 sc1
    v_mfma_f32_16x16x32_bf16 a[128:131], a[96:99], a[76:79], a[128:131]
    v_mfma_f32_16x16x32_bf16 a[148:151], a[100:103], a[76:79], a[148:151]
    v_mfma_f32_16x16x32_bf16 a[168:171], a[104:107], a[76:79], a[168:171]
    v_mfma_f32_16x16x32_bf16 a[188:191], a[108:111], a[76:79], a[188:191]
    buffer_load_dwordx4 a[56:59], v38, s[36:39], s5 offen offset:0 sc1
    s_add_u32 s5, s5, 40960
    s_cmp_eq_u32 s5, s10
    s_cselect_b32 s5, s9, s5
    s_mov_b32 s75, 2
.p2align 3
g1_loop:
    s_waitcnt vmcnt(14) lgkmcnt(0)
    s_nop 0
    s_add_u32 m0, s6, 12288
    v_mfma_f32_16x16x32_bf16 a[112:115], a[80:83], a[0:3], a[112:115]
    buffer_load_dwordx4 v33, s[12:15], s4 offen offset:0 lds
    v_mfma_f32_16x16x32_bf16 a[132:135], a[84:87], a[0:3], a[132:135]
    buffer_load_dwordx4 v34, s[12:15], s4 offen offset:1024 lds
    v_mfma_f32_16x16x32_bf16 a[152:155], a[88:91], a[0:3], a[152:155]
    buffer_load_dwordx4 v35, s[12:15], s4 offen offset:2048 lds
    v_mfma_f32_16x16x32_bf16 a[172:175], a[92:95], a[0:3], a[172:175]
    buffer_load_dwordx4 v36, s[12:15], s4 offen offset:3072 lds
    buffer_load_dwordx4 a[60:63], v37, s[36:39], s5 offen offset:0 sc1
    v_mfma_f32_16x16x32_bf16 a[116:119], a[80:83], a[4:7], a[116:119]
    ds_read_b64_tr_b16 a[96:97], v39 offset:4096
    v_mfma_f32_16x16x32_bf16 a[136:139], a[84:87], a[4:7], a[136:139]
    ds_read_b64_tr_b16 a[98:99], v39 offset:6144
    v_mfma_f32_16x16x32_bf16 a[156:159], a[88:91], a[4:7], a[156:159]
    ds_read_b64_tr_b16 a[100:101], v40 offset:4096
    v_mfma_f32_16x16x32_bf16 a[176:179], a[92:95], a[4:7], a[176:179]
    ds_read_b64_tr_b16 a[102:103], v40 offset:6144
    buffer_load_dwordx4 a[64:67], v37, s[36:39], s5 offen offset:1024 sc1
    v_mfma_f32_16x16x32_bf16 a[120:123], a[80:83], a[8:11], a[120:123]
    ds_read_b64_tr_b16 a[104:105], v41 offset:4096
    v_mfma_f32_16x16x32_bf16 a[140:143], a[84:87], a[8:11], a[140:143]
    ds_read_b64_tr_b16 a[106:107], v41 offset:6144
    v_mfma_f32_16x16x32_bf16 a[160:163], a[88:91], a[8:11], a[160:163]
    ds_read_b64_tr_b16 a[108:109], v42 offset:4096
    v_mfma_f32_16x16x32_bf16 a[180:183], a[92:95], a[8:11], a[180:183]
    ds_read_b64_tr_b16 a[110:111], v42 offset:6144
    buffer_load_dwordx4 a[68:71], v37, s[36:39], s5 offen offset:2048 sc1
    v_mfma_f32_16x16x32_bf16 a[124:127], a[80:83], a[12:15], a[124:127]
    s_add_u32 s4, s4, s11
    s_cmp_eq_u32 s4, s8
    s_cselect_b32 s4, s7, s4
    s_nop 0
    v_mfma_f32_16x16x32_bf16 a[144:147], a[84:87], a[12:15], a[144:147]
    v_mfma_f32_16x16x32_bf16 a[164:167], a[88:91], a[12:15], a[164:167]
    v_mfma_f32_16x16x32_bf16 a[184:187], a[92:95], a[12:15], a[184:187]
    buffer_load_dwordx4 a[72:75], v37, s[36:39], s5 offen offset:3072 sc1
    v_mfma_f32_16x16x32_bf16 a[128:131], a[80:83], a[16:19], a[128:131]
    v_mfma_f32_16x16x32_bf16 a[148:151], a[84:87], a[16:19], a[148:151]
    v_mfma_f32_16x16x32_bf16 a[168:171], a[88:91], a[16:19], a[168:171]
    v_mfma_f32_16x16x32_bf16 a[188:191], a[92:95], a[16:19], a[188:191]
    buffer_load_dwordx4 a[76:79], v38, s[36:39], s5 offen offset:0 sc1
    s_add_u32 s5, s5, 40960
    s_cmp_eq_u32 s5, s10
    s_cselect_b32 s5, s9, s5
    s_waitcnt vmcnt(14) lgkmcnt(0)
    s_add_u32 m0, s6, 0
    v_mfma_f32_16x16x32_bf16 a[112:115], a[96:99], a[20:23], a[112:115]
    buffer_load_dwordx4 v33, s[12:15], s4 offen offset:0 lds
    v_mfma_f32_16x16x32_bf16 a[132:135], a[100:103], a[20:23], a[132:135]
    buffer_load_dwordx4 v34, s[12:15], s4 offen offset:1024 lds
    v_mfma_f32_16x16x32_bf16 a[152:155], a[104:107], a[20:23], a[152:155]
    buffer_load_dwordx4 v35, s[12:15], s4 offen offset:2048 lds
    v_mfma_f32_16x16x32_bf16 a[172:175], a[108:111], a[20:23], a[172:175]
    buffer_load_dwordx4 v36, s[12:15], s4 offen offset:3072 lds
    buffer_load_dwordx4 a[0:3], v37, s[36:39], s5 offen offset:0 sc1
    v_mfma_f32_16x16x32_bf16 a[116:119], a[96:99], a[24:27], a[116:119]
    ds_read_b64_tr_b16 a[80:81], v39 offset:8192
    v_mfma_f32_16x16x32_bf16 a[136:139], a[100:103], a[24:27], a[136:139]
    ds_read_b64_tr_b16 a[82:83], v39 offset:10240
    v_mfma_f32_16x16x32_bf16 a[156:159], a[104:107], a[24:27], a[156:159]
    ds_read_b64_tr_b16 a[84:85], v40 offset:8192
    v_mfma_f32_16x16x32_bf16 a[176:179], a[108:111], a[24:27], a[176:179]
    ds_read_b64_tr_b16 a[86:87], v40 offset:10240
    buffer_load_dwordx4 a[4:7], v37, s[36:39], s5 offen offset:1024 sc1
    v_mfma_f32_16x16x32_bf16 a[120:123], a[96:99], a[28:31], a[120:123]
    ds_read_b64_tr_b16 a[88:89], v41 offset:8192
    v_mfma_f32_16x16x32_bf16 a[140:143], a[100:103], a[28:31], a[140:143]
    ds_read_b64_tr_b16 a[90:91], v41 offset:10240
    v_mfma_f32_16x16x32_bf16 a[160:163], a[104:107], a[28:31], a[160:163]
    ds_read_b64_tr_b16 a[92:93], v42 offset:8192
    v_mfma_f32_16x16x32_bf16 a[180:183], a[108:111], a[28:31], a[180:183]
    ds_read_b64_tr_b16 a[94:95], v42 offset:10240
    buffer_load_dwordx4 a[8:11], v37, s[36:39], s5 offen offset:2048 sc1
    v_mfma_f32_16x16x32_bf16 a[124:127], a[96:99], a[32:35], a[124:127]
    s_add_u32 s4, s4, s11
    s_cmp_eq_u32 s4, s8
    s_cselect_b32 s4, s7, s4
    s_nop 0
    v_mfma_f32_16x16x32_bf16 a[144:147], a[100:103], a[32:35], a[144:147]
    v_mfma_f32_16x16x32_bf16 a[164:167], a[104:107], a[32:35], a[164:167]
    v_mfma_f32_16x16x32_bf16 a[184:187], a[108:111], a[32:35], a[184:187]
    buffer_load_dwordx4 a[12:15], v37, s[36:39], s5 offen offset:3072 sc1
    v_mfma_f32_16x16x32_bf16 a[128:131], a[96:99], a[36:39], a[128:131]
    v_mfma_f32_16x16x32_bf16 a[148:151], a[100:103], a[36:39], a[148:151]
    v_mfma_f32_16x16x32_bf16 a[168:171], a[104:107], a[36:39], a[168:171]
    v_mfma_f32_16x16x32_bf16 a[188:191], a[108:111], a[36:39], a[188:191]
    buffer_load_dwordx4 a[16:19], v38, s[36:39], s5 offen offset:0 sc1
    s_add_u32 s5, s5, 40960
    s_cmp_eq_u32 s5, s10
    s_cselect_b32 s5, s9, s5
    s_waitcnt vmcnt(14) lgkmcnt(0)
    s_nop 0
    s_add_u32 m0, s6, 4096
    v_mfma_f32_16x16x32_bf16 a[112:115], a[80:83], a[40:43], a[112:115]
    buffer_load_dwordx4 v33, s[12:15], s4 offen offset:0 lds
    v_mfma_f32_16x16x32_bf16 a[132:135], a[84:87], a[40:43], a[132:135]
    buffer_load_dwordx4 v34, s[12:15], s4 offen offset:1024 lds
    v_mfma_f32_16x16x32_bf16 a[152:155], a[88:91], a[40:43], a[152:155]
    buffer_load_dwordx4 v35, s[12:15], s4 offen offset:2048 lds
    v_mfma_f32_16x16x32_bf16 a[172:175], a[92:95], a[40:43], a[172:175]
    buffer_load_dwordx4 v36, s[12:15], s4 offen offset:3072 lds
    buffer_load_dwordx4 a[20:23], v37, s[36:39], s5 offen offset:0 sc1
    v_mfma_f32_16x16x32_bf16 a[116:119], a[80:83], a[44:47], a[116:119]
    ds_read_b64_tr_b16 a[96:97], v39 offset:12288
    v_mfma_f32_16x16x32_bf16 a[136:139], a[84:87], a[44:47], a[136:139]
    ds_read_b64_tr_b16 a[98:99], v39 offset:14336
    v_mfma_f32_16x16x32_bf16 a[156:159], a[88:91], a[44:47], a[156:159]
    ds_read_b64_tr_b16 a[100:101], v40 offset:12288
    v_mfma_f32_16x16x32_bf16 a[176:179], a[92:95], a[44:47], a[176:179]
    ds_read_b64_tr_b16 a[102:103], v40 offset:14336
    buffer_load_dwordx4 a[24:27], v37, s[36:39], s5 offen offset:1024 sc1
    v_mfma_f32_16x16x32_bf16 a[120:123], a[80:83], a[48:51], a[120:123]
    ds_read_b64_tr_b16 a[104:105], v41 offset:12288
    v_mfma_f32_16x16x32_bf16 a[140:143], a[84:87], a[48:51], a[140:143]
    ds_read_b64_tr_b16 a[106:107], v41 offset:14336
    v_mfma_f32_16x16x32_bf16 a[160:163], a[88:91], a[48:51], a[160:163]
    ds_read_b64_tr_b16 a[108:109], v42 offset:12288
    v_mfma_f32_16x16x32_bf16 a[180:183], a[92:95], a[48:51], a[180:183]
    ds_read_b64_tr_b16 a[110:111], v42 offset:14336
    buffer_load_dwordx4 a[28:31], v37, s[36:39], s5 offen offset:2048 sc1
    v_mfma_f32_16x16x32_bf16 a[124:127], a[80:83], a[52:55], a[124:127]
    s_add_u32 s4, s4, s11
    s_cmp_eq_u32 s4, s8
    s_cselect_b32 s4, s7, s4
    s_nop 0
    v_mfma_f32_16x16x32_bf16 a[144:147], a[84:87], a[52:55], a[144:147]
    v_mfma_f32_16x16x32_bf16 a[164:167], a[88:91], a[52:55], a[164:167]
    v_mfma_f32_16x16x32_bf16 a[184:187], a[92:95], a[52:55], a[184:187]
    buffer_load_dwordx4 a[32:35], v37, s[36:39], s5 offen offset:3072 sc1
    v_mfma_f32_16x16x32_bf16 a[128:131], a[80:83], a[56:59], a[128:131]
    v_mfma_f32_16x16x32_bf16 a[148:151], a[84:87], a[56:59], a[148:151]
    v_mfma_f32_16x16x32_bf16 a[168:171], a[88:91], a[56:59], a[168:171]
    v_mfma_f32_16x16x32_bf16 a[188:191], a[92:95], a[56:59], a[188:191]
    buffer_load_dwordx4 a[36:39], v38, s[36:39], s5 offen offset:0 sc1
    s_add_u32 s5, s5, 40960
    s_cmp_eq_u32 s5, s10
    s_cselect_b32 s5, s9, s5
    s_waitcnt vmcnt(14) lgkmcnt(0)
    s_nop 0
    s_add_u32 m0, s6, 8192
    v_mfma_f32_16x16x32_bf16 a[112:115], a[96:99], a[60:63], a[112:115]
    buffer_load_dwordx4 v33, s[12:15], s4 offen offset:0 lds
    v_mfma_f32_16x16x32_bf16 a[132:135], a[100:103], a[60:63], a[132:135]
    buffer_load_dwordx4 v34, s[12:15], s4 offen offset:1024 lds
    v_mfma_f32_16x16x32_bf16 a[152:155], a[104:107], a[60:63], a[152:155]
    buffer_load_dwordx4 v35, s[12:15], s4 offen offset:2048 lds
    v_mfma_f32_16x16x32_bf16 a[172:175], a[108:111], a[60:63], a[172:175]
    buffer_load_dwordx4 v36, s[12:15], s4 offen offset:3072 lds
    buffer_load_dwordx4 a[40:43], v37, s[36:39], s5 offen offset:0 sc1
    v_mfma_f32_16x16x32_bf16 a[116:119], a[96:99], a[64:67], a[116:119]
    ds_read_b64_tr_b16 a[80:81], v39 offset:0
    v_mfma_f32_16x16x32_bf16 a[136:139], a[100:103], a[64:67], a[136:139]
    ds_read_b64_tr_b16 a[82:83], v39 offset:2048
    v_mfma_f32_16x16x32_bf16 a[156:159], a[104:107], a[64:67], a[156:159]
    ds_read_b64_tr_b16 a[84:85], v40 offset:0
    v_mfma_f32_16x16x32_bf16 a[176:179], a[108:111], a[64:67], a[176:179]
    ds_read_b64_tr_b16 a[86:87], v40 offset:2048
    buffer_load_dwordx4 a[44:47], v37, s[36:39], s5 offen offset:1024 sc1
    v_mfma_f32_16x16x32_bf16 a[120:123], a[96:99], a[68:71], a[120:123]
    ds_read_b64_tr_b16 a[88:89], v41 offset:0
    v_mfma_f32_16x16x32_bf16 a[140:143], a[100:103], a[68:71], a[140:143]
    ds_read_b64_tr_b16 a[90:91], v41 offset:2048
    v_mfma_f32_16x16x32_bf16 a[160:163], a[104:107], a[68:71], a[160:163]
    ds_read_b64_tr_b16 a[92:93], v42 offset:0
    v_mfma_f32_16x16x32_bf16 a[180:183], a[108:111], a[68:71], a[180:183]
    ds_read_b64_tr_b16 a[94:95], v42 offset:2048
    buffer_load_dwordx4 a[48:51], v37, s[36:39], s5 offen offset:2048 sc1
    v_mfma_f32_16x16x32_bf16 a[124:127], a[96:99], a[72:75], a[124:127]
    s_add_u32 s4, s4, s11
    s_cmp_eq_u32 s4, s8
    s_cselect_b32 s4, s7, s4
    s_nop 0
    v_mfma_f32_16x16x32_bf16 a[144:147], a[100:103], a[72:75], a[144:147]
    v_mfma_f32_16x16x32_bf16 a[164:167], a[104:107], a[72:75], a[164:167]
    v_mfma_f32_16x16x32_bf16 a[184:187], a[108:111], a[72:75], a[184:187]
    buffer_load_dwordx4 a[52:55], v37, s[36:39], s5 offen offset:3072 sc1
    v_mfma_f32_16x16x32_bf16 a[128:131], a[96:99], a[76:79], a[128:131]
    v_mfma_f32_16x16x32_bf16 a[148:151], a[100:103], a[76:79], a[148:151]
    v_mfma_f32_16x16x32_bf16 a[168:171], a[104:107], a[76:79], a[168:171]
    v_mfma_f32_16x16x32_bf16 a[188:191], a[108:111], a[76:79], a[188:191]
    buffer_load_dwordx4 a[56:59], v38, s[36:39], s5 offen offset:0 sc1
    s_add_u32 s5, s5, 40960
    s_cmp_eq_u32 s5, s10
    s_cselect_b32 s5, s9, s5
    s_sub_u32 s75, s75, 1
    s_cmp_lg_u32 s75, 0
    s_cbranch_scc1 g1_loop
    s_waitcnt vmcnt(14) lgkmcnt(0)
    s_add_u32 m0, s6, 12288
    v_mfma_f32_16x16x32_bf16 a[112:115], a[80:83], a[0:3], a[112:115]
    buffer_load_dwordx4 v33, s[12:15], s4 offen offset:0 lds
    v_mfma_f32_16x16x32_bf16 a[132:135], a[84:87], a[0:3], a[132:135]
    buffer_load_dwordx4 v34, s[12:15], s4 offen offset:1024 lds
    v_mfma_f32_16x16x32_bf16 a[152:155], a[88:91], a[0:3], a[152:155]
    buffer_load_dwordx4 v35, s[12:15], s4 offen offset:2048 lds
    v_mfma_f32_16x16x32_bf16 a[172:175], a[92:95], a[0:3], a[172:175]
    buffer_load_dwordx4 v36, s[12:15], s4 offen offset:3072 lds
    buffer_load_dwordx4 a[60:63], v37, s[36:39], s5 offen offset:0 sc1
    v_mfma_f32_16x16x32_bf16 a[116:119], a[80:83], a[4:7], a[116:119]
    ds_read_b64_tr_b16 a[96:97], v39 offset:4096
    v_mfma_f32_16x16x32_bf16 a[136:139], a[84:87], a[4:7], a[136:139]
    ds_read_b64_tr_b16 a[98:99], v39 offset:6144
    v_mfma_f32_16x16x32_bf16 a[156:159], a[88:91], a[4:7], a[156:159]
    ds_read_b64_tr_b16 a[100:101], v40 offset:4096
    v_mfma_f32_16x16x32_bf16 a[176:179], a[92:95], a[4:7], a[176:179]
    ds_read_b64_tr_b16 a[102:103], v40 offset:6144
    buffer_load_dwordx4 a[64:67], v37, s[36:39], s5 offen offset:1024 sc1
    v_mfma_f32_16x16x32_bf16 a[120:123], a[80:83], a[8:11], a[120:123]
    ds_read_b64_tr_b16 a[104:105], v41 offset:4096
    v_mfma_f32_16x16x32_bf16 a[140:143], a[84:87], a[8:11], a[140:143]
    ds_read_b64_tr_b16 a[106:107], v41 offset:6144
    v_mfma_f32_16x16x32_bf16 a[160:163], a[88:91], a[8:11], a[160:163]
    ds_read_b64_tr_b16 a[108:109], v42 offset:4096
    v_mfma_f32_16x16x32_bf16 a[180:183], a[92:95], a[8:11], a[180:183]
    ds_read_b64_tr_b16 a[110:111], v42 offset:6144
    buffer_load_dwordx4 a[68:71], v37, s[36:39], s5 offen offset:2048 sc1
    v_mfma_f32_16x16x32_bf16 a[124:127], a[80:83], a[12:15], a[124:127]
    s_add_u32 s4, s4, s11
    s_cmp_eq_u32 s4, s8
    s_cselect_b32 s4, s7, s4
    s_nop 0
    v_mfma_f32_16x16x32_bf16 a[144:147], a[84:87], a[12:15], a[144:147]
    v_mfma_f32_16x16x32_bf16 a[164:167], a[88:91], a[12:15], a[164:167]
    v_mfma_f32_16x16x32_bf16 a[184:187], a[92:95], a[12:15], a[184:187]
    buffer_load_dwordx4 a[72:75], v37, s[36:39], s5 offen offset:3072 sc1
    v_mfma_f32_16x16x32_bf16 a[128:131], a[80:83], a[16:19], a[128:131]
    v_mfma_f32_16x16x32_bf16 a[148:151], a[84:87], a[16:19], a[148:151]
    v_mfma_f32_16x16x32_bf16 a[168:171], a[88:91], a[16:19], a[168:171]
    v_mfma_f32_16x16x32_bf16 a[188:191], a[92:95], a[16:19], a[188:191]
    buffer_load_dwordx4 a[76:79], v38, s[36:39], s5 offen offset:0 sc1
    s_add_u32 s5, s5, 40960
    s_cmp_eq_u32 s5, s10
    s_cselect_b32 s5, s9, s5
    s_mov_b64 s[12:13], s[44:45]
    s_mov_b64 s[14:15], s[46:47]
    v_mov_b32 v33, v43
    v_mov_b32 v34, v44
    v_mov_b32 v35, v45
    v_mov_b32_e64 v36, v46
    s_mov_b32 s4, s17
    s_mov_b32 s7, s18
    s_mov_b32 s8, s19
    s_mov_b32 s11, 131072
    s_waitcnt vmcnt(14) lgkmcnt(0)
    s_add_u32 m0, s6, 0
    v_mfma_f32_16x16x32_bf16 a[112:115], a[96:99], a[20:23], a[112:115]
    buffer_load_dwordx4 v33, s[12:15], s4 offen offset:0 lds
    v_mfma_f32_16x16x32_bf16 a[132:135], a[100:103], a[20:23], a[132:135]
    buffer_load_dwordx4 v34, s[12:15], s4 offen offset:1024 lds
    v_mfma_f32_16x16x32_bf16 a[152:155], a[104:107], a[20:23], a[152:155]
    buffer_load_dwordx4 v35, s[12:15], s4 offen offset:2048 lds
    v_mfma_f32_16x16x32_bf16 a[172:175], a[108:111], a[20:23], a[172:175]
    buffer_load_dwordx4 v36, s[12:15], s4 offen offset:3072 lds
    v_mfma_f32_16x16x32_bf16 a[116:119], a[96:99], a[24:27], a[116:119]
    ds_read_b64_tr_b16 a[80:81], v39 offset:8192
    v_mfma_f32_16x16x32_bf16 a[136:139], a[100:103], a[24:27], a[136:139]
    ds_read_b64_tr_b16 a[82:83], v39 offset:10240
    v_mfma_f32_16x16x32_bf16 a[156:159], a[104:107], a[24:27], a[156:159]
    ds_read_b64_tr_b16 a[84:85], v40 offset:8192
    v_mfma_f32_16x16x32_bf16 a[176:179], a[108:111], a[24:27], a[176:179]
    ds_read_b64_tr_b16 a[86:87], v40 offset:10240
    v_mfma_f32_16x16x32_bf16 a[120:123], a[96:99], a[28:31], a[120:123]
    ds_read_b64_tr_b16 a[88:89], v41 offset:8192
    v_mfma_f32_16x16x32_bf16 a[140:143], a[100:103], a[28:31], a[140:143]
    ds_read_b64_tr_b16 a[90:91], v41 offset:10240
    v_mfma_f32_16x16x32_bf16 a[160:163], a[104:107], a[28:31], a[160:163]
    ds_read_b64_tr_b16 a[92:93], v42 offset:8192
    v_mfma_f32_16x16x32_bf16 a[180:183], a[108:111], a[28:31], a[180:183]
    ds_read_b64_tr_b16 a[94:95], v42 offset:10240
    v_mfma_f32_16x16x32_bf16 a[124:127], a[96:99], a[32:35], a[124:127]
    s_add_u32 s4, s4, s11
    s_cmp_eq_u32 s4, s8
    s_cselect_b32 s4, s7, s4
    s_nop 0
    v_mfma_f32_16x16x32_bf16 a[144:147], a[100:103], a[32:35], a[144:147]
    v_mfma_f32_16x16x32_bf16 a[164:167], a[104:107], a[32:35], a[164:167]
    v_mfma_f32_16x16x32_bf16 a[184:187], a[108:111], a[32:35], a[184:187]
    v_mfma_f32_16x16x32_bf16 a[128:131], a[96:99], a[36:39], a[128:131]
    v_mfma_f32_16x16x32_bf16 a[148:151], a[100:103], a[36:39], a[148:151]
    v_mfma_f32_16x16x32_bf16 a[168:171], a[104:107], a[36:39], a[168:171]
    v_mfma_f32_16x16x32_bf16 a[188:191], a[108:111], a[36:39], a[188:191]
    s_waitcnt vmcnt(9) lgkmcnt(0)
    s_nop 0
    s_add_u32 m0, s6, 4096
    v_mfma_f32_16x16x32_bf16 a[112:115], a[80:83], a[40:43], a[112:115]
    buffer_load_dwordx4 v33, s[12:15], s4 offen offset:0 lds
    v_mfma_f32_16x16x32_bf16 a[132:135], a[84:87], a[40:43], a[132:135]
    buffer_load_dwordx4 v34, s[12:15], s4 offen offset:1024 lds
    v_mfma_f32_16x16x32_bf16 a[152:155], a[88:91], a[40:43], a[152:155]
    buffer_load_dwordx4 v35, s[12:15], s4 offen offset:2048 lds
    v_mfma_f32_16x16x32_bf16 a[172:175], a[92:95], a[40:43], a[172:175]
    buffer_load_dwordx4 v36, s[12:15], s4 offen offset:3072 lds
    v_mfma_f32_16x16x32_bf16 a[116:119], a[80:83], a[44:47], a[116:119]
    ds_read_b64_tr_b16 a[96:97], v39 offset:12288
    v_mfma_f32_16x16x32_bf16 a[136:139], a[84:87], a[44:47], a[136:139]
    ds_read_b64_tr_b16 a[98:99], v39 offset:14336
    v_mfma_f32_16x16x32_bf16 a[156:159], a[88:91], a[44:47], a[156:159]
    ds_read_b64_tr_b16 a[100:101], v40 offset:12288
    v_mfma_f32_16x16x32_bf16 a[176:179], a[92:95], a[44:47], a[176:179]
    ds_read_b64_tr_b16 a[102:103], v40 offset:14336
    v_mfma_f32_16x16x32_bf16 a[120:123], a[80:83], a[48:51], a[120:123]
    ds_read_b64_tr_b16 a[104:105], v41 offset:12288
    v_mfma_f32_16x16x32_bf16 a[140:143], a[84:87], a[48:51], a[140:143]
    ds_read_b64_tr_b16 a[106:107], v41 offset:14336
    v_mfma_f32_16x16x32_bf16 a[160:163], a[88:91], a[48:51], a[160:163]
    ds_read_b64_tr_b16 a[108:109], v42 offset:12288
    v_mfma_f32_16x16x32_bf16 a[180:183], a[92:95], a[48:51], a[180:183]
    ds_read_b64_tr_b16 a[110:111], v42 offset:14336
    v_mfma_f32_16x16x32_bf16 a[124:127], a[80:83], a[52:55], a[124:127]
    s_add_u32 s4, s4, s11
    s_cmp_eq_u32 s4, s8
    s_cselect_b32 s4, s7, s4
    s_nop 0
    v_mfma_f32_16x16x32_bf16 a[144:147], a[84:87], a[52:55], a[144:147]
    v_mfma_f32_16x16x32_bf16 a[164:167], a[88:91], a[52:55], a[164:167]
    v_mfma_f32_16x16x32_bf16 a[184:187], a[92:95], a[52:55], a[184:187]
    v_mfma_f32_16x16x32_bf16 a[128:131], a[80:83], a[56:59], a[128:131]
    v_mfma_f32_16x16x32_bf16 a[148:151], a[84:87], a[56:59], a[148:151]
    v_mfma_f32_16x16x32_bf16 a[168:171], a[88:91], a[56:59], a[168:171]
    v_mfma_f32_16x16x32_bf16 a[188:191], a[92:95], a[56:59], a[188:191]
    s_waitcnt vmcnt(8) lgkmcnt(0)
    s_nop 0
    s_add_u32 m0, s6, 8192
    v_mfma_f32_16x16x32_bf16 a[112:115], a[96:99], a[60:63], a[112:115]
    buffer_load_dwordx4 v33, s[12:15], s4 offen offset:0 lds
    v_mfma_f32_16x16x32_bf16 a[132:135], a[100:103], a[60:63], a[132:135]
    buffer_load_dwordx4 v34, s[12:15], s4 offen offset:1024 lds
    v_mfma_f32_16x16x32_bf16 a[152:155], a[104:107], a[60:63], a[152:155]
    buffer_load_dwordx4 v35, s[12:15], s4 offen offset:2048 lds
    v_mfma_f32_16x16x32_bf16 a[172:175], a[108:111], a[60:63], a[172:175]
    buffer_load_dwordx4 v36, s[12:15], s4 offen offset:3072 lds
    v_mfma_f32_16x16x32_bf16 a[116:119], a[96:99], a[64:67], a[116:119]
    v_mfma_f32_16x16x32_bf16 a[136:139], a[100:103], a[64:67], a[136:139]
    s_add_u32 s4, s4, s11
    s_cmp_eq_u32 s4, s8
    s_cselect_b32 s4, s7, s4
    s_nop 0
    v_mfma_f32_16x16x32_bf16 a[156:159], a[104:107], a[64:67], a[156:159]
    v_mfma_f32_16x16x32_bf16 a[176:179], a[108:111], a[64:67], a[176:179]
    v_mfma_f32_16x16x32_bf16 a[120:123], a[96:99], a[68:71], a[120:123]
    ds_write_b128 v224, a[112:115] offset:0
    v_mfma_f32_16x16x32_bf16 a[140:143], a[100:103], a[68:71], a[140:143]
    ds_write_b128 v225, a[132:135] offset:0
    v_mfma_f32_16x16x32_bf16 a[160:163], a[104:107], a[68:71], a[160:163]
    ds_write_b128 v226, a[152:155] offset:0
    v_mfma_f32_16x16x32_bf16 a[180:183], a[108:111], a[68:71], a[180:183]
    ds_write_b128 v227, a[172:175] offset:0
    v_mfma_f32_16x16x32_bf16 a[124:127], a[96:99], a[72:75], a[124:127]
    ds_write_b128 v224, a[116:119] offset:4096
    v_mfma_f32_16x16x32_bf16 a[144:147], a[100:103], a[72:75], a[144:147]
    ds_write_b128 v225, a[136:139] offset:4096
    v_mfma_f32_16x16x32_bf16 a[164:167], a[104:107], a[72:75], a[164:167]
    ds_write_b128 v226, a[156:159] offset:4096
    v_mfma_f32_16x16x32_bf16 a[184:187], a[108:111], a[72:75], a[184:187]
    ds_write_b128 v227, a[176:179] offset:4096
    v_mfma_f32_16x16x32_bf16 a[128:131], a[96:99], a[76:79], a[128:131]
    ds_write_b128 v224, a[120:123] offset:8192
    v_mfma_f32_16x16x32_bf16 a[148:151], a[100:103], a[76:79], a[148:151]
    ds_write_b128 v225, a[140:143] offset:8192
    v_mfma_f32_16x16x32_bf16 a[168:171], a[104:107], a[76:79], a[168:171]
    ds_write_b128 v226, a[160:163] offset:8192
    v_mfma_f32_16x16x32_bf16 a[188:191], a[108:111], a[76:79], a[188:191]
    ds_write_b128 v227, a[180:183] offset:8192
    s_nop 3
    s_nop 0
    ds_write_b128 v224, a[124:127] offset:12288
    ds_write_b128 v225, a[144:147] offset:12288
    ds_write_b128 v226, a[164:167] offset:12288
    ds_write_b128 v227, a[184:187] offset:12288
    ds_write_b128 v224, a[128:131] offset:16384
    ds_write_b128 v225, a[148:151] offset:16384
    ds_write_b128 v226, a[168:171] offset:16384
    ds_write_b128 v227, a[188:191] offset:16384
    v_lshlrev_b32_e64 v234, 16, v242
    v_and_b32 v235, 0xffff0000, v242
    v_lshlrev_b32_e64 v236, 16, v243
    v_and_b32 v237, 0xffff0000, v243
    v_lshlrev_b32_e64 v238, 16, v244
    v_and_b32 v239, 0xffff0000, v244
    v_lshlrev_b32_e64 v240, 16, v245
    v_and_b32 v241, 0xffff0000, v245
    s_waitcnt lgkmcnt(0)
    s_barrier
    ds_read_b128 v[128:131], v228 offset:0
    ds_read_b128 v[132:135], v228 offset:20480
    ds_read_b128 v[136:139], v230 offset:0
    ds_read_b128 v[140:143], v230 offset:20480
    ds_read_b128 v[144:147], v229 offset:0
    ds_read_b128 v[148:151], v229 offset:20480
    ds_read_b128 v[152:155], v231 offset:0
    ds_read_b128 v[156:159], v231 offset:20480
    s_add_u32 m0, s6, 12288
    s_nop 0
    buffer_load_dwordx4 v33, s[12:15], s4 offen offset:0 lds
    s_waitcnt lgkmcnt(4)
    ds_read_b128 v[160:163], v228 offset:8192
    ds_read_b128 v[164:167], v228 offset:28672
    ds_read_b128 v[168:171], v230 offset:8192
    ds_read_b128 v[172:175], v230 offset:28672
    ds_read_b128 v[176:179], v229 offset:8192
    ds_read_b128 v[180:183], v229 offset:28672
    buffer_load_dwordx4 v34, s[12:15], s4 offen offset:1024 lds
    ds_read_b128 v[184:187], v231 offset:8192
    ds_read_b128 v[188:191], v231 offset:28672
    s_waitcnt lgkmcnt(8)
    s_nop 0
    v_pk_add_f32 v[128:129], v[128:129], v[132:133]
    v_pk_add_f32 v[136:137], v[136:137], v[140:141]
    v_pk_add_f32 v[130:131], v[130:131], v[134:135]
    v_pk_add_f32 v[138:139], v[138:139], v[142:143]
    buffer_load_dwordx4 v35, s[12:15], s4 offen offset:2048 lds
    v_pk_add_f32 v[144:145], v[144:145], v[148:149]
    v_pk_add_f32 v[152:153], v[152:153], v[156:157]
    v_pk_add_f32 v[146:147], v[146:147], v[150:151]
    v_pk_add_f32 v[154:155], v[154:155], v[158:159]
    v_pk_add_f32 v[128:129], v[128:129], v[234:235]
    v_pk_add_f32 v[130:131], v[130:131], v[236:237]
    v_pk_add_f32 v[144:145], v[144:145], v[238:239]
    buffer_load_dwordx4 v36, s[12:15], s4 offen offset:3072 lds
    s_add_u32 s4, s4, s11
    s_cmp_eq_u32 s4, s8
    s_cselect_b32 s4, s7, s4
    s_nop 0
    v_pk_add_f32 v[146:147], v[146:147], v[240:241]
    v_pk_add_f32 v[128:129], v[128:129], v[136:137]
    v_pk_add_f32 v[130:131], v[130:131], v[138:139]
    v_pk_add_f32 v[144:145], v[144:145], v[152:153]
    v_pk_add_f32 v[146:147], v[146:147], v[154:155]
    v_pk_mul_f32 v[132:133], v[128:129], v[128:129]
    v_pk_mul_f32 v[134:135], v[130:131], v[130:131]
    buffer_load_dwordx4 v[48:51], v33, s[12:15], s4 offen offset:0
    v_pk_mul_f32 v[148:149], v[144:145], v[144:145]
    v_pk_mul_f32 v[150:151], v[146:147], v[146:147]
    v_pk_fma_f32 v[132:133], v[132:133], s[90:91], v[232:233]
    v_pk_fma_f32 v[134:135], v[134:135], s[90:91], v[232:233]
    v_pk_fma_f32 v[148:149], v[148:149], s[90:91], v[232:233]
    v_pk_fma_f32 v[150:151], v[150:151], s[90:91], v[232:233]
    v_pk_mul_f32 v[132:133], v[132:133], v[128:129]
    v_pk_mul_f32 v[134:135], v[134:135], v[130:131]
    buffer_load_dwordx4 v[52:55], v34, s[12:15], s4 offen offset:1024
    v_pk_mul_f32 v[148:149], v[148:149], v[144:145]
    v_pk_mul_f32 v[150:151], v[150:151], v[146:147]
    v_exp_f32 v132, v132
    v_exp_f32 v133, v133
    v_exp_f32 v134, v134
    v_exp_f32 v135, v135
    v_exp_f32_e64 v148, v148
    buffer_load_dwordx4 v[56:59], v35, s[12:15], s4 offen offset:2048
    v_exp_f32 v149, v149
    v_exp_f32 v150, v150
    v_exp_f32_e64 v151, v151
    v_pk_add_f32 v[132:133], v[132:133], 1.0 op_sel_hi:[1,0]
    v_pk_add_f32 v[134:135], v[134:135], 1.0 op_sel_hi:[1,0]
    v_pk_add_f32 v[148:149], v[148:149], 1.0 op_sel_hi:[1,0]
    v_pk_add_f32 v[150:151], v[150:151], 1.0 op_sel_hi:[1,0]
    buffer_load_dwordx4 v[60:63], v36, s[12:15], s4 offen offset:3072
    s_add_u32 s4, s4, s11
    s_cmp_eq_u32 s4, s8
    s_cselect_b32 s4, s7, s4
    v_rcp_f32 v132, v132
    v_rcp_f32 v133, v133
    v_rcp_f32 v134, v134
    v_rcp_f32 v135, v135
    v_rcp_f32 v148, v148
    v_rcp_f32 v149, v149
    v_rcp_f32 v150, v150
    buffer_load_dwordx4 v[64:67], v33, s[12:15], s4 offen offset:0
    v_rcp_f32_e64 v151, v151
    v_pk_mul_f32 v[128:129], v[128:129], v[132:133]
    v_pk_mul_f32 v[130:131], v[130:131], v[134:135]
    v_pk_mul_f32 v[144:145], v[144:145], v[148:149]
    v_pk_mul_f32 v[146:147], v[146:147], v[150:151]
    v_cvt_pk_bf16_f32 v136, v128, v129
    v_cvt_pk_bf16_f32 v137, v130, v131
    v_cvt_pk_bf16_f32 v138, v144, v145
    v_cvt_pk_bf16_f32 v139, v146, v147
    buffer_store_dwordx4 v[136:139], v37, s[36:39], s52 offen offset:0 sc1
    s_cmp_ge_u32 s68, 2
    s_cbranch_scc1 g1_e1
    ds_read_b128 v[192:195], v228 offset:16384
    ds_read_b128 v[196:199], v228 offset:36864
    ds_read_b128 v[200:203], v230 offset:16384
    ds_read_b128 v[204:207], v230 offset:36864
    ds_read_b128 v[208:211], v229 offset:16384
    ds_read_b128 v[212:215], v229 offset:36864
    ds_read_b128 v[216:219], v231 offset:16384
    ds_read_b128 v[220:223], v231 offset:36864
    s_waitcnt lgkmcnt(8)
    s_nop 0
    buffer_load_dwordx4 v[68:71], v34, s[12:15], s4 offen offset:1024
    v_pk_add_f32 v[160:161], v[160:161], v[164:165]
    v_pk_add_f32 v[168:169], v[168:169], v[172:173]
    v_pk_add_f32 v[162:163], v[162:163], v[166:167]
    v_pk_add_f32 v[170:171], v[170:171], v[174:175]
    v_pk_add_f32 v[176:177], v[176:177], v[180:181]
    v_pk_add_f32 v[184:185], v[184:185], v[188:189]
    buffer_load_dwordx4 v[72:75], v35, s[12:15], s4 offen offset:2048
    v_pk_add_f32 v[178:179], v[178:179], v[182:183]
    v_pk_add_f32 v[186:187], v[186:187], v[190:191]
    v_pk_add_f32 v[160:161], v[160:161], v[234:235]
    v_pk_add_f32 v[162:163], v[162:163], v[236:237]
    v_pk_add_f32 v[176:177], v[176:177], v[238:239]
    v_pk_add_f32 v[178:179], v[178:179], v[240:241]
    v_pk_add_f32 v[160:161], v[160:161], v[168:169]
    buffer_load_dwordx4 v[76:79], v36, s[12:15], s4 offen offset:3072
    s_add_u32 s4, s4, s11
    s_cmp_eq_u32 s4, s8
    s_cselect_b32 s4, s7, s4
    s_nop 0
    v_pk_add_f32 v[162:163], v[162:163], v[170:171]
    v_pk_add_f32 v[176:177], v[176:177], v[184:185]
    v_pk_add_f32 v[178:179], v[178:179], v[186:187]
    v_pk_mul_f32 v[164:165], v[160:161], v[160:161]
    v_pk_mul_f32 v[166:167], v[162:163], v[162:163]
    v_pk_mul_f32 v[180:181], v[176:177], v[176:177]
    v_pk_mul_f32 v[182:183], v[178:179], v[178:179]
    buffer_load_dwordx4 v[80:83], v33, s[12:15], s4 offen offset:0
    v_pk_fma_f32 v[164:165], v[164:165], s[90:91], v[232:233]
    v_pk_fma_f32 v[166:167], v[166:167], s[90:91], v[232:233]
    v_pk_fma_f32 v[180:181], v[180:181], s[90:91], v[232:233]
    v_pk_fma_f32 v[182:183], v[182:183], s[90:91], v[232:233]
    v_pk_mul_f32 v[164:165], v[164:165], v[160:161]
    v_pk_mul_f32 v[166:167], v[166:167], v[162:163]
    v_pk_mul_f32 v[180:181], v[180:181], v[176:177]
    buffer_load_dwordx4 v[84:87], v34, s[12:15], s4 offen offset:1024
    v_pk_mul_f32 v[182:183], v[182:183], v[178:179]
    v_exp_f32 v164, v164
    v_exp_f32 v165, v165
    v_exp_f32 v166, v166
    v_exp_f32 v167, v167
    v_exp_f32 v180, v180
    v_exp_f32 v181, v181
    buffer_load_dwordx4 v[88:91], v35, s[12:15], s4 offen offset:2048
    v_exp_f32 v182, v182
    v_exp_f32 v183, v183
    v_pk_add_f32 v[164:165], v[164:165], 1.0 op_sel_hi:[1,0]
    v_pk_add_f32 v[166:167], v[166:167], 1.0 op_sel_hi:[1,0]
    v_pk_add_f32 v[180:181], v[180:181], 1.0 op_sel_hi:[1,0]
    v_pk_add_f32 v[182:183], v[182:183], 1.0 op_sel_hi:[1,0]
    v_rcp_f32_e64 v164, v164
    buffer_load_dwordx4 v[92:95], v36, s[12:15], s4 offen offset:3072
    s_add_u32 s4, s4, s11
    s_cmp_eq_u32 s4, s8
    s_cselect_b32 s4, s7, s4
    v_rcp_f32 v165, v165
    v_rcp_f32 v166, v166
    v_rcp_f32 v167, v167
    v_rcp_f32 v180, v180
    v_rcp_f32 v181, v181
    v_rcp_f32 v182, v182
    v_rcp_f32 v183, v183
    buffer_load_dword v14, v15, s[36:39], s25 offen sc1
    v_pk_mul_f32 v[160:161], v[160:161], v[164:165]
    v_pk_mul_f32 v[162:163], v[162:163], v[166:167]
    v_pk_mul_f32 v[176:177], v[176:177], v[180:181]
    v_pk_mul_f32 v[178:179], v[178:179], v[182:183]
    v_cvt_pk_bf16_f32 v168, v160, v161
    v_cvt_pk_bf16_f32 v169, v162, v163
    v_cvt_pk_bf16_f32 v170, v176, v177
    v_cvt_pk_bf16_f32 v171, v178, v179
    buffer_store_dwordx4 v[168:171], v37, s[36:39], s52 offen offset:2048 sc1
    s_waitcnt lgkmcnt(0)
    s_nop 0
    v_pk_add_f32 v[192:193], v[192:193], v[196:197]
    v_pk_add_f32 v[200:201], v[200:201], v[204:205]
    v_pk_add_f32 v[194:195], v[194:195], v[198:199]
    v_pk_add_f32 v[202:203], v[202:203], v[206:207]
    v_pk_add_f32 v[208:209], v[208:209], v[212:213]
    v_pk_add_f32 v[216:217], v[216:217], v[220:221]
    v_pk_add_f32 v[210:211], v[210:211], v[214:215]
    v_pk_add_f32 v[218:219], v[218:219], v[222:223]
    v_pk_add_f32 v[192:193], v[192:193], v[234:235]
    v_pk_add_f32 v[194:195], v[194:195], v[236:237]
    v_pk_add_f32 v[208:209], v[208:209], v[238:239]
    v_pk_add_f32 v[210:211], v[210:211], v[240:241]
    v_pk_add_f32 v[192:193], v[192:193], v[200:201]
    v_pk_add_f32 v[194:195], v[194:195], v[202:203]
    v_pk_add_f32 v[208:209], v[208:209], v[216:217]
    v_pk_add_f32 v[210:211], v[210:211], v[218:219]
    v_pk_mul_f32 v[196:197], v[192:193], v[192:193]
    v_pk_mul_f32 v[198:199], v[194:195], v[194:195]
    v_pk_mul_f32 v[212:213], v[208:209], v[208:209]
    v_pk_mul_f32 v[214:215], v[210:211], v[210:211]
    v_pk_fma_f32 v[196:197], v[196:197], s[90:91], v[232:233]
    v_pk_fma_f32 v[198:199], v[198:199], s[90:91], v[232:233]
    v_pk_fma_f32 v[212:213], v[212:213], s[90:91], v[232:233]
    v_pk_fma_f32 v[214:215], v[214:215], s[90:91], v[232:233]
    v_pk_mul_f32 v[196:197], v[196:197], v[192:193]
    v_pk_mul_f32 v[198:199], v[198:199], v[194:195]
    v_pk_mul_f32 v[212:213], v[212:213], v[208:209]
    v_pk_mul_f32 v[214:215], v[214:215], v[210:211]
    v_exp_f32 v196, v196
    v_exp_f32 v197, v197
    v_exp_f32 v198, v198
    v_exp_f32 v199, v199
    v_exp_f32 v212, v212
    v_exp_f32 v213, v213
    v_exp_f32 v214, v214
    v_exp_f32 v215, v215
    v_pk_add_f32 v[196:197], v[196:197], 1.0 op_sel_hi:[1,0]
    v_pk_add_f32 v[198:199], v[198:199], 1.0 op_sel_hi:[1,0]
    v_pk_add_f32 v[212:213], v[212:213], 1.0 op_sel_hi:[1,0]
    v_pk_add_f32 v[214:215], v[214:215], 1.0 op_sel_hi:[1,0]
    v_rcp_f32 v196, v196
    v_rcp_f32 v197, v197
    v_rcp_f32 v198, v198
    v_rcp_f32 v199, v199
    v_rcp_f32 v212, v212
    v_rcp_f32 v213, v213
    v_rcp_f32 v214, v214
    v_rcp_f32 v215, v215
    v_pk_mul_f32 v[192:193], v[192:193], v[196:197]
    v_pk_mul_f32 v[194:195], v[194:195], v[198:199]
    v_pk_mul_f32 v[208:209], v[208:209], v[212:213]
    v_pk_mul_f32 v[210:211], v[210:211], v[214:215]
    v_cvt_pk_bf16_f32 v200, v192, v193
    v_cvt_pk_bf16_f32 v201, v194, v195
    v_cvt_pk_bf16_f32 v202, v208, v209
    v_cvt_pk_bf16_f32 v203, v210, v211
    buffer_store_dwordx4 v[200:203], v37, s[36:39], s53 offen offset:0 sc1
    s_waitcnt vmcnt(2)
    s_branch g1_e2
g1_e1:
    s_waitcnt lgkmcnt(0)
    s_nop 0
    buffer_load_dwordx4 v[68:71], v34, s[12:15], s4 offen offset:1024
    v_pk_add_f32 v[160:161], v[160:161], v[164:165]
    v_pk_add_f32 v[168:169], v[168:169], v[172:173]
    v_pk_add_f32 v[162:163], v[162:163], v[166:167]
    v_pk_add_f32 v[170:171], v[170:171], v[174:175]
    v_pk_add_f32 v[176:177], v[176:177], v[180:181]
    v_pk_add_f32 v[184:185], v[184:185], v[188:189]
    buffer_load_dwordx4 v[72:75], v35, s[12:15], s4 offen offset:2048
    v_pk_add_f32 v[178:179], v[178:179], v[182:183]
    v_pk_add_f32 v[186:187], v[186:187], v[190:191]
    v_pk_add_f32 v[160:161], v[160:161], v[234:235]
    v_pk_add_f32 v[162:163], v[162:163], v[236:237]
    v_pk_add_f32 v[176:177], v[176:177], v[238:239]
    v_pk_add_f32 v[178:179], v[178:179], v[240:241]
    v_pk_add_f32 v[160:161], v[160:161], v[168:169]
    buffer_load_dwordx4 v[76:79], v36, s[12:15], s4 offen offset:3072
    s_add_u32 s4, s4, s11
    s_cmp_eq_u32 s4, s8
    s_cselect_b32 s4, s7, s4
    s_nop 0
    v_pk_add_f32 v[162:163], v[162:163], v[170:171]
    v_pk_add_f32 v[176:177], v[176:177], v[184:185]
    v_pk_add_f32 v[178:179], v[178:179], v[186:187]
    v_pk_mul_f32 v[164:165], v[160:161], v[160:161]
    v_pk_mul_f32 v[166:167], v[162:163], v[162:163]
    v_pk_mul_f32 v[180:181], v[176:177], v[176:177]
    v_pk_mul_f32 v[182:183], v[178:179], v[178:179]
    buffer_load_dwordx4 v[80:83], v33, s[12:15], s4 offen offset:0
    v_pk_fma_f32 v[164:165], v[164:165], s[90:91], v[232:233]
    v_pk_fma_f32 v[166:167], v[166:167], s[90:91], v[232:233]
    v_pk_fma_f32 v[180:181], v[180:181], s[90:91], v[232:233]
    v_pk_fma_f32 v[182:183], v[182:183], s[90:91], v[232:233]
    v_pk_mul_f32 v[164:165], v[164:165], v[160:161]
    v_pk_mul_f32 v[166:167], v[166:167], v[162:163]
    v_pk_mul_f32 v[180:181], v[180:181], v[176:177]
    buffer_load_dwordx4 v[84:87], v34, s[12:15], s4 offen offset:1024
    v_pk_mul_f32 v[182:183], v[182:183], v[178:179]
    v_exp_f32 v164, v164
    v_exp_f32 v165, v165
    v_exp_f32 v166, v166
    v_exp_f32 v167, v167
    v_exp_f32 v180, v180
    v_exp_f32 v181, v181
    buffer_load_dwordx4 v[88:91], v35, s[12:15], s4 offen offset:2048
    v_exp_f32 v182, v182
    v_exp_f32 v183, v183
    v_pk_add_f32 v[164:165], v[164:165], 1.0 op_sel_hi:[1,0]
    v_pk_add_f32 v[166:167], v[166:167], 1.0 op_sel_hi:[1,0]
    v_pk_add_f32 v[180:181], v[180:181], 1.0 op_sel_hi:[1,0]
    v_pk_add_f32 v[182:183], v[182:183], 1.0 op_sel_hi:[1,0]
    v_rcp_f32_e64 v164, v164
    buffer_load_dwordx4 v[92:95], v36, s[12:15], s4 offen offset:3072
    s_add_u32 s4, s4, s11
    s_cmp_eq_u32 s4, s8
    s_cselect_b32 s4, s7, s4
    v_rcp_f32 v165, v165
    v_rcp_f32 v166, v166
    v_rcp_f32 v167, v167
    v_rcp_f32 v180, v180
    v_rcp_f32 v181, v181
    v_rcp_f32 v182, v182
    v_rcp_f32 v183, v183
    buffer_load_dword v14, v15, s[36:39], s25 offen sc1
    v_pk_mul_f32 v[160:161], v[160:161], v[164:165]
    v_pk_mul_f32 v[162:163], v[162:163], v[166:167]
    v_pk_mul_f32 v[176:177], v[176:177], v[180:181]
    v_pk_mul_f32 v[178:179], v[178:179], v[182:183]
    v_cvt_pk_bf16_f32 v168, v160, v161
    v_cvt_pk_bf16_f32 v169, v162, v163
    v_cvt_pk_bf16_f32 v170, v176, v177
    v_cvt_pk_bf16_f32 v171, v178, v179
    buffer_store_dwordx4 v[168:171], v37, s[36:39], s52 offen offset:2048 sc1
    s_waitcnt vmcnt(1)
g1_e2:
    s_mov_b32 s99, 0
    v_cmp_ne_u32_e64 vcc, s16, v14
    s_cbranch_vccnz g1_q1
    s_mov_b32 s99, 1
    buffer_load_dwordx4 a[0:3], v37, s[36:39], s54 offen offset:0 sc1
    buffer_load_dwordx4 a[4:7], v37, s[36:39], s54 offen offset:1024 sc1
    buffer_load_dwordx4 a[8:11], v37, s[36:39], s54 offen offset:2048 sc1
    buffer_load_dwordx4 a[12:15], v37, s[36:39], s54 offen offset:3072 sc1
    buffer_load_dwordx4 a[16:19], v37, s[36:39], s55 offen offset:0 sc1
    buffer_load_dwordx4 a[20:23], v37, s[36:39], s55 offen offset:1024 sc1
    buffer_load_dwordx4 a[24:27], v37, s[36:39], s55 offen offset:2048 sc1
    buffer_load_dwordx4 a[28:31], v37, s[36:39], s55 offen offset:3072 sc1
    buffer_load_dwordx4 a[32:35], v38, s[36:39], s55 offen offset:0 sc1
    s_add_u32 s54, s54, 4096
    s_add_u32 s55, s55, 40960
    s_add_u32 s94, s94, 1
    s_cmp_eq_u32 s94, 5
    s_cselect_b32 s86, 20480, 0
    s_cselect_b32 s89, 204800, 0
    s_sub_u32 s54, s54, s86
    s_sub_u32 s55, s55, s89
    s_waitcnt vmcnt(9)
    s_branch g1_q2
g1_q1:
    s_waitcnt vmcnt(0)
g1_q2:
    s_mul_i32 s88, s71, 24
    s_add_u32 s88, s88, s72
    s_barrier
    s_cmp_lg_u32 s68, 0
    s_cbranch_scc1 pub_u_np
    s_lshl_b32 s85, s88, 7
    s_add_u32 s85, s85, 0x97c080
    v_mov_b32 v2, s16
    v_lshlrev_b32 v3, 2, v1
    s_mov_b32 exec_hi, 0
    buffer_store_dword v2, v3, s[36:39], s85 offen sc1
    s_mov_b32 exec_hi, -1
pub_u_np:
    s_nop 0
    ds_write_b128 v250, v[48:51] offset:0
    ds_write_b128 v250, v[52:55] offset:1024
    ds_write_b128 v250, v[56:59] offset:2048
    ds_write_b128 v250, v[60:63] offset:3072
    ds_write_b128 v250, v[64:67] offset:4096
    ds_write_b128 v250, v[68:71] offset:5120
    ds_write_b128 v250, v[72:75] offset:6144
    ds_write_b128 v250, v[76:79] offset:7168
    ds_write_b128 v250, v[80:83] offset:8192
    ds_write_b128 v250, v[84:87] offset:9216
    ds_write_b128 v250, v[88:91] offset:10240
    ds_write_b128 v250, v[92:95] offset:11264
    s_cmp_lg_u32 s99, 0
    s_cbranch_scc1 f_go
    buffer_load_dword v14, v15, s[36:39], s25 offen sc1
    s_waitcnt vmcnt(0)
    v_cmp_ne_u32_e64 vcc, s16, v14
    s_cbranch_vccz pq_ok
    s_mov_b32 s98, 0
pq_spin:
    s_add_u32 s98, s98, 1
    s_cmp_gt_u32 s98, 0x80000
    s_cbranch_scc1 pq_ok
    s_sleep 1
    buffer_load_dword v14, v15, s[36:39], s25 offen sc1
    s_waitcnt vmcnt(0)
    v_cmp_ne_u32_e64 vcc, s16, v14
    s_cbranch_vccnz pq_spin
pq_ok:
f_entry:
    buffer_load_dwordx4 a[0:3], v37, s[36:39], s54 offen offset:0 sc1
    buffer_load_dwordx4 a[4:7], v37, s[36:39], s54 offen offset:1024 sc1
    buffer_load_dwordx4 a[8:11], v37, s[36:39], s54 offen offset:2048 sc1
    buffer_load_dwordx4 a[12:15], v37, s[36:39], s54 offen offset:3072 sc1
    buffer_load_dwordx4 a[16:19], v37, s[36:39], s55 offen offset:0 sc1
    buffer_load_dwordx4 a[20:23], v37, s[36:39], s55 offen offset:1024 sc1
    buffer_load_dwordx4 a[24:27], v37, s[36:39], s55 offen offset:2048 sc1
    buffer_load_dwordx4 a[28:31], v37, s[36:39], s55 offen offset:3072 sc1
    buffer_load_dwordx4 a[32:35], v38, s[36:39], s55 offen offset:0 sc1
    s_add_u32 s54, s54, 4096
    s_add_u32 s55, s55, 40960
    s_add_u32 s94, s94, 1
    s_cmp_eq_u32 s94, 5
    s_cselect_b32 s86, 20480, 0
    s_cselect_b32 s89, 204800, 0
    s_sub_u32 s54, s54, s86
    s_sub_u32 s55, s55, s89
f_go:
    buffer_load_dwordx4 a[112:115], v37, s[36:39], s54 offen offset:0 sc1
    buffer_load_dwordx4 a[116:119], v37, s[36:39], s54 offen offset:1024 sc1
    buffer_load_dwordx4 a[120:123], v37, s[36:39], s54 offen offset:2048 sc1
    buffer_load_dwordx4 a[124:127], v37, s[36:39], s54 offen offset:3072 sc1
    buffer_load_dwordx4 a[128:131], v37, s[36:39], s55 offen offset:0 sc1
    buffer_load_dwordx4 a[132:135], v37, s[36:39], s55 offen offset:1024 sc1
    buffer_load_dwordx4 a[136:139], v37, s[36:39], s55 offen offset:2048 sc1
    buffer_load_dwordx4 a[140:143], v37, s[36:39], s55 offen offset:3072 sc1
    buffer_load_dwordx4 a[144:147], v38, s[36:39], s55 offen offset:0 sc1
    s_add_u32 s54, s54, 4096
    s_add_u32 s55, s55, 40960
    s_add_u32 s94, s94, 1
    s_cmp_eq_u32 s94, 5
    s_cselect_b32 s86, 20480, 0
    s_cselect_b32 s89, 204800, 0
    s_sub_u32 s54, s54, s86
    s_sub_u32 s55, s55, s89
    s_or_b32 s85, s2, s68
    s_cmp_lg_u32 s85, 0
    s_cbranch_scc1 f_nox
    s_mov_b32 s85, 0x974000
    v_mov_b32 v2, s16
    v_lshlrev_b32 v3, 2, v1
    s_mov_b32 exec_hi, 0
    buffer_store_dword v2, v3, s[36:39], s85 offen sc1
    s_mov_b32 exec_hi, -1
f_nox:
    s_nop 0
    buffer_load_dwordx4 a[148:151], v37, s[36:39], s54 offen offset:0 sc1
    buffer_load_dwordx4 a[152:155], v37, s[36:39], s54 offen offset:1024 sc1
    buffer_load_dwordx4 a[156:159], v37, s[36:39], s54 offen offset:2048 sc1
    buffer_load_dwordx4 a[160:163], v37, s[36:39], s54 offen offset:3072 sc1
    buffer_load_dwordx4 a[164:167], v37, s[36:39], s55 offen offset:0 sc1
    buffer_load_dwordx4 a[168:171], v37, s[36:39], s55 offen offset:1024 sc1
    buffer_load_dwordx4 a[172:175], v37, s[36:39], s55 offen offset:2048 sc1
    buffer_load_dwordx4 a[176:179], v37, s[36:39], s55 offen offset:3072 sc1
    buffer_load_dwordx4 a[180:183], v38, s[36:39], s55 offen offset:0 sc1
    s_add_u32 s54, s54, 4096
    s_add_u32 s55, s55, 40960
    s_add_u32 s94, s94, 1
    s_cmp_eq_u32 s94, 5
    s_cselect_b32 s86, 20480, 0
    s_cselect_b32 s89, 204800, 0
    s_sub_u32 s54, s54, s86
    s_sub_u32 s55, s55, s89
    s_mov_b32 s5, s20
    s_mov_b32 s9, s21
    s_mov_b32 s10, s22
    s_waitcnt vmcnt(18)
    v_mfma_f32_16x16x32_bf16 v[128:131], a[16:19], a[0:3], 0
    buffer_load_dwordx4 a[184:187], v37, s[36:39], s54 offen offset:0 sc1
    v_mfma_f32_16x16x32_bf16 v[148:151], a[16:19], a[4:7], 0
    v_mfma_f32_16x16x32_bf16 v[168:171], a[16:19], a[8:11], 0
    buffer_load_dwordx4 a[188:191], v37, s[36:39], s54 offen offset:1024 sc1
    v_mfma_f32_16x16x32_bf16 v[188:191], a[16:19], a[12:15], 0
    v_mfma_f32_16x16x32_bf16 v[132:135], a[20:23], a[0:3], 0
    buffer_load_dwordx4 a[192:195], v37, s[36:39], s54 offen offset:2048 sc1
    v_mfma_f32_16x16x32_bf16 v[152:155], a[20:23], a[4:7], 0
    v_mfma_f32_16x16x32_bf16 v[172:175], a[20:23], a[8:11], 0
    buffer_load_dwordx4 a[196:199], v37, s[36:39], s54 offen offset:3072 sc1
    v_mfma_f32_16x16x32_bf16 v[192:195], a[20:23], a[12:15], 0
    v_mfma_f32_16x16x32_bf16 v[136:139], a[24:27], a[0:3], 0
    buffer_load_dwordx4 a[200:203], v37, s[36:39], s55 offen offset:0 sc1
    v_mfma_f32_16x16x32_bf16 v[156:159], a[24:27], a[4:7], 0
    v_mfma_f32_16x16x32_bf16 v[176:179], a[24:27], a[8:11], 0
    v_mfma_f32_16x16x32_bf16 v[196:199], a[24:27], a[12:15], 0
    buffer_load_dwordx4 a[204:207], v37, s[36:39], s55 offen offset:1024 sc1
    v_mfma_f32_16x16x32_bf16 v[140:143], a[28:31], a[0:3], 0
    v_mfma_f32_16x16x32_bf16 v[160:163], a[28:31], a[4:7], 0
    buffer_load_dwordx4 a[208:211], v37, s[36:39], s55 offen offset:2048 sc1
    v_mfma_f32_16x16x32_bf16 v[180:183], a[28:31], a[8:11], 0
    v_mfma_f32_16x16x32_bf16 v[200:203], a[28:31], a[12:15], 0
    buffer_load_dwordx4 a[212:215], v37, s[36:39], s55 offen offset:3072 sc1
    v_mfma_f32_16x16x32_bf16 v[144:147], a[32:35], a[0:3], 0
    v_mfma_f32_16x16x32_bf16 v[164:167], a[32:35], a[4:7], 0
    buffer_load_dwordx4 a[216:219], v38, s[36:39], s55 offen offset:0 sc1
    s_add_u32 s54, s54, 4096
    s_add_u32 s55, s55, 40960
    s_add_u32 s94, s94, 1
    s_cmp_eq_u32 s94, 5
    s_cselect_b32 s86, 20480, 0
    s_cselect_b32 s89, 204800, 0
    s_sub_u32 s54, s54, s86
    s_sub_u32 s55, s55, s89
    v_mfma_f32_16x16x32_bf16 v[184:187], a[32:35], a[8:11], 0
    v_mfma_f32_16x16x32_bf16 v[204:207], a[32:35], a[12:15], 0
    s_waitcnt vmcnt(18)
    s_nop 0
    v_mfma_f32_16x16x32_bf16 v[128:131], a[128:131], a[112:115], v[128:131]
    buffer_load_dword v14, v12, s[36:39], s23 offen sc1
    v_mfma_f32_16x16x32_bf16 v[148:151], a[128:131], a[116:119], v[148:151]
    v_mfma_f32_16x16x32_bf16 v[168:171], a[128:131], a[120:123], v[168:171]
    buffer_load_dwordx4 a[220:223], v37, s[36:39], s54 offen offset:0 sc1
    v_mfma_f32_16x16x32_bf16 v[188:191], a[128:131], a[124:127], v[188:191]
    v_mfma_f32_16x16x32_bf16 v[132:135], a[132:135], a[112:115], v[132:135]
    buffer_load_dwordx4 a[224:227], v37, s[36:39], s54 offen offset:1024 sc1
    v_mfma_f32_16x16x32_bf16 v[152:155], a[132:135], a[116:119], v[152:155]
    v_mfma_f32_16x16x32_bf16 v[172:175], a[132:135], a[120:123], v[172:175]
    buffer_load_dwordx4 a[228:231], v37, s[36:39], s54 offen offset:2048 sc1
    v_mfma_f32_16x16x32_bf16 v[192:195], a[132:135], a[124:127], v[192:195]
    v_mfma_f32_16x16x32_bf16 v[136:139], a[136:139], a[112:115], v[136:139]
    buffer_load_dwordx4 a[232:235], v37, s[36:39], s54 offen offset:3072 sc1
    v_mfma_f32_16x16x32_bf16 v[156:159], a[136:139], a[116:119], v[156:159]
    v_mfma_f32_16x16x32_bf16 v[176:179], a[136:139], a[120:123], v[176:179]
    buffer_load_dwordx4 a[236:239], v37, s[36:39], s55 offen offset:0 sc1
    v_mfma_f32_16x16x32_bf16 v[196:199], a[136:139], a[124:127], v[196:199]
    v_mfma_f32_16x16x32_bf16 v[140:143], a[140:143], a[112:115], v[140:143]
    buffer_load_dwordx4 a[240:243], v37, s[36:39], s55 offen offset:1024 sc1
    v_mfma_f32_16x16x32_bf16 v[160:163], a[140:143], a[116:119], v[160:163]
    v_mfma_f32_16x16x32_bf16 v[180:183], a[140:143], a[120:123], v[180:183]
    buffer_load_dwordx4 a[244:247], v37, s[36:39], s55 offen offset:2048 sc1
    v_mfma_f32_16x16x32_bf16 v[200:203], a[140:143], a[124:127], v[200:203]
    v_mfma_f32_16x16x32_bf16 v[144:147], a[144:147], a[112:115], v[144:147]
    buffer_load_dwordx4 a[248:251], v37, s[36:39], s55 offen offset:3072 sc1
    v_mfma_f32_16x16x32_bf16 v[164:167], a[144:147], a[116:119], v[164:167]
    v_mfma_f32_16x16x32_bf16 v[184:187], a[144:147], a[120:123], v[184:187]
    buffer_load_dwordx4 a[252:255], v38, s[36:39], s55 offen offset:0 sc1
    v_mfma_f32_16x16x32_bf16 v[204:207], a[144:147], a[124:127], v[204:207]
    s_waitcnt vmcnt(9) lgkmcnt(0)
    v_cmp_ne_u32_e64 vcc, s16, v14
    s_cbranch_vccz pu_ok
    s_mov_b32 s98, 0
pu_spin:
    s_add_u32 s98, s98, 1
    s_cmp_gt_u32 s98, 0x80000
    s_cbranch_scc1 pu_ok
    s_sleep 1
    buffer_load_dword v14, v12, s[36:39], s23 offen sc1
    s_waitcnt vmcnt(0)
    v_cmp_ne_u32_e64 vcc, s16, v14
    s_cbranch_vccnz pu_spin
pu_ok:
    v_mfma_f32_16x16x32_bf16 v[128:131], a[164:167], a[148:151], v[128:131]
    buffer_load_dwordx4 a[0:3], v37, s[36:39], s5 offen offset:0 sc1
    v_mfma_f32_16x16x32_bf16 v[148:151], a[164:167], a[152:155], v[148:151]
    buffer_load_dwordx4 a[4:7], v37, s[36:39], s5 offen offset:1024 sc1
    v_mfma_f32_16x16x32_bf16 v[168:171], a[164:167], a[156:159], v[168:171]
    buffer_load_dwordx4 a[8:11], v37, s[36:39], s5 offen offset:2048 sc1
    v_mfma_f32_16x16x32_bf16 v[188:191], a[164:167], a[160:163], v[188:191]
    v_mfma_f32_16x16x32_bf16 v[132:135], a[168:171], a[148:151], v[132:135]
    buffer_load_dwordx4 a[12:15], v37, s[36:39], s5 offen offset:3072 sc1
    v_mfma_f32_16x16x32_bf16 v[152:155], a[168:171], a[152:155], v[152:155]
    buffer_load_dwordx4 a[16:19], v38, s[36:39], s5 offen offset:0 sc1
    s_add_u32 s5, s5, 40960
    s_cmp_eq_u32 s5, s10
    s_cselect_b32 s5, s9, s5
    v_mfma_f32_16x16x32_bf16 v[172:175], a[168:171], a[156:159], v[172:175]
    buffer_load_dwordx4 a[20:23], v37, s[36:39], s5 offen offset:0 sc1
    v_mfma_f32_16x16x32_bf16 v[192:195], a[168:171], a[160:163], v[192:195]
    v_mfma_f32_16x16x32_bf16 v[136:139], a[172:175], a[148:151], v[136:139]
    buffer_load_dwordx4 a[24:27], v37, s[36:39], s5 offen offset:1024 sc1
    v_mfma_f32_16x16x32_bf16 v[156:159], a[172:175], a[152:155], v[156:159]
    buffer_load_dwordx4 a[28:31], v37, s[36:39], s5 offen offset:2048 sc1
    v_mfma_f32_16x16x32_bf16 v[176:179], a[172:175], a[156:159], v[176:179]
    buffer_load_dwordx4 a[32:35], v37, s[36:39], s5 offen offset:3072 sc1
    v_mfma_f32_16x16x32_bf16 v[196:199], a[172:175], a[160:163], v[196:199]
    v_mfma_f32_16x16x32_bf16 v[140:143], a[176:179], a[148:151], v[140:143]
    buffer_load_dwordx4 a[36:39], v38, s[36:39], s5 offen offset:0 sc1
    s_add_u32 s5, s5, 40960
    s_cmp_eq_u32 s5, s10
    s_cselect_b32 s5, s9, s5
    v_mfma_f32_16x16x32_bf16 v[160:163], a[176:179], a[152:155], v[160:163]
    buffer_load_dwordx4 a[40:43], v37, s[36:39], s5 offen offset:0 sc1
    v_mfma_f32_16x16x32_bf16 v[180:183], a[176:179], a[156:159], v[180:183]
    buffer_load_dwordx4 a[44:47], v37, s[36:39], s5 offen offset:1024 sc1
    v_mfma_f32_16x16x32_bf16 v[200:203], a[176:179], a[160:163], v[200:203]
    v_mfma_f32_16x16x32_bf16 v[144:147], a[180:183], a[148:151], v[144:147]
    buffer_load_dwordx4 a[48:51], v37, s[36:39], s5 offen offset:2048 sc1
    v_mfma_f32_16x16x32_bf16 v[164:167], a[180:183], a[152:155], v[164:167]
    buffer_load_dwordx4 a[52:55], v37, s[36:39], s5 offen offset:3072 sc1
    v_mfma_f32_16x16x32_bf16 v[184:187], a[180:183], a[156:159], v[184:187]
    buffer_load_dwordx4 a[56:59], v38, s[36:39], s5 offen offset:0 sc1
    s_add_u32 s5, s5, 40960
    s_cmp_eq_u32 s5, s10
    s_cselect_b32 s5, s9, s5
    v_mfma_f32_16x16x32_bf16 v[204:207], a[180:183], a[160:163], v[204:207]
    v_mfma_f32_16x16x32_bf16 v[128:131], a[200:203], a[184:187], v[128:131]
    v_lshlrev_b32 v48, 16, v29
    v_lshlrev_b32 v49, 16, v29
    v_mov_b64_e64 v[50:51], v[48:49]
    v_mfma_f32_16x16x32_bf16 v[148:151], a[200:203], a[188:191], v[148:151]
    v_mov_b64 v[52:53], v[48:49]
    v_mov_b64 v[54:55], v[48:49]
    v_mfma_f32_16x16x32_bf16 v[168:171], a[200:203], a[192:195], v[168:171]
    v_mov_b64 v[56:57], v[48:49]
    v_mov_b64 v[58:59], v[48:49]
    v_mfma_f32_16x16x32_bf16 v[188:191], a[200:203], a[196:199], v[188:191]
    v_mov_b64 v[60:61], v[48:49]
    v_mov_b64 v[62:63], v[48:49]
    v_mfma_f32_16x16x32_bf16 v[132:135], a[204:207], a[184:187], v[132:135]
    v_mov_b64 v[64:65], v[48:49]
    v_mov_b64 v[66:67], v[48:49]
    v_mfma_f32_16x16x32_bf16 v[152:155], a[204:207], a[188:191], v[152:155]
    v_lshlrev_b32 v68, 16, v30
    v_lshlrev_b32 v69, 16, v30
    v_mov_b64_e64 v[70:71], v[68:69]
    v_mfma_f32_16x16x32_bf16 v[172:175], a[204:207], a[192:195], v[172:175]
    v_mov_b64 v[72:73], v[68:69]
    v_mov_b64 v[74:75], v[68:69]
    v_mfma_f32_16x16x32_bf16 v[192:195], a[204:207], a[196:199], v[192:195]
    v_mov_b64 v[76:77], v[68:69]
    v_mov_b64 v[78:79], v[68:69]
    v_mfma_f32_16x16x32_bf16 v[136:139], a[208:211], a[184:187], v[136:139]
    v_mov_b64 v[80:81], v[68:69]
    v_mov_b64 v[82:83], v[68:69]
    v_mfma_f32_16x16x32_bf16 v[156:159], a[208:211], a[188:191], v[156:159]
    v_mov_b64 v[84:85], v[68:69]
    v_mov_b64 v[86:87], v[68:69]
    v_mfma_f32_16x16x32_bf16 v[176:179], a[208:211], a[192:195], v[176:179]
    v_lshlrev_b32 v88, 16, v31
    v_lshlrev_b32 v89, 16, v31
    v_mov_b64_e64 v[90:91], v[88:89]
    v_mfma_f32_16x16x32_bf16 v[196:199], a[208:211], a[196:199], v[196:199]
    v_mov_b64 v[92:93], v[88:89]
    v_mov_b64 v[94:95], v[88:89]
    v_mfma_f32_16x16x32_bf16 v[140:143], a[212:215], a[184:187], v[140:143]
    v_mov_b64 v[96:97], v[88:89]
    v_mov_b64 v[98:99], v[88:89]
    v_mfma_f32_16x16x32_bf16 v[160:163], a[212:215], a[188:191], v[160:163]
    v_mov_b64 v[100:101], v[88:89]
    v_mov_b64 v[102:103], v[88:89]
    v_mfma_f32_16x16x32_bf16 v[180:183], a[212:215], a[192:195], v[180:183]
    v_mov_b64 v[104:105], v[88:89]
    v_mov_b64 v[106:107], v[88:89]
    v_mfma_f32_16x16x32_bf16 v[200:203], a[212:215], a[196:199], v[200:203]
    v_lshlrev_b32 v108, 16, v32
    v_lshlrev_b32 v109, 16, v32
    v_mov_b64_e64 v[110:111], v[108:109]
    v_mfma_f32_16x16x32_bf16 v[144:147], a[216:219], a[184:187], v[144:147]
    v_mov_b64 v[112:113], v[108:109]
    v_mov_b64 v[114:115], v[108:109]
    v_mfma_f32_16x16x32_bf16 v[164:167], a[216:219], a[188:191], v[164:167]
    v_mov_b64 v[116:117], v[108:109]
    v_mov_b64 v[118:119], v[108:109]
    v_mfma_f32_16x16x32_bf16 v[184:187], a[216:219], a[192:195], v[184:187]
    v_mov_b64 v[120:121], v[108:109]
    v_mov_b64 v[122:123], v[108:109]
    v_mfma_f32_16x16x32_bf16 v[204:207], a[216:219], a[196:199], v[204:207]
    v_mov_b64 v[124:125], v[108:109]
    v_mov_b64_e64 v[126:127], v[108:109]
    s_waitcnt vmcnt(15)
    v_mfma_f32_16x16x32_bf16 v[128:131], a[236:239], a[220:223], v[128:131]
    v_mfma_f32_16x16x32_bf16 v[148:151], a[236:239], a[224:227], v[148:151]
    v_mfma_f32_16x16x32_bf16 v[168:171], a[236:239], a[228:231], v[168:171]
    v_mfma_f32_16x16x32_bf16 v[188:191], a[236:239], a[232:235], v[188:191]
    ds_read_b64_tr_b16 a[80:81], v39 offset:0
    v_mfma_f32_16x16x32_bf16 v[132:135], a[240:243], a[220:223], v[132:135]
    v_mfma_f32_16x16x32_bf16 v[152:155], a[240:243], a[224:227], v[152:155]
    ds_read_b64_tr_b16 a[82:83], v39 offset:2048
    v_mfma_f32_16x16x32_bf16 v[172:175], a[240:243], a[228:231], v[172:175]
    ds_read_b64_tr_b16 a[84:85], v40 offset:0
    v_mfma_f32_16x16x32_bf16 v[192:195], a[240:243], a[232:235], v[192:195]
    ds_read_b64_tr_b16 a[86:87], v40 offset:2048
    v_mfma_f32_16x16x32_bf16 v[136:139], a[244:247], a[220:223], v[136:139]
    ds_read_b64_tr_b16 a[88:89], v41 offset:0
    v_mfma_f32_16x16x32_bf16 v[156:159], a[244:247], a[224:227], v[156:159]
    v_mfma_f32_16x16x32_bf16 v[176:179], a[244:247], a[228:231], v[176:179]
    ds_read_b64_tr_b16 a[90:91], v41 offset:2048
    v_mfma_f32_16x16x32_bf16 v[196:199], a[244:247], a[232:235], v[196:199]
    ds_read_b64_tr_b16 a[92:93], v42 offset:0
    v_mfma_f32_16x16x32_bf16 v[140:143], a[248:251], a[220:223], v[140:143]
    ds_read_b64_tr_b16 a[94:95], v42 offset:2048
    v_mfma_f32_16x16x32_bf16 v[160:163], a[248:251], a[224:227], v[160:163]
    v_mfma_f32_16x16x32_bf16 v[180:183], a[248:251], a[228:231], v[180:183]
    v_mfma_f32_16x16x32_bf16 v[200:203], a[248:251], a[232:235], v[200:203]
    v_mfma_f32_16x16x32_bf16 v[144:147], a[252:255], a[220:223], v[144:147]
    v_mfma_f32_16x16x32_bf16 v[164:167], a[252:255], a[224:227], v[164:167]
    v_mfma_f32_16x16x32_bf16 v[184:187], a[252:255], a[228:231], v[184:187]
    v_mfma_f32_16x16x32_bf16 v[204:207], a[252:255], a[232:235], v[204:207]
    s_waitcnt vmcnt(10)
    s_waitcnt vmcnt(10) lgkmcnt(0)
    v_mfma_f32_16x16x32_bf16 v[48:51], a[0:3], a[80:83], v[48:51]
    v_mfma_f32_16x16x32_bf16 v[68:71], a[0:3], a[84:87], v[68:71]
    v_mfma_f32_16x16x32_bf16 v[88:91], a[0:3], a[88:91], v[88:91]
    v_mfma_f32_16x16x32_bf16 v[108:111], a[0:3], a[92:95], v[108:111]
    buffer_load_dwordx4 a[60:63], v37, s[36:39], s5 offen offset:0 sc1
    v_mfma_f32_16x16x32_bf16 v[52:55], a[4:7], a[80:83], v[52:55]
    ds_read_b64_tr_b16 a[96:97], v39 offset:4096
    v_mfma_f32_16x16x32_bf16 v[72:75], a[4:7], a[84:87], v[72:75]
    ds_read_b64_tr_b16 a[98:99], v39 offset:6144
    v_mfma_f32_16x16x32_bf16 v[92:95], a[4:7], a[88:91], v[92:95]
    ds_read_b64_tr_b16 a[100:101], v40 offset:4096
    v_mfma_f32_16x16x32_bf16 v[112:115], a[4:7], a[92:95], v[112:115]
    ds_read_b64_tr_b16 a[102:103], v40 offset:6144
    buffer_load_dwordx4 a[64:67], v37, s[36:39], s5 offen offset:1024 sc1
    v_mfma_f32_16x16x32_bf16 v[56:59], a[8:11], a[80:83], v[56:59]
    ds_read_b64_tr_b16 a[104:105], v41 offset:4096
    v_mfma_f32_16x16x32_bf16 v[76:79], a[8:11], a[84:87], v[76:79]
    ds_read_b64_tr_b16 a[106:107], v41 offset:6144
    v_mfma_f32_16x16x32_bf16 v[96:99], a[8:11], a[88:91], v[96:99]
    ds_read_b64_tr_b16 a[108:109], v42 offset:4096
    v_mfma_f32_16x16x32_bf16 v[116:119], a[8:11], a[92:95], v[116:119]
    ds_read_b64_tr_b16 a[110:111], v42 offset:6144
    buffer_load_dwordx4 a[68:71], v37, s[36:39], s5 offen offset:2048 sc1
    v_mfma_f32_16x16x32_bf16 v[60:63], a[12:15], a[80:83], v[60:63]
    v_mfma_f32_16x16x32_bf16 v[80:83], a[12:15], a[84:87], v[80:83]
    v_mfma_f32_16x16x32_bf16 v[100:103], a[12:15], a[88:91], v[100:103]
    v_mfma_f32_16x16x32_bf16 v[120:123], a[12:15], a[92:95], v[120:123]
    buffer_load_dwordx4 a[72:75], v37, s[36:39], s5 offen offset:3072 sc1
    v_mfma_f32_16x16x32_bf16 v[64:67], a[16:19], a[80:83], v[64:67]
    v_mfma_f32_16x16x32_bf16 v[84:87], a[16:19], a[84:87], v[84:87]
    v_mfma_f32_16x16x32_bf16 v[104:107], a[16:19], a[88:91], v[104:107]
    v_mfma_f32_16x16x32_bf16 v[124:127], a[16:19], a[92:95], v[124:127]
    buffer_load_dwordx4 a[76:79], v38, s[36:39], s5 offen offset:0 sc1
    s_add_u32 s5, s5, 40960
    s_cmp_eq_u32 s5, s10
    s_cselect_b32 s5, s9, s5
    s_waitcnt vmcnt(10) lgkmcnt(0)
    s_nop 0
    v_mfma_f32_16x16x32_bf16 v[48:51], a[20:23], a[96:99], v[48:51]
    v_mfma_f32_16x16x32_bf16 v[68:71], a[20:23], a[100:103], v[68:71]
    v_mfma_f32_16x16x32_bf16 v[88:91], a[20:23], a[104:107], v[88:91]
    v_mfma_f32_16x16x32_bf16 v[108:111], a[20:23], a[108:111], v[108:111]
    buffer_load_dwordx4 a[0:3], v37, s[36:39], s5 offen offset:0 sc1
    v_mfma_f32_16x16x32_bf16 v[52:55], a[24:27], a[96:99], v[52:55]
    ds_read_b64_tr_b16 a[80:81], v39 offset:8192
    v_mfma_f32_16x16x32_bf16 v[72:75], a[24:27], a[100:103], v[72:75]
    ds_read_b64_tr_b16 a[82:83], v39 offset:10240
    v_mfma_f32_16x16x32_bf16 v[92:95], a[24:27], a[104:107], v[92:95]
    ds_read_b64_tr_b16 a[84:85], v40 offset:8192
    v_mfma_f32_16x16x32_bf16 v[112:115], a[24:27], a[108:111], v[112:115]
    ds_read_b64_tr_b16 a[86:87], v40 offset:10240
    buffer_load_dwordx4 a[4:7], v37, s[36:39], s5 offen offset:1024 sc1
    v_mfma_f32_16x16x32_bf16 v[56:59], a[28:31], a[96:99], v[56:59]
    ds_read_b64_tr_b16 a[88:89], v41 offset:8192
    v_mfma_f32_16x16x32_bf16 v[76:79], a[28:31], a[100:103], v[76:79]
    ds_read_b64_tr_b16 a[90:91], v41 offset:10240
    v_mfma_f32_16x16x32_bf16 v[96:99], a[28:31], a[104:107], v[96:99]
    ds_read_b64_tr_b16 a[92:93], v42 offset:8192
    v_mfma_f32_16x16x32_bf16 v[116:119], a[28:31], a[108:111], v[116:119]
    ds_read_b64_tr_b16 a[94:95], v42 offset:10240
    buffer_load_dwordx4 a[8:11], v37, s[36:39], s5 offen offset:2048 sc1
    v_mfma_f32_16x16x32_bf16 v[60:63], a[32:35], a[96:99], v[60:63]
    v_mfma_f32_16x16x32_bf16 v[80:83], a[32:35], a[100:103], v[80:83]
    v_mfma_f32_16x16x32_bf16 v[100:103], a[32:35], a[104:107], v[100:103]
    v_mfma_f32_16x16x32_bf16 v[120:123], a[32:35], a[108:111], v[120:123]
    buffer_load_dwordx4 a[12:15], v37, s[36:39], s5 offen offset:3072 sc1
    v_mfma_f32_16x16x32_bf16 v[64:67], a[36:39], a[96:99], v[64:67]
    v_mfma_f32_16x16x32_bf16 v[84:87], a[36:39], a[100:103], v[84:87]
    v_mfma_f32_16x16x32_bf16 v[104:107], a[36:39], a[104:107], v[104:107]
    v_mfma_f32_16x16x32_bf16 v[124:127], a[36:39], a[108:111], v[124:127]
    buffer_load_dwordx4 a[16:19], v38, s[36:39], s5 offen offset:0 sc1
    s_add_u32 s5, s5, 40960
    s_cmp_eq_u32 s5, s10
    s_cselect_b32 s5, s9, s5
    s_waitcnt vmcnt(10) lgkmcnt(0)
    s_nop 0
    v_mfma_f32_16x16x32_bf16 v[48:51], a[40:43], a[80:83], v[48:51]
    v_mfma_f32_16x16x32_bf16 v[68:71], a[40:43], a[84:87], v[68:71]
    v_mfma_f32_16x16x32_bf16 v[88:91], a[40:43], a[88:91], v[88:91]
    v_mfma_f32_16x16x32_bf16 v[108:111], a[40:43], a[92:95], v[108:111]
    buffer_load_dwordx4 a[20:23], v37, s[36:39], s5 offen offset:0 sc1
    v_mfma_f32_16x16x32_bf16 v[52:55], a[44:47], a[80:83], v[52:55]
    ds_read_b64_tr_b16 a[96:97], v39 offset:12288
    v_mfma_f32_16x16x32_bf16 v[72:75], a[44:47], a[84:87], v[72:75]
    ds_read_b64_tr_b16 a[98:99], v39 offset:14336
    v_mfma_f32_16x16x32_bf16 v[92:95], a[44:47], a[88:91], v[92:95]
    ds_read_b64_tr_b16 a[100:101], v40 offset:12288
    v_mfma_f32_16x16x32_bf16 v[112:115], a[44:47], a[92:95], v[112:115]
    ds_read_b64_tr_b16 a[102:103], v40 offset:14336
    buffer_load_dwordx4 a[24:27], v37, s[36:39], s5 offen offset:1024 sc1
    v_mfma_f32_16x16x32_bf16 v[56:59], a[48:51], a[80:83], v[56:59]
    ds_read_b64_tr_b16 a[104:105], v41 offset:12288
    v_mfma_f32_16x16x32_bf16 v[76:79], a[48:51], a[84:87], v[76:79]
    ds_read_b64_tr_b16 a[106:107], v41 offset:14336
    v_mfma_f32_16x16x32_bf16 v[96:99], a[48:51], a[88:91], v[96:99]
    ds_read_b64_tr_b16 a[108:109], v42 offset:12288
    v_mfma_f32_16x16x32_bf16 v[116:119], a[48:51], a[92:95], v[116:119]
    ds_read_b64_tr_b16 a[110:111], v42 offset:14336
    buffer_load_dwordx4 a[28:31], v37, s[36:39], s5 offen offset:2048 sc1
    v_mfma_f32_16x16x32_bf16 v[60:63], a[52:55], a[80:83], v[60:63]
    v_mfma_f32_16x16x32_bf16 v[80:83], a[52:55], a[84:87], v[80:83]
    v_mfma_f32_16x16x32_bf16 v[100:103], a[52:55], a[88:91], v[100:103]
    v_mfma_f32_16x16x32_bf16 v[120:123], a[52:55], a[92:95], v[120:123]
    buffer_load_dwordx4 a[32:35], v37, s[36:39], s5 offen offset:3072 sc1
    v_mfma_f32_16x16x32_bf16 v[64:67], a[56:59], a[80:83], v[64:67]
    v_mfma_f32_16x16x32_bf16 v[84:87], a[56:59], a[84:87], v[84:87]
    v_mfma_f32_16x16x32_bf16 v[104:107], a[56:59], a[88:91], v[104:107]
    v_mfma_f32_16x16x32_bf16 v[124:127], a[56:59], a[92:95], v[124:127]
    buffer_load_dwordx4 a[36:39], v38, s[36:39], s5 offen offset:0 sc1
    s_add_u32 s5, s5, 40960
    s_cmp_eq_u32 s5, s10
    s_cselect_b32 s5, s9, s5
    s_waitcnt vmcnt(10) lgkmcnt(0)
    s_nop 0
    v_mfma_f32_16x16x32_bf16 v[48:51], a[60:63], a[96:99], v[48:51]
    v_mfma_f32_16x16x32_bf16 v[68:71], a[60:63], a[100:103], v[68:71]
    v_mfma_f32_16x16x32_bf16 v[88:91], a[60:63], a[104:107], v[88:91]
    v_mfma_f32_16x16x32_bf16 v[108:111], a[60:63], a[108:111], v[108:111]
    buffer_load_dwordx4 a[40:43], v37, s[36:39], s5 offen offset:0 sc1
    v_mfma_f32_16x16x32_bf16 v[52:55], a[64:67], a[96:99], v[52:55]
    ds_read_b64_tr_b16 a[80:81], v246 offset:0
    v_mfma_f32_16x16x32_bf16 v[72:75], a[64:67], a[100:103], v[72:75]
    ds_read_b64_tr_b16 a[82:83], v246 offset:2048
    v_mfma_f32_16x16x32_bf16 v[92:95], a[64:67], a[104:107], v[92:95]
    ds_read_b64_tr_b16 a[84:85], v247 offset:0
    v_mfma_f32_16x16x32_bf16 v[112:115], a[64:67], a[108:111], v[112:115]
    ds_read_b64_tr_b16 a[86:87], v247 offset:2048
    buffer_load_dwordx4 a[44:47], v37, s[36:39], s5 offen offset:1024 sc1
    v_mfma_f32_16x16x32_bf16 v[56:59], a[68:71], a[96:99], v[56:59]
    ds_read_b64_tr_b16 a[88:89], v248 offset:0
    v_mfma_f32_16x16x32_bf16 v[76:79], a[68:71], a[100:103], v[76:79]
    ds_read_b64_tr_b16 a[90:91], v248 offset:2048
    v_mfma_f32_16x16x32_bf16 v[96:99], a[68:71], a[104:107], v[96:99]
    ds_read_b64_tr_b16 a[92:93], v249 offset:0
    v_mfma_f32_16x16x32_bf16 v[116:119], a[68:71], a[108:111], v[116:119]
    ds_read_b64_tr_b16 a[94:95], v249 offset:2048
    buffer_load_dwordx4 a[48:51], v37, s[36:39], s5 offen offset:2048 sc1
    v_mfma_f32_16x16x32_bf16 v[60:63], a[72:75], a[96:99], v[60:63]
    v_mfma_f32_16x16x32_bf16 v[80:83], a[72:75], a[100:103], v[80:83]
    v_mfma_f32_16x16x32_bf16 v[100:103], a[72:75], a[104:107], v[100:103]
    v_mfma_f32_16x16x32_bf16 v[120:123], a[72:75], a[108:111], v[120:123]
    buffer_load_dwordx4 a[52:55], v37, s[36:39], s5 offen offset:3072 sc1
    v_mfma_f32_16x16x32_bf16 v[64:67], a[76:79], a[96:99], v[64:67]
    v_mfma_f32_16x16x32_bf16 v[84:87], a[76:79], a[100:103], v[84:87]
    v_mfma_f32_16x16x32_bf16 v[104:107], a[76:79], a[104:107], v[104:107]
    v_mfma_f32_16x16x32_bf16 v[124:127], a[76:79], a[108:111], v[124:127]
    buffer_load_dwordx4 a[56:59], v38, s[36:39], s5 offen offset:0 sc1
    s_add_u32 s5, s5, 40960
    s_cmp_eq_u32 s5, s10
    s_cselect_b32 s5, s9, s5
    s_waitcnt vmcnt(10) lgkmcnt(0)
    s_add_u32 m0, s6, 0
    v_mfma_f32_16x16x32_bf16 v[48:51], a[0:3], a[80:83], v[48:51]
    buffer_load_dwordx4 v33, s[12:15], s4 offen offset:0 lds
    v_mfma_f32_16x16x32_bf16 v[68:71], a[0:3], a[84:87], v[68:71]
    buffer_load_dwordx4 v34, s[12:15], s4 offen offset:1024 lds
    v_mfma_f32_16x16x32_bf16 v[88:91], a[0:3], a[88:91], v[88:91]
    buffer_load_dwordx4 v35, s[12:15], s4 offen offset:2048 lds
    v_mfma_f32_16x16x32_bf16 v[108:111], a[0:3], a[92:95], v[108:111]
    buffer_load_dwordx4 v36, s[12:15], s4 offen offset:3072 lds
    buffer_load_dwordx4 a[60:63], v37, s[36:39], s5 offen offset:0 sc1
    v_mfma_f32_16x16x32_bf16 v[52:55], a[4:7], a[80:83], v[52:55]
    ds_read_b64_tr_b16 a[96:97], v246 offset:4096
    v_mfma_f32_16x16x32_bf16 v[72:75], a[4:7], a[84:87], v[72:75]
    ds_read_b64_tr_b16 a[98:99], v246 offset:6144
    v_mfma_f32_16x16x32_bf16 v[92:95], a[4:7], a[88:91], v[92:95]
    ds_read_b64_tr_b16 a[100:101], v247 offset:4096
    v_mfma_f32_16x16x32_bf16 v[112:115], a[4:7], a[92:95], v[112:115]
    ds_read_b64_tr_b16 a[102:103], v247 offset:6144
    buffer_load_dwordx4 a[64:67], v37, s[36:39], s5 offen offset:1024 sc1
    v_mfma_f32_16x16x32_bf16 v[56:59], a[8:11], a[80:83], v[56:59]
    ds_read_b64_tr_b16 a[104:105], v248 offset:4096
    v_mfma_f32_16x16x32_bf16 v[76:79], a[8:11], a[84:87], v[76:79]
    ds_read_b64_tr_b16 a[106:107], v248 offset:6144
    v_mfma_f32_16x16x32_bf16 v[96:99], a[8:11], a[88:91], v[96:99]
    ds_read_b64_tr_b16 a[108:109], v249 offset:4096
    v_mfma_f32_16x16x32_bf16 v[116:119], a[8:11], a[92:95], v[116:119]
    ds_read_b64_tr_b16 a[110:111], v249 offset:6144
    buffer_load_dwordx4 a[68:71], v37, s[36:39], s5 offen offset:2048 sc1
    v_mfma_f32_16x16x32_bf16 v[60:63], a[12:15], a[80:83], v[60:63]
    s_add_u32 s4, s4, s11
    s_cmp_eq_u32 s4, s8
    s_cselect_b32 s4, s7, s4
    s_nop 0
    v_mfma_f32_16x16x32_bf16 v[80:83], a[12:15], a[84:87], v[80:83]
    v_mfma_f32_16x16x32_bf16 v[100:103], a[12:15], a[88:91], v[100:103]
    v_mfma_f32_16x16x32_bf16 v[120:123], a[12:15], a[92:95], v[120:123]
    buffer_load_dwordx4 a[72:75], v37, s[36:39], s5 offen offset:3072 sc1
    v_mfma_f32_16x16x32_bf16 v[64:67], a[16:19], a[80:83], v[64:67]
    v_mfma_f32_16x16x32_bf16 v[84:87], a[16:19], a[84:87], v[84:87]
    v_mfma_f32_16x16x32_bf16 v[104:107], a[16:19], a[88:91], v[104:107]
    v_mfma_f32_16x16x32_bf16 v[124:127], a[16:19], a[92:95], v[124:127]
    buffer_load_dwordx4 a[76:79], v38, s[36:39], s5 offen offset:0 sc1
    s_add_u32 s5, s5, 40960
    s_cmp_eq_u32 s5, s10
    s_cselect_b32 s5, s9, s5
    s_waitcnt vmcnt(14) lgkmcnt(0)
    s_nop 0
    s_add_u32 m0, s6, 4096
    v_mfma_f32_16x16x32_bf16 v[48:51], a[20:23], a[96:99], v[48:51]
    buffer_load_dwordx4 v33, s[12:15], s4 offen offset:0 lds
    v_mfma_f32_16x16x32_bf16 v[68:71], a[20:23], a[100:103], v[68:71]
    buffer_load_dwordx4 v34, s[12:15], s4 offen offset:1024 lds
    v_mfma_f32_16x16x32_bf16 v[88:91], a[20:23], a[104:107], v[88:91]
    buffer_load_dwordx4 v35, s[12:15], s4 offen offset:2048 lds
    v_mfma_f32_16x16x32_bf16 v[108:111], a[20:23], a[108:111], v[108:111]
    buffer_load_dwordx4 v36, s[12:15], s4 offen offset:3072 lds
    buffer_load_dwordx4 a[0:3], v37, s[36:39], s5 offen offset:0 sc1
    v_mfma_f32_16x16x32_bf16 v[52:55], a[24:27], a[96:99], v[52:55]
    ds_read_b64_tr_b16 a[80:81], v246 offset:8192
    v_mfma_f32_16x16x32_bf16 v[72:75], a[24:27], a[100:103], v[72:75]
    ds_read_b64_tr_b16 a[82:83], v246 offset:10240
    v_mfma_f32_16x16x32_bf16 v[92:95], a[24:27], a[104:107], v[92:95]
    ds_read_b64_tr_b16 a[84:85], v247 offset:8192
    v_mfma_f32_16x16x32_bf16 v[112:115], a[24:27], a[108:111], v[112:115]
    ds_read_b64_tr_b16 a[86:87], v247 offset:10240
    buffer_load_dwordx4 a[4:7], v37, s[36:39], s5 offen offset:1024 sc1
    v_mfma_f32_16x16x32_bf16 v[56:59], a[28:31], a[96:99], v[56:59]
    ds_read_b64_tr_b16 a[88:89], v248 offset:8192
    v_mfma_f32_16x16x32_bf16 v[76:79], a[28:31], a[100:103], v[76:79]
    ds_read_b64_tr_b16 a[90:91], v248 offset:10240
    v_mfma_f32_16x16x32_bf16 v[96:99], a[28:31], a[104:107], v[96:99]
    ds_read_b64_tr_b16 a[92:93], v249 offset:8192
    v_mfma_f32_16x16x32_bf16 v[116:119], a[28:31], a[108:111], v[116:119]
    ds_read_b64_tr_b16 a[94:95], v249 offset:10240
    buffer_load_dwordx4 a[8:11], v37, s[36:39], s5 offen offset:2048 sc1
    v_mfma_f32_16x16x32_bf16 v[60:63], a[32:35], a[96:99], v[60:63]
    s_add_u32 s4, s4, s11
    s_cmp_eq_u32 s4, s8
    s_cselect_b32 s4, s7, s4
    s_nop 0
    v_mfma_f32_16x16x32_bf16 v[80:83], a[32:35], a[100:103], v[80:83]
    v_mfma_f32_16x16x32_bf16 v[100:103], a[32:35], a[104:107], v[100:103]
    v_mfma_f32_16x16x32_bf16 v[120:123], a[32:35], a[108:111], v[120:123]
    buffer_load_dwordx4 a[12:15], v37, s[36:39], s5 offen offset:3072 sc1
    v_mfma_f32_16x16x32_bf16 v[64:67], a[36:39], a[96:99], v[64:67]
    v_mfma_f32_16x16x32_bf16 v[84:87], a[36:39], a[100:103], v[84:87]
    v_mfma_f32_16x16x32_bf16 v[104:107], a[36:39], a[104:107], v[104:107]
    v_mfma_f32_16x16x32_bf16 v[124:127], a[36:39], a[108:111], v[124:127]
    buffer_load_dwordx4 a[16:19], v38, s[36:39], s5 offen offset:0 sc1
    s_add_u32 s5, s5, 40960
    s_cmp_eq_u32 s5, s10
    s_cselect_b32 s5, s9, s5
    s_waitcnt vmcnt(14) lgkmcnt(0)
    s_nop 0
    s_add_u32 m0, s6, 8192
    v_mfma_f32_16x16x32_bf16 v[48:51], a[40:43], a[80:83], v[48:51]
    buffer_load_dwordx4 v33, s[12:15], s4 offen offset:0 lds
    v_mfma_f32_16x16x32_bf16 v[68:71], a[40:43], a[84:87], v[68:71]
    buffer_load_dwordx4 v34, s[12:15], s4 offen offset:1024 lds
    v_mfma_f32_16x16x32_bf16 v[88:91], a[40:43], a[88:91], v[88:91]
    buffer_load_dwordx4 v35, s[12:15], s4 offen offset:2048 lds
    v_mfma_f32_16x16x32_bf16 v[108:111], a[40:43], a[92:95], v[108:111]
    buffer_load_dwordx4 v36, s[12:15], s4 offen offset:3072 lds
    buffer_load_dwordx4 a[20:23], v37, s[36:39], s5 offen offset:0 sc1
    v_mfma_f32_16x16x32_bf16 v[52:55], a[44:47], a[80:83], v[52:55]
    ds_read_b64_tr_b16 a[96:97], v39 offset:0
    v_mfma_f32_16x16x32_bf16 v[72:75], a[44:47], a[84:87], v[72:75]
    ds_read_b64_tr_b16 a[98:99], v39 offset:2048
    v_mfma_f32_16x16x32_bf16 v[92:95], a[44:47], a[88:91], v[92:95]
    ds_read_b64_tr_b16 a[100:101], v40 offset:0
    v_mfma_f32_16x16x32_bf16 v[112:115], a[44:47], a[92:95], v[112:115]
    ds_read_b64_tr_b16 a[102:103], v40 offset:2048
    buffer_load_dwordx4 a[24:27], v37, s[36:39], s5 offen offset:1024 sc1
    v_mfma_f32_16x16x32_bf16 v[56:59], a[48:51], a[80:83], v[56:59]
    ds_read_b64_tr_b16 a[104:105], v41 offset:0
    v_mfma_f32_16x16x32_bf16 v[76:79], a[48:51], a[84:87], v[76:79]
    ds_read_b64_tr_b16 a[106:107], v41 offset:2048
    v_mfma_f32_16x16x32_bf16 v[96:99], a[48:51], a[88:91], v[96:99]
    ds_read_b64_tr_b16 a[108:109], v42 offset:0
    v_mfma_f32_16x16x32_bf16 v[116:119], a[48:51], a[92:95], v[116:119]
    ds_read_b64_tr_b16 a[110:111], v42 offset:2048
    buffer_load_dwordx4 a[28:31], v37, s[36:39], s5 offen offset:2048 sc1
    v_mfma_f32_16x16x32_bf16 v[60:63], a[52:55], a[80:83], v[60:63]
    s_add_u32 s4, s4, s11
    s_cmp_eq_u32 s4, s8
    s_cselect_b32 s4, s7, s4
    s_nop 0
    v_mfma_f32_16x16x32_bf16 v[80:83], a[52:55], a[84:87], v[80:83]
    v_mfma_f32_16x16x32_bf16 v[100:103], a[52:55], a[88:91], v[100:103]
    v_mfma_f32_16x16x32_bf16 v[120:123], a[52:55], a[92:95], v[120:123]
    buffer_load_dwordx4 a[32:35], v37, s[36:39], s5 offen offset:3072 sc1
    v_mfma_f32_16x16x32_bf16 v[64:67], a[56:59], a[80:83], v[64:67]
    v_mfma_f32_16x16x32_bf16 v[84:87], a[56:59], a[84:87], v[84:87]
    v_mfma_f32_16x16x32_bf16 v[104:107], a[56:59], a[88:91], v[104:107]
    v_mfma_f32_16x16x32_bf16 v[124:127], a[56:59], a[92:95], v[124:127]
    buffer_load_dwordx4 a[36:39], v38, s[36:39], s5 offen offset:0 sc1
    s_add_u32 s5, s5, 40960
    s_cmp_eq_u32 s5, s10
    s_cselect_b32 s5, s9, s5
    s_waitcnt vmcnt(14) lgkmcnt(0)
    s_nop 0
    s_add_u32 m0, s6, 12288
    v_mfma_f32_16x16x32_bf16 v[48:51], a[60:63], a[96:99], v[48:51]
    buffer_load_dwordx4 v33, s[12:15], s4 offen offset:0 lds
    v_mfma_f32_16x16x32_bf16 v[68:71], a[60:63], a[100:103], v[68:71]
    buffer_load_dwordx4 v34, s[12:15], s4 offen offset:1024 lds
    v_mfma_f32_16x16x32_bf16 v[88:91], a[60:63], a[104:107], v[88:91]
    buffer_load_dwordx4 v35, s[12:15], s4 offen offset:2048 lds
    v_mfma_f32_16x16x32_bf16 v[108:111], a[60:63], a[108:111], v[108:111]
    buffer_load_dwordx4 v36, s[12:15], s4 offen offset:3072 lds
    buffer_load_dwordx4 a[40:43], v37, s[36:39], s5 offen offset:0 sc1
    v_mfma_f32_16x16x32_bf16 v[52:55], a[64:67], a[96:99], v[52:55]
    ds_read_b64_tr_b16 a[80:81], v39 offset:4096
    v_mfma_f32_16x16x32_bf16 v[72:75], a[64:67], a[100:103], v[72:75]
    ds_read_b64_tr_b16 a[82:83], v39 offset:6144
    v_mfma_f32_16x16x32_bf16 v[92:95], a[64:67], a[104:107], v[92:95]
    ds_read_b64_tr_b16 a[84:85], v40 offset:4096
    v_mfma_f32_16x16x32_bf16 v[112:115], a[64:67], a[108:111], v[112:115]
    ds_read_b64_tr_b16 a[86:87], v40 offset:6144
    buffer_load_dwordx4 a[44:47], v37, s[36:39], s5 offen offset:1024 sc1
    v_mfma_f32_16x16x32_bf16 v[56:59], a[68:71], a[96:99], v[56:59]
    ds_read_b64_tr_b16 a[88:89], v41 offset:4096
    v_mfma_f32_16x16x32_bf16 v[76:79], a[68:71], a[100:103], v[76:79]
    ds_read_b64_tr_b16 a[90:91], v41 offset:6144
    v_mfma_f32_16x16x32_bf16 v[96:99], a[68:71], a[104:107], v[96:99]
    ds_read_b64_tr_b16 a[92:93], v42 offset:4096
    v_mfma_f32_16x16x32_bf16 v[116:119], a[68:71], a[108:111], v[116:119]
    ds_read_b64_tr_b16 a[94:95], v42 offset:6144
    buffer_load_dwordx4 a[48:51], v37, s[36:39], s5 offen offset:2048 sc1
    v_mfma_f32_16x16x32_bf16 v[60:63], a[72:75], a[96:99], v[60:63]
    s_add_u32 s4, s4, s11
    s_cmp_eq_u32 s4, s8
    s_cselect_b32 s4, s7, s4
    s_nop 0
    v_mfma_f32_16x16x32_bf16 v[80:83], a[72:75], a[100:103], v[80:83]
    v_mfma_f32_16x16x32_bf16 v[100:103], a[72:75], a[104:107], v[100:103]
    v_mfma_f32_16x16x32_bf16 v[120:123], a[72:75], a[108:111], v[120:123]
    buffer_load_dwordx4 a[52:55], v37, s[36:39], s5 offen offset:3072 sc1
    v_mfma_f32_16x16x32_bf16 v[64:67], a[76:79], a[96:99], v[64:67]
    v_mfma_f32_16x16x32_bf16 v[84:87], a[76:79], a[100:103], v[84:87]
    v_mfma_f32_16x16x32_bf16 v[104:107], a[76:79], a[104:107], v[104:107]
    v_mfma_f32_16x16x32_bf16 v[124:127], a[76:79], a[108:111], v[124:127]
    buffer_load_dwordx4 a[56:59], v38, s[36:39], s5 offen offset:0 sc1
    s_add_u32 s5, s5, 40960
    s_cmp_eq_u32 s5, s10
    s_cselect_b32 s5, s9, s5
    s_waitcnt vmcnt(14) lgkmcnt(0)
    s_add_u32 m0, s6, 0
    v_mfma_f32_16x16x32_bf16 v[48:51], a[0:3], a[80:83], v[48:51]
    buffer_load_dwordx4 v33, s[12:15], s4 offen offset:0 lds
    v_mfma_f32_16x16x32_bf16 v[68:71], a[0:3], a[84:87], v[68:71]
    buffer_load_dwordx4 v34, s[12:15], s4 offen offset:1024 lds
    v_mfma_f32_16x16x32_bf16 v[88:91], a[0:3], a[88:91], v[88:91]
    buffer_load_dwordx4 v35, s[12:15], s4 offen offset:2048 lds
    v_mfma_f32_16x16x32_bf16 v[108:111], a[0:3], a[92:95], v[108:111]
    buffer_load_dwordx4 v36, s[12:15], s4 offen offset:3072 lds
    buffer_load_dwordx4 a[60:63], v37, s[36:39], s5 offen offset:0 sc1
    v_mfma_f32_16x16x32_bf16 v[52:55], a[4:7], a[80:83], v[52:55]
    ds_read_b64_tr_b16 a[96:97], v39 offset:8192
    v_mfma_f32_16x16x32_bf16 v[72:75], a[4:7], a[84:87], v[72:75]
    ds_read_b64_tr_b16 a[98:99], v39 offset:10240
    v_mfma_f32_16x16x32_bf16 v[92:95], a[4:7], a[88:91], v[92:95]
    ds_read_b64_tr_b16 a[100:101], v40 offset:8192
    v_mfma_f32_16x16x32_bf16 v[112:115], a[4:7], a[92:95], v[112:115]
    ds_read_b64_tr_b16 a[102:103], v40 offset:10240
    buffer_load_dwordx4 a[64:67], v37, s[36:39], s5 offen offset:1024 sc1
    v_mfma_f32_16x16x32_bf16 v[56:59], a[8:11], a[80:83], v[56:59]
    ds_read_b64_tr_b16 a[104:105], v41 offset:8192
    v_mfma_f32_16x16x32_bf16 v[76:79], a[8:11], a[84:87], v[76:79]
    ds_read_b64_tr_b16 a[106:107], v41 offset:10240
    v_mfma_f32_16x16x32_bf16 v[96:99], a[8:11], a[88:91], v[96:99]
    ds_read_b64_tr_b16 a[108:109], v42 offset:8192
    v_mfma_f32_16x16x32_bf16 v[116:119], a[8:11], a[92:95], v[116:119]
    ds_read_b64_tr_b16 a[110:111], v42 offset:10240
    buffer_load_dwordx4 a[68:71], v37, s[36:39], s5 offen offset:2048 sc1
    v_mfma_f32_16x16x32_bf16 v[60:63], a[12:15], a[80:83], v[60:63]
    s_add_u32 s4, s4, s11
    s_cmp_eq_u32 s4, s8
    s_cselect_b32 s4, s7, s4
    s_nop 0
    v_mfma_f32_16x16x32_bf16 v[80:83], a[12:15], a[84:87], v[80:83]
    v_mfma_f32_16x16x32_bf16 v[100:103], a[12:15], a[88:91], v[100:103]
    v_mfma_f32_16x16x32_bf16 v[120:123], a[12:15], a[92:95], v[120:123]
    buffer_load_dwordx4 a[72:75], v37, s[36:39], s5 offen offset:3072 sc1
    v_mfma_f32_16x16x32_bf16 v[64:67], a[16:19], a[80:83], v[64:67]
    v_mfma_f32_16x16x32_bf16 v[84:87], a[16:19], a[84:87], v[84:87]
    v_mfma_f32_16x16x32_bf16 v[104:107], a[16:19], a[88:91], v[104:107]
    v_mfma_f32_16x16x32_bf16 v[124:127], a[16:19], a[92:95], v[124:127]
    buffer_load_dwordx4 a[76:79], v38, s[36:39], s5 offen offset:0 sc1
    s_add_u32 s5, s5, 40960
    s_cmp_eq_u32 s5, s10
    s_cselect_b32 s5, s9, s5
    s_waitcnt vmcnt(14) lgkmcnt(0)
    s_nop 0
    v_mfma_f32_16x16x32_bf16 v[48:51], a[20:23], a[96:99], v[48:51]
    v_mfma_f32_16x16x32_bf16 v[68:71], a[20:23], a[100:103], v[68:71]
    v_mfma_f32_16x16x32_bf16 v[88:91], a[20:23], a[104:107], v[88:91]
    v_mfma_f32_16x16x32_bf16 v[108:111], a[20:23], a[108:111], v[108:111]
    v_mfma_f32_16x16x32_bf16 v[52:55], a[24:27], a[96:99], v[52:55]
    ds_read_b64_tr_b16 a[80:81], v39 offset:12288
    v_mfma_f32_16x16x32_bf16 v[72:75], a[24:27], a[100:103], v[72:75]
    ds_read_b64_tr_b16 a[82:83], v39 offset:14336
    v_mfma_f32_16x16x32_bf16 v[92:95], a[24:27], a[104:107], v[92:95]
    ds_read_b64_tr_b16 a[84:85], v40 offset:12288
    v_mfma_f32_16x16x32_bf16 v[112:115], a[24:27], a[108:111], v[112:115]
    ds_read_b64_tr_b16 a[86:87], v40 offset:14336
    v_mfma_f32_16x16x32_bf16 v[56:59], a[28:31], a[96:99], v[56:59]
    ds_read_b64_tr_b16 a[88:89], v41 offset:12288
    v_mfma_f32_16x16x32_bf16 v[76:79], a[28:31], a[100:103], v[76:79]
    ds_read_b64_tr_b16 a[90:91], v41 offset:14336
    v_mfma_f32_16x16x32_bf16 v[96:99], a[28:31], a[104:107], v[96:99]
    ds_read_b64_tr_b16 a[92:93], v42 offset:12288
    v_mfma_f32_16x16x32_bf16 v[116:119], a[28:31], a[108:111], v[116:119]
    ds_read_b64_tr_b16 a[94:95], v42 offset:14336
    v_mfma_f32_16x16x32_bf16 v[60:63], a[32:35], a[96:99], v[60:63]
    v_mfma_f32_16x16x32_bf16 v[80:83], a[32:35], a[100:103], v[80:83]
    v_mfma_f32_16x16x32_bf16 v[100:103], a[32:35], a[104:107], v[100:103]
    v_mfma_f32_16x16x32_bf16 v[120:123], a[32:35], a[108:111], v[120:123]
    v_mfma_f32_16x16x32_bf16 v[64:67], a[36:39], a[96:99], v[64:67]
    v_mfma_f32_16x16x32_bf16 v[84:87], a[36:39], a[100:103], v[84:87]
    v_mfma_f32_16x16x32_bf16 v[104:107], a[36:39], a[104:107], v[104:107]
    v_mfma_f32_16x16x32_bf16 v[124:127], a[36:39], a[108:111], v[124:127]
    s_waitcnt vmcnt(5) lgkmcnt(0)
    s_nop 0
    v_mfma_f32_16x16x32_bf16 v[48:51], a[40:43], a[80:83], v[48:51]
    v_mfma_f32_16x16x32_bf16 v[68:71], a[40:43], a[84:87], v[68:71]
    v_mfma_f32_16x16x32_bf16 v[88:91], a[40:43], a[88:91], v[88:91]
    v_mfma_f32_16x16x32_bf16 v[108:111], a[40:43], a[92:95], v[108:111]
    v_mfma_f32_16x16x32_bf16 v[52:55], a[44:47], a[80:83], v[52:55]
    ds_read_b64_tr_b16 a[96:97], v39 offset:0
    v_mfma_f32_16x16x32_bf16 v[72:75], a[44:47], a[84:87], v[72:75]
    ds_read_b64_tr_b16 a[98:99], v39 offset:2048
    v_mfma_f32_16x16x32_bf16 v[92:95], a[44:47], a[88:91], v[92:95]
    ds_read_b64_tr_b16 a[100:101], v40 offset:0
    v_mfma_f32_16x16x32_bf16 v[112:115], a[44:47], a[92:95], v[112:115]
    ds_read_b64_tr_b16 a[102:103], v40 offset:2048
    v_mfma_f32_16x16x32_bf16 v[56:59], a[48:51], a[80:83], v[56:59]
    ds_read_b64_tr_b16 a[104:105], v41 offset:0
    v_mfma_f32_16x16x32_bf16 v[76:79], a[48:51], a[84:87], v[76:79]
    ds_read_b64_tr_b16 a[106:107], v41 offset:2048
    v_mfma_f32_16x16x32_bf16 v[96:99], a[48:51], a[88:91], v[96:99]
    ds_read_b64_tr_b16 a[108:109], v42 offset:0
    v_mfma_f32_16x16x32_bf16 v[116:119], a[48:51], a[92:95], v[116:119]
    ds_read_b64_tr_b16 a[110:111], v42 offset:2048
    v_mfma_f32_16x16x32_bf16 v[60:63], a[52:55], a[80:83], v[60:63]
    v_mfma_f32_16x16x32_bf16 v[80:83], a[52:55], a[84:87], v[80:83]
    v_mfma_f32_16x16x32_bf16 v[100:103], a[52:55], a[88:91], v[100:103]
    v_mfma_f32_16x16x32_bf16 v[120:123], a[52:55], a[92:95], v[120:123]
    v_mfma_f32_16x16x32_bf16 v[64:67], a[56:59], a[80:83], v[64:67]
    v_mfma_f32_16x16x32_bf16 v[84:87], a[56:59], a[84:87], v[84:87]
    v_mfma_f32_16x16x32_bf16 v[104:107], a[56:59], a[88:91], v[104:107]
    v_mfma_f32_16x16x32_bf16 v[124:127], a[56:59], a[92:95], v[124:127]
    s_waitcnt vmcnt(0) lgkmcnt(0)
    s_nop 0
    v_mfma_f32_16x16x32_bf16 v[48:51], a[60:63], a[96:99], v[48:51]
    v_mfma_f32_16x16x32_bf16 v[68:71], a[60:63], a[100:103], v[68:71]
    v_mfma_f32_16x16x32_bf16 v[88:91], a[60:63], a[104:107], v[88:91]
    v_mfma_f32_16x16x32_bf16 v[108:111], a[60:63], a[108:111], v[108:111]
    v_mfma_f32_16x16x32_bf16 v[52:55], a[64:67], a[96:99], v[52:55]
    v_mfma_f32_16x16x32_bf16 v[72:75], a[64:67], a[100:103], v[72:75]
    v_mfma_f32_16x16x32_bf16 v[92:95], a[64:67], a[104:107], v[92:95]
    v_mfma_f32_16x16x32_bf16 v[112:115], a[64:67], a[108:111], v[112:115]
    v_mfma_f32_16x16x32_bf16 v[56:59], a[68:71], a[96:99], v[56:59]
    v_fma_f32 v128, v48, v8, v128
    v_fma_f32 v129, v49, v8, v129
    v_fma_f32 v130, v50, v8, v130
    v_fma_f32 v131, v51, v8, v131
    ds_write_b128 v4, v[128:131] offset:0
    v_mfma_f32_16x16x32_bf16 v[76:79], a[68:71], a[100:103], v[76:79]
    v_fma_f32 v148, v68, v9, v148
    v_fma_f32 v149, v69, v9, v149
    v_fma_f32 v150, v70, v9, v150
    v_fma_f32 v151, v71, v9, v151
    ds_write_b128 v4, v[148:151] offset:5376
    v_mfma_f32_16x16x32_bf16 v[96:99], a[68:71], a[104:107], v[96:99]
    v_fma_f32 v168, v88, v10, v168
    v_fma_f32 v169, v89, v10, v169
    v_fma_f32 v170, v90, v10, v170
    v_fma_f32 v171, v91, v10, v171
    ds_write_b128 v4, v[168:171] offset:10752
    v_mfma_f32_16x16x32_bf16 v[116:119], a[68:71], a[108:111], v[116:119]
    v_fma_f32 v188, v108, v11, v188
    v_fma_f32 v189, v109, v11, v189
    v_fma_f32 v190, v110, v11, v190
    v_fma_f32 v191, v111, v11, v191
    ds_write_b128 v4, v[188:191] offset:16128
    v_mfma_f32_16x16x32_bf16 v[60:63], a[72:75], a[96:99], v[60:63]
    v_fma_f32 v132, v52, v8, v132
    v_fma_f32 v133, v53, v8, v133
    v_fma_f32 v134, v54, v8, v134
    v_fma_f32 v135, v55, v8, v135
    ds_write_b128 v4, v[132:135] offset:64
    v_mfma_f32_16x16x32_bf16 v[80:83], a[72:75], a[100:103], v[80:83]
    v_fma_f32 v152, v72, v9, v152
    v_fma_f32 v153, v73, v9, v153
    v_fma_f32 v154, v74, v9, v154
    v_fma_f32 v155, v75, v9, v155
    ds_write_b128 v4, v[152:155] offset:5440
    v_mfma_f32_16x16x32_bf16 v[100:103], a[72:75], a[104:107], v[100:103]
    v_fma_f32 v172, v92, v10, v172
    v_fma_f32 v173, v93, v10, v173
    v_fma_f32 v174, v94, v10, v174
    v_fma_f32 v175, v95, v10, v175
    ds_write_b128 v4, v[172:175] offset:10816
    v_mfma_f32_16x16x32_bf16 v[120:123], a[72:75], a[108:111], v[120:123]
    v_fma_f32 v192, v112, v11, v192
    v_fma_f32 v193, v113, v11, v193
    v_fma_f32 v194, v114, v11, v194
    v_fma_f32 v195, v115, v11, v195
    ds_write_b128 v4, v[192:195] offset:16192
    v_mfma_f32_16x16x32_bf16 v[64:67], a[76:79], a[96:99], v[64:67]
    v_fma_f32 v136, v56, v8, v136
    v_fma_f32 v137, v57, v8, v137
    v_fma_f32 v138, v58, v8, v138
    v_fma_f32 v139, v59, v8, v139
    ds_write_b128 v4, v[136:139] offset:128
    v_mfma_f32_16x16x32_bf16 v[84:87], a[76:79], a[100:103], v[84:87]
    v_fma_f32 v156, v76, v9, v156
    v_fma_f32 v157, v77, v9, v157
    v_fma_f32 v158, v78, v9, v158
    v_fma_f32 v159, v79, v9, v159
    ds_write_b128 v4, v[156:159] offset:5504
    v_mfma_f32_16x16x32_bf16 v[104:107], a[76:79], a[104:107], v[104:107]
    v_fma_f32 v176, v96, v10, v176
    v_fma_f32 v177, v97, v10, v177
    v_fma_f32 v178, v98, v10, v178
    v_fma_f32 v179, v99, v10, v179
    ds_write_b128 v4, v[176:179] offset:10880
    v_mfma_f32_16x16x32_bf16 v[124:127], a[76:79], a[108:111], v[124:127]
    v_fma_f32 v196, v116, v11, v196
    v_fma_f32 v197, v117, v11, v197
    v_fma_f32 v198, v118, v11, v198
    v_fma_f32 v199, v119, v11, v199
    ds_write_b128 v4, v[196:199] offset:16256
    s_nop 3
    s_nop 0
    v_fma_f32 v140, v60, v8, v140
    v_fma_f32 v141, v61, v8, v141
    v_fma_f32 v142, v62, v8, v142
    v_fma_f32 v143, v63, v8, v143
    ds_write_b128 v4, v[140:143] offset:192
    v_fma_f32 v160, v80, v9, v160
    v_fma_f32 v161, v81, v9, v161
    v_fma_f32 v162, v82, v9, v162
    v_fma_f32 v163, v83, v9, v163
    ds_write_b128 v4, v[160:163] offset:5568
    v_fma_f32 v180, v100, v10, v180
    v_fma_f32 v181, v101, v10, v181
    v_fma_f32 v182, v102, v10, v182
    v_fma_f32 v183, v103, v10, v183
    ds_write_b128 v4, v[180:183] offset:10944
    v_fma_f32 v200, v120, v11, v200
    v_fma_f32 v201, v121, v11, v201
    v_fma_f32 v202, v122, v11, v202
    v_fma_f32 v203, v123, v11, v203
    ds_write_b128 v4, v[200:203] offset:16320
    v_fma_f32 v144, v64, v8, v144
    v_fma_f32 v145, v65, v8, v145
    v_fma_f32 v146, v66, v8, v146
    v_fma_f32 v147, v67, v8, v147
    ds_write_b128 v4, v[144:147] offset:256
    v_fma_f32 v164, v84, v9, v164
    v_fma_f32 v165, v85, v9, v165
    v_fma_f32 v166, v86, v9, v166
    v_fma_f32 v167, v87, v9, v167
    ds_write_b128 v4, v[164:167] offset:5632
    v_fma_f32 v184, v104, v10, v184
    v_fma_f32 v185, v105, v10, v185
    v_fma_f32 v186, v106, v10, v186
    v_fma_f32 v187, v107, v10, v187
    ds_write_b128 v4, v[184:187] offset:11008
    v_fma_f32 v204, v124, v11, v204
    v_fma_f32 v205, v125, v11, v205
    v_fma_f32 v206, v126, v11, v206
    v_fma_f32 v207, v127, v11, v207
    ds_write_b128 v4, v[204:207] offset:16384
    s_waitcnt lgkmcnt(0)
    s_barrier
    ds_read_b128 v[48:51], v16 offset:0
    ds_read_b128 v[52:55], v16 offset:21504
    ds_read_b128 v[56:59], v16 offset:43008
    ds_read_b128 v[60:63], v16 offset:64512
    ds_read_b128 v[64:67], v17 offset:0
    ds_read_b128 v[68:71], v17 offset:21504
    ds_read_b128 v[72:75], v17 offset:43008
    ds_read_b128 v[76:79], v17 offset:64512
    ds_read_b128 v[80:83], v18 offset:0
    ds_read_b128 v[84:87], v18 offset:21504
    ds_read_b128 v[88:91], v18 offset:43008
    ds_read_b128 v[92:95], v18 offset:64512
    s_waitcnt lgkmcnt(8)
    s_nop 0
    v_pk_add_f32 v[48:49], v[48:49], v[52:53]
    v_pk_add_f32 v[56:57], v[56:57], v[60:61]
    v_pk_add_f32 v[50:51], v[50:51], v[54:55]
    v_pk_add_f32 v[58:59], v[58:59], v[62:63]
    ds_read_b128 v[96:99], v19 offset:0
    ds_read_b128 v[100:103], v19 offset:21504
    ds_read_b128 v[104:107], v19 offset:43008
    ds_read_b128 v[108:111], v19 offset:64512
    v_pk_add_f32 v[48:49], v[48:49], v[56:57]
    v_pk_add_f32 v[50:51], v[50:51], v[58:59]
    v_cvt_pk_bf16_f32 v48, v48, v49
    v_cvt_pk_bf16_f32 v49, v50, v51
    buffer_store_dwordx2 v[48:49], v24, s[48:51], s95 offen nt
    s_waitcnt lgkmcnt(8)
    s_nop 0
    v_pk_add_f32 v[64:65], v[64:65], v[68:69]
    v_pk_add_f32 v[72:73], v[72:73], v[76:77]
    v_pk_add_f32 v[66:67], v[66:67], v[70:71]
    v_pk_add_f32 v[74:75], v[74:75], v[78:79]
    ds_read_b128 v[112:115], v20 offset:0
    ds_read_b128 v[116:119], v20 offset:21504
    ds_read_b128 v[120:123], v20 offset:43008
    ds_read_b128 v[124:127], v20 offset:64512
    v_pk_add_f32 v[64:65], v[64:65], v[72:73]
    v_pk_add_f32 v[66:67], v[66:67], v[74:75]
    v_cvt_pk_bf16_f32 v64, v64, v65
    v_cvt_pk_bf16_f32 v65, v66, v67
    buffer_store_dwordx2 v[64:65], v25, s[48:51], s95 offen nt
    s_waitcnt lgkmcnt(8)
    s_nop 0
    v_pk_add_f32 v[80:81], v[80:81], v[84:85]
    v_pk_add_f32 v[88:89], v[88:89], v[92:93]
    v_pk_add_f32 v[82:83], v[82:83], v[86:87]
    v_pk_add_f32 v[90:91], v[90:91], v[94:95]
    v_pk_add_f32 v[80:81], v[80:81], v[88:89]
    v_pk_add_f32 v[82:83], v[82:83], v[90:91]
    v_cvt_pk_bf16_f32 v80, v80, v81
    v_cvt_pk_bf16_f32 v81, v82, v83
    buffer_store_dwordx2 v[80:81], v26, s[48:51], s95 offen nt
    s_waitcnt lgkmcnt(4)
    s_nop 0
    v_pk_add_f32 v[96:97], v[96:97], v[100:101]
    v_pk_add_f32 v[104:105], v[104:105], v[108:109]
    v_pk_add_f32 v[98:99], v[98:99], v[102:103]
    v_pk_add_f32 v[106:107], v[106:107], v[110:111]
    v_pk_add_f32 v[96:97], v[96:97], v[104:105]
    v_pk_add_f32 v[98:99], v[98:99], v[106:107]
    v_cvt_pk_bf16_f32 v96, v96, v97
    v_cvt_pk_bf16_f32 v97, v98, v99
    buffer_store_dwordx2 v[96:97], v27, s[48:51], s95 offen nt
    s_waitcnt lgkmcnt(0)
    s_nop 0
    v_pk_add_f32 v[112:113], v[112:113], v[116:117]
    v_pk_add_f32 v[120:121], v[120:121], v[124:125]
    v_pk_add_f32 v[114:115], v[114:115], v[118:119]
    v_pk_add_f32 v[122:123], v[122:123], v[126:127]
    v_pk_add_f32 v[112:113], v[112:113], v[120:121]
    v_pk_add_f32 v[114:115], v[114:115], v[122:123]
    v_cvt_pk_bf16_f32 v112, v112, v113
    v_cvt_pk_bf16_f32 v113, v114, v115
    buffer_store_dwordx2 v[112:113], v28, s[48:51], s95 offen nt
k_end:
    s_endpgm
r_notkv:
    s_getpc_b64 s[86:87]
pc_here:
    s_sub_u32 s86, s86, pc_here-gated_mix__linear_attn_block__mixer_token_mlp__prompt_kernel
    s_subb_u32 s87, s87, 0
    s_sub_u32 s85, s82, 16
    s_lshl_b32 s85, s85, 2
    s_add_u32 s85, s85, s68
    s_lshl_b32 s85, s85, 3
    v_add_lshl_u32 v2, v1, s85, 7
    v_min_u32 v2, k_codeend-gated_mix__linear_attn_block__mixer_token_mlp__prompt_kernel-4, v2
    s_mov_b64 exec, 0xff
    global_load_dword a255, v2, s[86:87]
    s_mov_b64 exec, -1
    s_cmp_lt_u32 s82, 24
    s_cbranch_scc1 r_q
    s_sub_u32 s87, s82, 24
    s_lshl_b32 s85, s81, 3
    s_add_u32 s69, s85, s87
    v_lshrrev_b32 v2, 3, v1
    s_lshl_b32 s85, s68, 3
    v_add_u32 v2, s85, v2
    v_and_b32 v3, 7, v1
    v_lshlrev_b32 v3, 4, v3
    v_mul_u32_u24 v4, 1280, v2
    v_add_u32_e64 v4, v4, v3
    s_mul_i32 s85, s69, 40960
    s_waitcnt lgkmcnt(0)
    s_mov_b64 s[28:29], s[4:5]
    s_mov_b32 s30, 0x280000
    s_mov_b32 s31, 0x20000
    s_mov_b64 s[64:65], s[20:21]
    s_nop 0
    s_mov_b32 s66, 0x500
    s_mov_b32 s67, 0x20000
    buffer_load_dwordx4 v[48:51], v4, s[28:31], s85 offen offset:0
    buffer_load_dwordx4 v[52:55], v4, s[28:31], s85 offen offset:128
    buffer_load_dwordx4 v[56:59], v4, s[28:31], s85 offen offset:256
    buffer_load_dwordx4 v[60:63], v4, s[28:31], s85 offen offset:384
    buffer_load_dwordx4 v[64:67], v4, s[28:31], s85 offen offset:512
    buffer_load_dwordx4 v[68:71], v4, s[28:31], s85 offen offset:640
    buffer_load_dwordx4 v[72:75], v4, s[28:31], s85 offen offset:768
    buffer_load_dwordx4 v[76:79], v4, s[28:31], s85 offen offset:896
    buffer_load_dwordx4 v[80:83], v4, s[28:31], s85 offen offset:1024
    buffer_load_dwordx4 v[84:87], v4, s[28:31], s85 offen offset:1152
    buffer_load_dwordx4 v[88:91], v3, s[64:67], 0 offen offset:0
    buffer_load_dwordx4 v[92:95], v3, s[64:67], 0 offen offset:128
    buffer_load_dwordx4 v[96:99], v3, s[64:67], 0 offen offset:256
    buffer_load_dwordx4 v[100:103], v3, s[64:67], 0 offen offset:384
    buffer_load_dwordx4 v[104:107], v3, s[64:67], 0 offen offset:512
    buffer_load_dwordx4 v[108:111], v3, s[64:67], 0 offen offset:640
    buffer_load_dwordx4 v[112:115], v3, s[64:67], 0 offen offset:768
    buffer_load_dwordx4 v[116:119], v3, s[64:67], 0 offen offset:896
    buffer_load_dwordx4 v[120:123], v3, s[64:67], 0 offen offset:1024
    buffer_load_dwordx4 v[124:127], v3, s[64:67], 0 offen offset:1152
    v_mul_u32_u24 v16, 1312, v2
    v_add_u32 v16, v16, v3
    v_lshlrev_b32 v17, 2, v2
    s_add_u32 s86, s26, 0x974000
    s_addc_u32 s87, s27, 0
    s_load_dword s3, s[86:87], 0
    s_lshr_b32 s85, s82, 2
    s_lshl_b32 s88, s83, 3
    s_add_u32 s73, s85, s88
    s_and_b32 s85, s82, 3
    s_lshl_b32 s88, s84, 2
    s_add_u32 s74, s85, s88
    s_lshr_b32 s85, s82, 3
    s_lshl_b32 s85, s85, 3
    s_add_u32 s73, s85, s81
    s_and_b32 s74, s82, 7
    s_sub_u32 s85, s82, 8
    s_cmp_lt_u32 s82, 16
    s_cselect_b32 s85, s82, s85
    s_and_b32 s89, s85, 3
    s_add_u32 s71, s89, s88
    s_lshr_b32 s85, s85, 2
    s_lshl_b32 s88, s85, 2
    s_add_u32 s72, s83, s88
    s_lshr_b32 s88, s85, 2
    s_lshl_b32 s85, s85, 1
    s_add_u32 s85, s85, s88
    s_lshl_b32 s85, s85, 1
    s_mul_i32 s89, s89, 4
    s_add_u32 s85, s85, s89
    s_and_b32 s99, s85, 15
    s_mov_b64 s[36:37], s[26:27]
    s_mov_b32 s38, 0x982080
    s_mov_b32 s39, 0x20000
    s_mov_b64 s[40:41], s[12:13]
    s_mov_b32 s42, 0x600000
    s_mov_b32 s43, 0x20000
    s_mov_b64 s[56:57], s[14:15]
    s_mov_b32 s58, 0xc00
    s_mov_b32 s59, 0x20000
    s_mov_b64 s[44:45], s[16:17]
    s_mov_b32 s46, 0x600000
    s_mov_b32 s47, 0x20000
    s_mov_b64 s[60:61], s[18:19]
    s_mov_b32 s62, 0x1000
    s_mov_b32 s63, 0x20000
    s_mov_b64 s[48:49], s[22:23]
    s_mov_b32 s50, 0x280000
    s_mov_b32 s51, 0x20000
    s_mov_b64 s[12:13], s[40:41]
    s_mov_b64 s[14:15], s[42:43]
    s_mul_i32 s7, s68, 1572864
    s_lshl_b32 s85, s72, 7
    s_add_u32 s7, s7, s85
    s_add_u32 s8, s7, 1572864
    s_mul_i32 s85, s99, 98304
    s_add_u32 s4, s7, s85
    s_mul_i32 s9, s68, 655360
    s_mul_i32 s85, s71, 5120
    s_add_u32 s9, s9, s85
    s_add_u32 s10, s9, 655360
    s_mul_i32 s85, s99, 40960
    s_add_u32 s5, s9, s85
    s_mov_b32 s11, 98304
    s_lshl_b32 s6, s68, 14
    s_and_b32 s85, s82, 3
    s_mul_i32 s85, s85, 3
    s_lshr_b32 s86, s82, 2
    s_mul_i32 s86, s86, 3
    s_lshr_b32 s86, s86, 1
    s_add_u32 s85, s85, s86
    s_cmp_ge_u32 s85, 12
    s_cselect_b32 s86, 12, 0
    s_sub_u32 s85, s85, s86
    s_add_u32 s85, s73, s74
    s_and_b32 s85, s85, 1
    s_mul_i32 s85, s85, 6
    s_mul_i32 s18, s68, 1572864
    s_lshl_b32 s86, s73, 7
    s_add_u32 s18, s18, s86
    s_add_u32 s19, s18, 1572864
    s_lshl_b32 s86, s85, 17
    s_add_u32 s17, s18, s86
    s_mul_i32 s21, s68, 491520
    s_mul_i32 s86, s74, 5120
    s_add_u32 s21, s21, s86
    s_add_u32 s21, s21, 0x280000
    s_add_u32 s22, s21, 491520
    s_mul_i32 s86, s85, 40960
    s_add_u32 s20, s21, s86
    v_lshlrev_b32_e64 v37, 4, v1
    v_add_u32 v38, 4096, v37
    v_lshrrev_b32 v2, 2, v1
    v_lshrrev_b32 v3, 1, v2
    v_and_b32 v3, 3, v3
    v_lshlrev_b32 v2, 7, v2
    v_lshl_add_u32 v2, v3, 5, v2
    v_and_b32_e64 v3, 3, v1
    v_lshl_add_u32 v2, v3, 3, v2
    v_add_u32 v39, s6, v2
    v_xor_b32 v40, 32, v39
    v_xor_b32_e64 v41, 64, v39
    v_xor_b32 v42, 96, v39
    v_lshrrev_b32 v2, 3, v1
    v_lshrrev_b32 v3, 4, v1
    v_lshlrev_b32 v3, 1, v3
    v_and_b32 v4, 7, v1
    v_xor_b32 v3, v3, v4
    v_lshlrev_b32 v3, 4, v3
    v_mul_u32_u24 v4, 3072, v2
    v_add_u32_e64 v33, v3, v4
    v_add_u32 v34, 23552, v33
    v_add_u32 v35, 47104, v33
    v_add_u32 v36, 70656, v33
    v_mul_u32_u24 v4, 4096, v2
    v_add_u32_e64 v43, v3, v4
    v_add_u32 v44, 31744, v43
    v_add_u32 v45, 63488, v43
    v_add_u32 v46, 95232, v43
    v_and_b32 v13, 15, v1
    s_mul_i32 s85, s68, 16
    v_add_lshl_u32 v13, v13, s85, 7
    v_lshlrev_b32_e64 v15, 7, v1
    s_mov_b32 s24, 0x974080
    s_mov_b32 s25, 0x97a080
    s_waitcnt lgkmcnt(0)
    s_mul_i32 s16, s3, 0x41C64E6D
    s_add_u32 s16, s16, 0x3C6EF35F
    v_and_b32 v2, 15, v1
    v_lshrrev_b32 v3, 4, v1
    v_xor_b32 v4, v2, v3
    v_lshlrev_b32_e64 v4, 4, v4
    v_lshl_add_u32 v4, v2, 8, v4
    s_mul_i32 s85, s68, 20480
    s_add_u32 s85, s85, 65536
    v_add_u32 v224, s85, v4
    v_xor_b32 v225, 64, v224
    v_xor_b32 v226, 128, v224
    v_xor_b32 v227, 192, v224
    s_and_b32 s85, s68, 1
    s_lshr_b32 s86, s68, 1
    s_lshl_b32 s87, s85, 7
    v_xor_b32_e64 v4, s87, v4
    s_lshl_b32 s87, s86, 12
    s_add_u32 s87, s87, 65536
    v_add_u32 v228, s87, v4
    v_xor_b32 v229, 64, v228
    v_add_u32 v230, 40960, v228
    v_add_u32 v231, 40960, v229
    s_lshl_b32 s87, s72, 1
    s_add_u32 s87, s87, s85
    s_lshl_b32 s23, s87, 6
    v_lshlrev_b32_e64 v12, 3, v3
    s_mul_i32 s87, s87, 40
    s_mul_i32 s88, s71, 5
    s_add_u32 s87, s87, s88
    s_add_u32 s87, s87, s86
    s_lshl_b32 s87, s87, 10
    s_add_u32 s52, s87, 0x280000
    s_add_u32 s53, s52, 4096
    s_mov_b32 s90, 0xbdd2d3e8
    s_mov_b32 s91, 0xbdd2d3e8
    v_mov_b32 v232, 0xc0135761
    v_mov_b32 v233, 0xc0135761
    s_and_b32 s94, s74, 3
    s_lshl_b32 s94, s94, 1
    s_and_b32 s89, s73, 7
    s_add_u32 s94, s94, s89
    s_mul_i32 s89, s94, 52
    s_lshr_b32 s89, s89, 8
    s_mul_i32 s89, s89, 5
    s_sub_u32 s94, s94, s89
    s_add_u32 s94, s73, s74
    s_and_b32 s94, s94, 1
    s_mul_i32 s94, s94, 3
    s_mul_i32 s86, s68, 5
    s_add_u32 s86, s86, s94
    s_mul_i32 s54, s73, 20
    s_add_u32 s54, s54, s86
    s_lshl_b32 s54, s54, 12
    s_add_u32 s54, s54, 0x460000
    s_mul_i32 s55, s86, 40960
    s_mul_i32 s89, s74, 5120
    s_add_u32 s55, s55, s89
    s_add_u32 s55, s55, 0x6e0000
    s_sub_u32 s88, s82, 24
    s_lshl_b32 s88, s88, 2
    s_add_u32 s88, s88, s68
    v_and_b32_e64 v22, 31, v1
    v_mul_u32_u24 v22, 3072, v22
    v_lshrrev_b32_e64 v3, 5, v1
    v_lshl_add_u32 v22, v3, 9, v22
    s_mul_i32 s85, s88, 98304
    s_lshl_b32 s86, s83, 7
    s_add_u32 s85, s85, s86
    s_mul_i32 s86, s84, 3145728
    s_add_u32 s26, s86, s85
    s_xor_b32 s87, s84, 1
    s_mul_i32 s87, s87, 3145728
    s_add_u32 s27, s87, s85
    buffer_load_dword a255, v22, s[40:43], s26 offen offset:0
    v_mov_b32 v5, 0x3f803f80
    v_mov_b32 v8, 0
    v_mov_b32 v9, 0
    v_mov_b32 v10, 0
    v_mov_b32 v11, 0
    s_waitcnt vmcnt(11)
    v_dot2_f32_bf16 v8, v48, v5, v8
    v_dot2_f32_bf16 v9, v49, v5, v9
    v_dot2_f32_bf16 v8, v50, v5, v8
    v_dot2_f32_bf16 v9, v51, v5, v9
    v_dot2_f32_bf16 v8, v52, v5, v8
    v_dot2_f32_bf16 v9, v53, v5, v9
    v_dot2_f32_bf16 v8, v54, v5, v8
    v_dot2_f32_bf16 v9, v55, v5, v9
    v_dot2_f32_bf16 v8, v56, v5, v8
    v_dot2_f32_bf16 v9, v57, v5, v9
    v_dot2_f32_bf16 v8, v58, v5, v8
    v_dot2_f32_bf16 v9, v59, v5, v9
    v_dot2_f32_bf16 v8, v60, v5, v8
    v_dot2_f32_bf16 v9, v61, v5, v9
    v_dot2_f32_bf16 v8, v62, v5, v8
    v_dot2_f32_bf16 v9, v63, v5, v9
    v_dot2_f32_bf16 v8, v64, v5, v8
    v_dot2_f32_bf16 v9, v65, v5, v9
    v_dot2_f32_bf16 v8, v66, v5, v8
    v_dot2_f32_bf16 v9, v67, v5, v9
    v_dot2_f32_bf16 v8, v68, v5, v8
    v_dot2_f32_bf16 v9, v69, v5, v9
    v_dot2_f32_bf16 v8, v70, v5, v8
    v_dot2_f32_bf16 v9, v71, v5, v9
    v_dot2_f32_bf16 v8, v72, v5, v8
    v_dot2_f32_bf16 v9, v73, v5, v9
    v_dot2_f32_bf16 v8, v74, v5, v8
    v_dot2_f32_bf16 v9, v75, v5, v9
    v_dot2_f32_bf16 v8, v76, v5, v8
    v_dot2_f32_bf16 v9, v77, v5, v9
    v_dot2_f32_bf16 v8, v78, v5, v8
    v_dot2_f32_bf16 v9, v79, v5, v9
    v_dot2_f32_bf16 v8, v80, v5, v8
    v_dot2_f32_bf16 v9, v81, v5, v9
    v_dot2_f32_bf16 v8, v82, v5, v8
    v_dot2_f32_bf16 v9, v83, v5, v9
    v_dot2_f32_bf16 v8, v84, v5, v8
    v_dot2_f32_bf16 v9, v85, v5, v9
    v_dot2_f32_bf16 v8, v86, v5, v8
    v_dot2_f32_bf16 v9, v87, v5, v9
    s_waitcnt vmcnt(1)
    s_nop 0
    v_dot2_f32_bf16 v10, v48, v88, v10
    v_dot2_f32_bf16 v11, v49, v89, v11
    v_dot2_f32_bf16 v10, v50, v90, v10
    v_dot2_f32_bf16 v11, v51, v91, v11
    v_dot2_f32_bf16 v10, v52, v92, v10
    v_dot2_f32_bf16 v11, v53, v93, v11
    v_dot2_f32_bf16 v10, v54, v94, v10
    v_dot2_f32_bf16 v11, v55, v95, v11
    v_dot2_f32_bf16 v10, v56, v96, v10
    v_dot2_f32_bf16 v11, v57, v97, v11
    v_dot2_f32_bf16 v10, v58, v98, v10
    v_dot2_f32_bf16 v11, v59, v99, v11
    v_dot2_f32_bf16 v10, v60, v100, v10
    v_dot2_f32_bf16 v11, v61, v101, v11
    v_dot2_f32_bf16 v10, v62, v102, v10
    v_dot2_f32_bf16 v11, v63, v103, v11
    v_dot2_f32_bf16 v10, v64, v104, v10
    v_dot2_f32_bf16 v11, v65, v105, v11
    v_dot2_f32_bf16 v10, v66, v106, v10
    v_dot2_f32_bf16 v11, v67, v107, v11
    v_dot2_f32_bf16 v10, v68, v108, v10
    v_dot2_f32_bf16 v11, v69, v109, v11
    v_dot2_f32_bf16 v10, v70, v110, v10
    v_dot2_f32_bf16 v11, v71, v111, v11
    v_dot2_f32_bf16 v10, v72, v112, v10
    v_dot2_f32_bf16 v11, v73, v113, v11
    v_dot2_f32_bf16 v10, v74, v114, v10
    v_dot2_f32_bf16 v11, v75, v115, v11
    v_dot2_f32_bf16 v10, v76, v116, v10
    v_dot2_f32_bf16 v11, v77, v117, v11
    v_dot2_f32_bf16 v10, v78, v118, v10
    v_dot2_f32_bf16 v11, v79, v119, v11
    v_dot2_f32_bf16 v10, v80, v120, v10
    v_dot2_f32_bf16 v11, v81, v121, v11
    v_dot2_f32_bf16 v10, v82, v122, v10
    v_dot2_f32_bf16 v11, v83, v123, v11
    v_dot2_f32_bf16 v10, v84, v124, v10
    v_dot2_f32_bf16 v11, v85, v125, v11
    v_dot2_f32_bf16 v10, v86, v126, v10
    v_dot2_f32_bf16 v11, v87, v127, v11
    s_nop 2
    v_add_f32 v8, v8, v9
    v_add_f32 v10, v10, v11
    s_nop 1
    v_add_f32_dpp v8, v8, v8 quad_perm:[1,0,3,2] row_mask:0xf bank_mask:0xf
    v_add_f32_dpp v10, v10, v10 quad_perm:[1,0,3,2] row_mask:0xf bank_mask:0xf
    s_nop 1
    v_add_f32_dpp v8, v8, v8 quad_perm:[2,3,0,1] row_mask:0xf bank_mask:0xf
    v_add_f32_dpp v10, v10, v10 quad_perm:[2,3,0,1] row_mask:0xf bank_mask:0xf
    s_nop 1
    v_add_f32_dpp v8, v8, v8 row_half_mirror row_mask:0xf bank_mask:0xf
    v_add_f32_dpp v10, v10, v10 row_half_mirror row_mask:0xf bank_mask:0xf
    v_mul_f32 v8, 0xbacccccd, v8
    v_mov_b32_e64 v9, v8
    v_mul_f32 v10, 0xbfb8aa3b, v10
    v_exp_f32 v10, v10
    v_lshlrev_b32 v128, 16, v48
    v_and_b32 v129, 0xffff0000, v48
    v_lshlrev_b32_e64 v130, 16, v49
    v_and_b32 v131, 0xffff0000, v49
    v_lshlrev_b32_e64 v132, 16, v50
    v_and_b32 v133, 0xffff0000, v50
    v_lshlrev_b32_e64 v134, 16, v51
    v_and_b32 v135, 0xffff0000, v51
    v_lshlrev_b32_e64 v136, 16, v52
    v_and_b32 v137, 0xffff0000, v52
    v_lshlrev_b32_e64 v138, 16, v53
    v_and_b32 v139, 0xffff0000, v53
    v_lshlrev_b32_e64 v140, 16, v54
    v_and_b32 v141, 0xffff0000, v54
    v_lshlrev_b32_e64 v142, 16, v55
    v_and_b32 v143, 0xffff0000, v55
    v_lshlrev_b32_e64 v144, 16, v56
    v_and_b32 v145, 0xffff0000, v56
    v_lshlrev_b32_e64 v146, 16, v57
    v_and_b32 v147, 0xffff0000, v57
    v_lshlrev_b32_e64 v148, 16, v58
    v_and_b32 v149, 0xffff0000, v58
    v_lshlrev_b32_e64 v150, 16, v59
    v_and_b32 v151, 0xffff0000, v59
    v_lshlrev_b32_e64 v152, 16, v60
    v_and_b32 v153, 0xffff0000, v60
    v_lshlrev_b32_e64 v154, 16, v61
    v_and_b32 v155, 0xffff0000, v61
    v_lshlrev_b32_e64 v156, 16, v62
    v_and_b32 v157, 0xffff0000, v62
    v_lshlrev_b32_e64 v158, 16, v63
    v_and_b32 v159, 0xffff0000, v63
    v_lshlrev_b32_e64 v160, 16, v64
    v_and_b32 v161, 0xffff0000, v64
    v_lshlrev_b32_e64 v162, 16, v65
    v_and_b32 v163, 0xffff0000, v65
    v_lshlrev_b32_e64 v164, 16, v66
    v_and_b32 v165, 0xffff0000, v66
    v_lshlrev_b32_e64 v166, 16, v67
    v_and_b32 v167, 0xffff0000, v67
    v_lshlrev_b32_e64 v168, 16, v68
    v_and_b32 v169, 0xffff0000, v68
    v_lshlrev_b32_e64 v170, 16, v69
    v_and_b32 v171, 0xffff0000, v69
    v_lshlrev_b32_e64 v172, 16, v70
    v_and_b32 v173, 0xffff0000, v70
    v_lshlrev_b32_e64 v174, 16, v71
    v_and_b32 v175, 0xffff0000, v71
    v_lshlrev_b32_e64 v176, 16, v72
    v_and_b32 v177, 0xffff0000, v72
    v_lshlrev_b32_e64 v178, 16, v73
    v_and_b32 v179, 0xffff0000, v73
    v_lshlrev_b32_e64 v180, 16, v74
    v_and_b32 v181, 0xffff0000, v74
    v_lshlrev_b32_e64 v182, 16, v75
    v_and_b32 v183, 0xffff0000, v75
    v_lshlrev_b32_e64 v184, 16, v76
    v_and_b32 v185, 0xffff0000, v76
    v_lshlrev_b32_e64 v186, 16, v77
    v_and_b32 v187, 0xffff0000, v77
    v_lshlrev_b32_e64 v188, 16, v78
    v_and_b32 v189, 0xffff0000, v78
    v_lshlrev_b32_e64 v190, 16, v79
    v_and_b32 v191, 0xffff0000, v79
    v_lshlrev_b32_e64 v192, 16, v80
    v_and_b32 v193, 0xffff0000, v80
    v_lshlrev_b32_e64 v194, 16, v81
    v_and_b32 v195, 0xffff0000, v81
    v_lshlrev_b32_e64 v196, 16, v82
    v_and_b32 v197, 0xffff0000, v82
    v_lshlrev_b32_e64 v198, 16, v83
    v_and_b32 v199, 0xffff0000, v83
    v_lshlrev_b32_e64 v200, 16, v84
    v_and_b32 v201, 0xffff0000, v84
    v_lshlrev_b32_e64 v202, 16, v85
    v_and_b32 v203, 0xffff0000, v85
    v_lshlrev_b32_e64 v204, 16, v86
    v_and_b32 v205, 0xffff0000, v86
    v_lshlrev_b32_e64 v206, 16, v87
    v_and_b32 v207, 0xffff0000, v87
    v_add_f32 v10, 1.0, v10
    v_rcp_f32 v10, v10
    v_pk_add_f32 v[128:129], v[128:129], v[8:9]
    v_pk_add_f32 v[130:131], v[130:131], v[8:9]
    v_pk_add_f32 v[132:133], v[132:133], v[8:9]
    v_pk_add_f32 v[134:135], v[134:135], v[8:9]
    v_pk_add_f32 v[136:137], v[136:137], v[8:9]
    v_pk_add_f32 v[138:139], v[138:139], v[8:9]
    v_pk_add_f32 v[140:141], v[140:141], v[8:9]
    v_pk_add_f32 v[142:143], v[142:143], v[8:9]
    v_pk_add_f32 v[144:145], v[144:145], v[8:9]
    v_pk_add_f32 v[146:147], v[146:147], v[8:9]
    v_pk_add_f32 v[148:149], v[148:149], v[8:9]
    v_pk_add_f32 v[150:151], v[150:151], v[8:9]
    v_pk_add_f32 v[152:153], v[152:153], v[8:9]
    v_pk_add_f32 v[154:155], v[154:155], v[8:9]
    v_pk_add_f32 v[156:157], v[156:157], v[8:9]
    v_pk_add_f32 v[158:159], v[158:159], v[8:9]
    v_pk_add_f32 v[160:161], v[160:161], v[8:9]
    v_pk_add_f32 v[162:163], v[162:163], v[8:9]
    v_pk_add_f32 v[164:165], v[164:165], v[8:9]
    v_pk_add_f32 v[166:167], v[166:167], v[8:9]
    v_pk_add_f32 v[168:169], v[168:169], v[8:9]
    v_pk_add_f32 v[170:171], v[170:171], v[8:9]
    v_pk_add_f32 v[172:173], v[172:173], v[8:9]
    v_pk_add_f32 v[174:175], v[174:175], v[8:9]
    v_pk_add_f32 v[176:177], v[176:177], v[8:9]
    v_pk_add_f32 v[178:179], v[178:179], v[8:9]
    v_pk_add_f32 v[180:181], v[180:181], v[8:9]
    v_pk_add_f32 v[182:183], v[182:183], v[8:9]
    v_pk_add_f32 v[184:185], v[184:185], v[8:9]
    v_pk_add_f32 v[186:187], v[186:187], v[8:9]
    v_pk_add_f32 v[188:189], v[188:189], v[8:9]
    v_pk_add_f32 v[190:191], v[190:191], v[8:9]
    v_pk_add_f32 v[192:193], v[192:193], v[8:9]
    v_pk_add_f32 v[194:195], v[194:195], v[8:9]
    v_pk_add_f32 v[196:197], v[196:197], v[8:9]
    v_pk_add_f32 v[198:199], v[198:199], v[8:9]
    v_pk_add_f32 v[200:201], v[200:201], v[8:9]
    v_pk_add_f32 v[202:203], v[202:203], v[8:9]
    v_pk_add_f32 v[204:205], v[204:205], v[8:9]
    v_pk_add_f32 v[206:207], v[206:207], v[8:9]
    v_pk_mul_f32 v[18:19], v[128:129], v[128:129]
    v_pk_mul_f32 v[20:21], v[130:131], v[130:131]
    v_pk_fma_f32 v[18:19], v[132:133], v[132:133], v[18:19]
    v_pk_fma_f32 v[20:21], v[134:135], v[134:135], v[20:21]
    v_pk_fma_f32 v[18:19], v[136:137], v[136:137], v[18:19]
    v_pk_fma_f32 v[20:21], v[138:139], v[138:139], v[20:21]
    v_pk_fma_f32 v[18:19], v[140:141], v[140:141], v[18:19]
    v_pk_fma_f32 v[20:21], v[142:143], v[142:143], v[20:21]
    v_pk_fma_f32 v[18:19], v[144:145], v[144:145], v[18:19]
    v_pk_fma_f32 v[20:21], v[146:147], v[146:147], v[20:21]
    v_pk_fma_f32 v[18:19], v[148:149], v[148:149], v[18:19]
    v_pk_fma_f32 v[20:21], v[150:151], v[150:151], v[20:21]
    v_pk_fma_f32 v[18:19], v[152:153], v[152:153], v[18:19]
    v_pk_fma_f32 v[20:21], v[154:155], v[154:155], v[20:21]
    v_pk_fma_f32 v[18:19], v[156:157], v[156:157], v[18:19]
    v_pk_fma_f32 v[20:21], v[158:159], v[158:159], v[20:21]
    v_pk_fma_f32 v[18:19], v[160:161], v[160:161], v[18:19]
    v_pk_fma_f32 v[20:21], v[162:163], v[162:163], v[20:21]
    v_pk_fma_f32 v[18:19], v[164:165], v[164:165], v[18:19]
    v_pk_fma_f32 v[20:21], v[166:167], v[166:167], v[20:21]
    v_pk_fma_f32 v[18:19], v[168:169], v[168:169], v[18:19]
    v_pk_fma_f32 v[20:21], v[170:171], v[170:171], v[20:21]
    v_pk_fma_f32 v[18:19], v[172:173], v[172:173], v[18:19]
    v_pk_fma_f32 v[20:21], v[174:175], v[174:175], v[20:21]
    v_pk_fma_f32 v[18:19], v[176:177], v[176:177], v[18:19]
    v_pk_fma_f32 v[20:21], v[178:179], v[178:179], v[20:21]
    v_pk_fma_f32 v[18:19], v[180:181], v[180:181], v[18:19]
    v_pk_fma_f32 v[20:21], v[182:183], v[182:183], v[20:21]
    v_pk_fma_f32 v[18:19], v[184:185], v[184:185], v[18:19]
    v_pk_fma_f32 v[20:21], v[186:187], v[186:187], v[20:21]
    v_pk_fma_f32 v[18:19], v[188:189], v[188:189], v[18:19]
    v_pk_fma_f32 v[20:21], v[190:191], v[190:191], v[20:21]
    v_pk_fma_f32 v[18:19], v[192:193], v[192:193], v[18:19]
    v_pk_fma_f32 v[20:21], v[194:195], v[194:195], v[20:21]
    v_pk_fma_f32 v[18:19], v[196:197], v[196:197], v[18:19]
    v_pk_fma_f32 v[20:21], v[198:199], v[198:199], v[20:21]
    v_pk_fma_f32 v[18:19], v[200:201], v[200:201], v[18:19]
    v_pk_fma_f32 v[20:21], v[202:203], v[202:203], v[20:21]
    v_pk_fma_f32 v[18:19], v[204:205], v[204:205], v[18:19]
    v_pk_fma_f32 v[20:21], v[206:207], v[206:207], v[20:21]
    v_pk_add_f32 v[18:19], v[18:19], v[20:21]
    ds_write_b32 v17, v10 offset:49152
    v_add_f32 v18, v18, v19
    s_nop 1
    v_add_f32_dpp v18, v18, v18 quad_perm:[1,0,3,2] row_mask:0xf bank_mask:0xf
    s_nop 1
    v_add_f32_dpp v18, v18, v18 quad_perm:[2,3,0,1] row_mask:0xf bank_mask:0xf
    s_nop 1
    v_add_f32_dpp v18, v18, v18 row_half_mirror row_mask:0xf bank_mask:0xf
    v_mov_b32 v19, 0x3727c5ac
    v_fmac_f32 v19, 0x3acccccd, v18
    v_rsq_f32 v18, v19
    s_nop 0
    v_mov_b32_e64 v19, v18
    v_pk_mul_f32 v[128:129], v[128:129], v[18:19]
    v_cvt_pk_bf16_f32 v48, v128, v129
    v_pk_mul_f32 v[130:131], v[130:131], v[18:19]
    v_cvt_pk_bf16_f32 v49, v130, v131
    v_pk_mul_f32 v[132:133], v[132:133], v[18:19]
    v_cvt_pk_bf16_f32 v50, v132, v133
    v_pk_mul_f32 v[134:135], v[134:135], v[18:19]
    v_cvt_pk_bf16_f32 v51, v134, v135
    ds_write_b128 v16, v[48:51] offset:0
    v_pk_mul_f32 v[136:137], v[136:137], v[18:19]
    v_cvt_pk_bf16_f32 v52, v136, v137
    v_pk_mul_f32 v[138:139], v[138:139], v[18:19]
    v_cvt_pk_bf16_f32 v53, v138, v139
    v_pk_mul_f32 v[140:141], v[140:141], v[18:19]
    v_cvt_pk_bf16_f32 v54, v140, v141
    v_pk_mul_f32 v[142:143], v[142:143], v[18:19]
    v_cvt_pk_bf16_f32 v55, v142, v143
    ds_write_b128 v16, v[52:55] offset:128
    v_pk_mul_f32 v[144:145], v[144:145], v[18:19]
    v_cvt_pk_bf16_f32 v56, v144, v145
    v_pk_mul_f32 v[146:147], v[146:147], v[18:19]
    v_cvt_pk_bf16_f32 v57, v146, v147
    v_pk_mul_f32 v[148:149], v[148:149], v[18:19]
    v_cvt_pk_bf16_f32 v58, v148, v149
    v_pk_mul_f32 v[150:151], v[150:151], v[18:19]
    v_cvt_pk_bf16_f32 v59, v150, v151
    ds_write_b128 v16, v[56:59] offset:256
    v_pk_mul_f32 v[152:153], v[152:153], v[18:19]
    v_cvt_pk_bf16_f32 v60, v152, v153
    v_pk_mul_f32 v[154:155], v[154:155], v[18:19]
    v_cvt_pk_bf16_f32 v61, v154, v155
    v_pk_mul_f32 v[156:157], v[156:157], v[18:19]
    v_cvt_pk_bf16_f32 v62, v156, v157
    v_pk_mul_f32 v[158:159], v[158:159], v[18:19]
    v_cvt_pk_bf16_f32 v63, v158, v159
    ds_write_b128 v16, v[60:63] offset:384
    v_pk_mul_f32 v[160:161], v[160:161], v[18:19]
    v_cvt_pk_bf16_f32 v64, v160, v161
    v_pk_mul_f32 v[162:163], v[162:163], v[18:19]
    v_cvt_pk_bf16_f32 v65, v162, v163
    v_pk_mul_f32 v[164:165], v[164:165], v[18:19]
    v_cvt_pk_bf16_f32 v66, v164, v165
    v_pk_mul_f32 v[166:167], v[166:167], v[18:19]
    v_cvt_pk_bf16_f32 v67, v166, v167
    ds_write_b128 v16, v[64:67] offset:512
    v_pk_mul_f32 v[168:169], v[168:169], v[18:19]
    v_cvt_pk_bf16_f32 v68, v168, v169
    v_pk_mul_f32 v[170:171], v[170:171], v[18:19]
    v_cvt_pk_bf16_f32 v69, v170, v171
    v_pk_mul_f32 v[172:173], v[172:173], v[18:19]
    v_cvt_pk_bf16_f32 v70, v172, v173
    v_pk_mul_f32 v[174:175], v[174:175], v[18:19]
    v_cvt_pk_bf16_f32 v71, v174, v175
    ds_write_b128 v16, v[68:71] offset:640
    v_pk_mul_f32 v[176:177], v[176:177], v[18:19]
    v_cvt_pk_bf16_f32 v72, v176, v177
    v_pk_mul_f32 v[178:179], v[178:179], v[18:19]
    v_cvt_pk_bf16_f32 v73, v178, v179
    v_pk_mul_f32 v[180:181], v[180:181], v[18:19]
    v_cvt_pk_bf16_f32 v74, v180, v181
    v_pk_mul_f32 v[182:183], v[182:183], v[18:19]
    v_cvt_pk_bf16_f32 v75, v182, v183
    ds_write_b128 v16, v[72:75] offset:768
    v_pk_mul_f32 v[184:185], v[184:185], v[18:19]
    v_cvt_pk_bf16_f32 v76, v184, v185
    v_pk_mul_f32 v[186:187], v[186:187], v[18:19]
    v_cvt_pk_bf16_f32 v77, v186, v187
    v_pk_mul_f32 v[188:189], v[188:189], v[18:19]
    v_cvt_pk_bf16_f32 v78, v188, v189
    v_pk_mul_f32 v[190:191], v[190:191], v[18:19]
    v_cvt_pk_bf16_f32 v79, v190, v191
    ds_write_b128 v16, v[76:79] offset:896
    v_pk_mul_f32 v[192:193], v[192:193], v[18:19]
    v_cvt_pk_bf16_f32 v80, v192, v193
    v_pk_mul_f32 v[194:195], v[194:195], v[18:19]
    v_cvt_pk_bf16_f32 v81, v194, v195
    v_pk_mul_f32 v[196:197], v[196:197], v[18:19]
    v_cvt_pk_bf16_f32 v82, v196, v197
    v_pk_mul_f32 v[198:199], v[198:199], v[18:19]
    v_cvt_pk_bf16_f32 v83, v198, v199
    ds_write_b128 v16, v[80:83] offset:1024
    v_pk_mul_f32 v[200:201], v[200:201], v[18:19]
    v_cvt_pk_bf16_f32 v84, v200, v201
    v_pk_mul_f32 v[202:203], v[202:203], v[18:19]
    v_cvt_pk_bf16_f32 v85, v202, v203
    v_pk_mul_f32 v[204:205], v[204:205], v[18:19]
    v_cvt_pk_bf16_f32 v86, v204, v205
    v_pk_mul_f32 v[206:207], v[206:207], v[18:19]
    v_cvt_pk_bf16_f32 v87, v206, v207
    ds_write_b128 v16, v[84:87] offset:1152
    v_lshrrev_b32_e64 v2, 2, v1
    v_mul_u32_u24 v2, 1312, v2
    v_and_b32_e64 v3, 3, v1
    v_lshl_add_u32 v2, v3, 3, v2
    s_mul_i32 s85, s68, 320
    v_add_u32_e64 v2, s85, v2
    s_mul_i32 s85, s69, 40960
    s_mul_i32 s86, s68, 10240
    s_add_u32 s85, s85, s86
    s_add_u32 s86, s85, 4096
    s_add_u32 s87, s85, 8192
    v_lshlrev_b32_e64 v17, 2, v1
    s_lshl_b32 s88, s69, 7
    s_add_u32 s88, s88, 0x972000
    s_waitcnt lgkmcnt(0)
    s_barrier
    s_cmp_lg_u32 s68, 3
    s_cbranch_scc1 ln_ng
    ds_read_b32 v10, v17 offset:49152
    s_waitcnt lgkmcnt(0)
    s_mov_b32 exec_hi, 0
    buffer_store_dword v10, v17, s[36:39], s88 offen sc1
    s_mov_b32 exec_hi, -1
ln_ng:
    s_nop 0
    ds_read_b64_tr_b16 v[128:129], v2 offset:0
    ds_read_b64_tr_b16 v[130:131], v2 offset:20992
    ds_read_b64_tr_b16 v[132:133], v2 offset:32
    ds_read_b64_tr_b16 v[134:135], v2 offset:21024
    ds_read_b64_tr_b16 v[136:137], v2 offset:64
    ds_read_b64_tr_b16 v[138:139], v2 offset:21056
    ds_read_b64_tr_b16 v[140:141], v2 offset:96
    ds_read_b64_tr_b16 v[142:143], v2 offset:21088
    ds_read_b64_tr_b16 v[144:145], v2 offset:128
    ds_read_b64_tr_b16 v[146:147], v2 offset:21120
    ds_read_b64_tr_b16 v[148:149], v2 offset:160
    ds_read_b64_tr_b16 v[150:151], v2 offset:21152
    ds_read_b64_tr_b16 v[152:153], v2 offset:192
    ds_read_b64_tr_b16 v[154:155], v2 offset:21184
    s_waitcnt lgkmcnt(6)
    s_nop 0
    ds_read_b64_tr_b16 v[156:157], v2 offset:224
    ds_read_b64_tr_b16 v[158:159], v2 offset:21216
    ds_read_b64_tr_b16 v[160:161], v2 offset:256
    ds_read_b64_tr_b16 v[162:163], v2 offset:21248
    ds_read_b64_tr_b16 v[164:165], v2 offset:288
    ds_read_b64_tr_b16 v[166:167], v2 offset:21280
    s_waitcnt lgkmcnt(6)
    buffer_store_dwordx4 v[128:131], v37, s[36:39], s85 offen offset:0 sc1
    s_waitcnt lgkmcnt(6)
    buffer_store_dwordx4 v[132:135], v37, s[36:39], s85 offen offset:1024 sc1
    s_waitcnt lgkmcnt(6)
    buffer_store_dwordx4 v[136:139], v37, s[36:39], s85 offen offset:2048 sc1
    s_waitcnt lgkmcnt(6)
    buffer_store_dwordx4 v[140:143], v37, s[36:39], s85 offen offset:3072 sc1
    s_waitcnt lgkmcnt(6)
    buffer_store_dwordx4 v[144:147], v37, s[36:39], s86 offen offset:0 sc1
    s_waitcnt lgkmcnt(6)
    buffer_store_dwordx4 v[148:151], v37, s[36:39], s86 offen offset:1024 sc1
    s_waitcnt lgkmcnt(6)
    buffer_store_dwordx4 v[152:155], v37, s[36:39], s86 offen offset:2048 sc1
    s_waitcnt lgkmcnt(4)
    buffer_store_dwordx4 v[156:159], v37, s[36:39], s86 offen offset:3072 sc1
    s_waitcnt lgkmcnt(2)
    buffer_store_dwordx4 v[160:163], v37, s[36:39], s87 offen offset:0 sc1
    s_waitcnt lgkmcnt(0)
    buffer_store_dwordx4 v[164:167], v37, s[36:39], s87 offen offset:1024 sc1
    s_waitcnt vmcnt(0)
    s_barrier
    s_cmp_lg_u32 s68, 0
    s_cbranch_scc1 pub_ln_np
    s_lshl_b32 s85, s69, 7
    s_add_u32 s85, s85, 0x974080
    v_mov_b32 v2, s16
    v_lshlrev_b32 v3, 2, v1
    s_mov_b32 exec_hi, 0
    buffer_store_dword v2, v3, s[36:39], s85 offen sc1
    s_mov_b32 exec_hi, -1
pub_ln_np:
    s_sub_u32 s85, s82, 24
    s_lshl_b32 s85, s85, 2
    s_add_u32 s85, s85, s68
    s_lshl_b32 s86, s81, 5
    s_add_u32 s85, s85, s86
    s_lshl_b32 s85, s85, 13
    s_nop 0
    buffer_load_dword a255, v15, s[44:47], s85 offen
    s_add_u32 s85, s85, 2097152
    buffer_load_dword a255, v15, s[44:47], s85 offen
    s_add_u32 s85, s85, 2097152
    buffer_load_dword a255, v15, s[44:47], s85 offen
    buffer_load_dword a255, v22, s[40:43], s27 offen offset:0
    buffer_load_dword a255, v22, s[40:43], s27 offen offset:1024
    buffer_load_dword a255, v22, s[40:43], s27 offen offset:2048
    buffer_load_dwordx2 v[242:243], v12, s[56:59], s23 offen offset:0
    buffer_load_dwordx2 v[244:245], v12, s[56:59], s23 offen offset:32
    buffer_load_dword v14, v13, s[36:39], s24 offen sc1
    s_add_u32 m0, s6, 0
    s_nop 0
    buffer_load_dwordx4 v33, s[12:15], s4 offen offset:0 lds
    buffer_load_dwordx4 v34, s[12:15], s4 offen offset:1024 lds
    buffer_load_dwordx4 v35, s[12:15], s4 offen offset:2048 lds
    buffer_load_dwordx4 v36, s[12:15], s4 offen offset:3072 lds
    s_add_u32 s4, s4, s11
    s_cmp_eq_u32 s4, s8
    s_cselect_b32 s4, s7, s4
    s_add_u32 m0, s6, 4096
    s_nop 0
    buffer_load_dwordx4 v33, s[12:15], s4 offen offset:0 lds
    buffer_load_dwordx4 v34, s[12:15], s4 offen offset:1024 lds
    buffer_load_dwordx4 v35, s[12:15], s4 offen offset:2048 lds
    buffer_load_dwordx4 v36, s[12:15], s4 offen offset:3072 lds
    s_add_u32 s4, s4, s11
    s_cmp_eq_u32 s4, s8
    s_cselect_b32 s4, s7, s4
    s_add_u32 m0, s6, 8192
    s_nop 0
    buffer_load_dwordx4 v33, s[12:15], s4 offen offset:0 lds
    buffer_load_dwordx4 v34, s[12:15], s4 offen offset:1024 lds
    buffer_load_dwordx4 v35, s[12:15], s4 offen offset:2048 lds
    buffer_load_dwordx4 v36, s[12:15], s4 offen offset:3072 lds
    s_add_u32 s4, s4, s11
    s_cmp_eq_u32 s4, s8
    s_cselect_b32 s4, s7, s4
    s_waitcnt vmcnt(12)
    v_cmp_ne_u32 vcc, s16, v14
    s_cbranch_vccz pln2_ok
    s_mov_b32 s98, 0
pln2_spin:
    s_add_u32 s98, s98, 1
    s_cmp_gt_u32 s98, 0x80000
    s_cbranch_scc1 pln2_ok
    s_sleep 1
    buffer_load_dword v14, v13, s[36:39], s24 offen sc1
    s_waitcnt vmcnt(0)
    v_cmp_ne_u32 vcc, s16, v14
    s_cbranch_vccnz pln2_spin
pln2_ok:
    s_barrier
    v_and_b32 v5, 15, v1
    v_lshlrev_b32_e64 v6, 2, v5
    s_lshl_b32 s23, s73, 8
    s_add_u32 s23, s23, 0x972000
    buffer_load_dword v8, v6, s[36:39], s23 offen offset:0 sc1
    buffer_load_dword v9, v6, s[36:39], s23 offen offset:64 sc1
    buffer_load_dword v10, v6, s[36:39], s23 offen offset:128 sc1
    buffer_load_dword v11, v6, s[36:39], s23 offen offset:192 sc1
    v_lshlrev_b32 v6, 1, v5
    s_lshl_b32 s23, s73, 7
    s_cmp_eq_u32 s68, 0
    s_cselect_b32 s23, s23, 0x40000000
    buffer_load_ushort v29, v6, s[60:63], s23 offen offset:0
    buffer_load_ushort v30, v6, s[60:63], s23 offen offset:32
    buffer_load_ushort v31, v6, s[60:63], s23 offen offset:64
    buffer_load_ushort v32, v6, s[60:63], s23 offen offset:96
    buffer_load_dwordx4 a[0:3], v37, s[36:39], s5 offen offset:0 sc1
    buffer_load_dwordx4 a[4:7], v37, s[36:39], s5 offen offset:1024 sc1
    buffer_load_dwordx4 a[8:11], v37, s[36:39], s5 offen offset:2048 sc1
    buffer_load_dwordx4 a[12:15], v37, s[36:39], s5 offen offset:3072 sc1
    buffer_load_dwordx4 a[16:19], v38, s[36:39], s5 offen offset:0 sc1
    s_add_u32 s5, s5, 40960
    s_cmp_eq_u32 s5, s10
    s_cselect_b32 s5, s9, s5
    buffer_load_dwordx4 a[20:23], v37, s[36:39], s5 offen offset:0 sc1
    buffer_load_dwordx4 a[24:27], v37, s[36:39], s5 offen offset:1024 sc1
    buffer_load_dwordx4 a[28:31], v37, s[36:39], s5 offen offset:2048 sc1
    buffer_load_dwordx4 a[32:35], v37, s[36:39], s5 offen offset:3072 sc1
    buffer_load_dwordx4 a[36:39], v38, s[36:39], s5 offen offset:0 sc1
    s_add_u32 s5, s5, 40960
    s_cmp_eq_u32 s5, s10
    s_cselect_b32 s5, s9, s5
    buffer_load_dwordx4 a[40:43], v37, s[36:39], s5 offen offset:0 sc1
    buffer_load_dwordx4 a[44:47], v37, s[36:39], s5 offen offset:1024 sc1
    buffer_load_dwordx4 a[48:51], v37, s[36:39], s5 offen offset:2048 sc1
    buffer_load_dwordx4 a[52:55], v37, s[36:39], s5 offen offset:3072 sc1
    buffer_load_dwordx4 a[56:59], v38, s[36:39], s5 offen offset:0 sc1
    s_add_u32 s5, s5, 40960
    s_cmp_eq_u32 s5, s10
    s_cselect_b32 s5, s9, s5
    v_accvgpr_write_b32 a112, 0
    v_accvgpr_write_b32 a113, 0
    v_accvgpr_write_b32 a114, 0
    v_accvgpr_write_b32 a115, 0
    v_accvgpr_write_b32 a116, 0
    v_accvgpr_write_b32 a117, 0
    v_accvgpr_write_b32 a118, 0
    v_accvgpr_write_b32 a119, 0
    v_accvgpr_write_b32 a120, 0
    v_accvgpr_write_b32 a121, 0
    v_accvgpr_write_b32 a122, 0
    v_accvgpr_write_b32 a123, 0
    v_accvgpr_write_b32 a124, 0
    v_accvgpr_write_b32 a125, 0
    v_accvgpr_write_b32 a126, 0
    v_accvgpr_write_b32 a127, 0
    v_accvgpr_write_b32 a128, 0
    v_accvgpr_write_b32 a129, 0
    v_accvgpr_write_b32 a130, 0
    v_accvgpr_write_b32 a131, 0
    v_accvgpr_write_b32 a132, 0
    v_accvgpr_write_b32 a133, 0
    v_accvgpr_write_b32 a134, 0
    v_accvgpr_write_b32 a135, 0
    v_accvgpr_write_b32 a136, 0
    v_accvgpr_write_b32 a137, 0
    v_accvgpr_write_b32 a138, 0
    v_accvgpr_write_b32 a139, 0
    v_accvgpr_write_b32 a140, 0
    v_accvgpr_write_b32 a141, 0
    v_accvgpr_write_b32 a142, 0
    v_accvgpr_write_b32 a143, 0
    v_accvgpr_write_b32 a144, 0
    v_accvgpr_write_b32 a145, 0
    v_accvgpr_write_b32 a146, 0
    v_accvgpr_write_b32 a147, 0
    v_accvgpr_write_b32 a148, 0
    v_accvgpr_write_b32 a149, 0
    v_accvgpr_write_b32 a150, 0
    v_accvgpr_write_b32 a151, 0
    v_accvgpr_write_b32 a152, 0
    v_accvgpr_write_b32 a153, 0
    v_accvgpr_write_b32 a154, 0
    v_accvgpr_write_b32 a155, 0
    v_accvgpr_write_b32 a156, 0
    v_accvgpr_write_b32 a157, 0
    v_accvgpr_write_b32 a158, 0
    v_accvgpr_write_b32 a159, 0
    v_accvgpr_write_b32 a160, 0
    v_accvgpr_write_b32 a161, 0
    v_accvgpr_write_b32 a162, 0
    v_accvgpr_write_b32 a163, 0
    v_accvgpr_write_b32 a164, 0
    v_accvgpr_write_b32 a165, 0
    v_accvgpr_write_b32 a166, 0
    v_accvgpr_write_b32 a167, 0
    v_accvgpr_write_b32 a168, 0
    v_accvgpr_write_b32 a169, 0
    v_accvgpr_write_b32 a170, 0
    v_accvgpr_write_b32 a171, 0
    v_accvgpr_write_b32 a172, 0
    v_accvgpr_write_b32 a173, 0
    v_accvgpr_write_b32 a174, 0
    v_accvgpr_write_b32 a175, 0
    v_accvgpr_write_b32 a176, 0
    v_accvgpr_write_b32 a177, 0
    v_accvgpr_write_b32 a178, 0
    v_accvgpr_write_b32 a179, 0
    v_accvgpr_write_b32 a180, 0
    v_accvgpr_write_b32 a181, 0
    v_accvgpr_write_b32 a182, 0
    v_accvgpr_write_b32 a183, 0
    v_accvgpr_write_b32 a184, 0
    v_accvgpr_write_b32 a185, 0
    v_accvgpr_write_b32 a186, 0
    v_accvgpr_write_b32 a187, 0
    v_accvgpr_write_b32 a188, 0
    v_accvgpr_write_b32 a189, 0
    v_accvgpr_write_b32 a190, 0
    v_accvgpr_write_b32 a191, 0
    s_waitcnt vmcnt(15)
    v_sub_f32 v8, 1.0, v8
    v_sub_f32 v9, 1.0, v9
    v_sub_f32 v10, 1.0, v10
    v_sub_f32 v11, 1.0, v11
    v_min_u32 v12, 23, v1
    v_lshlrev_b32_e64 v12, 7, v12
    s_mul_i32 s23, s74, 3072
    s_add_u32 s23, s23, 0x97c080
    v_and_b32 v5, 15, v1
    v_lshrrev_b32 v6, 4, v1
    v_mul_u32_u24 v4, 336, v5
    v_lshl_add_u32 v4, v6, 4, v4
    s_mul_i32 s85, s68, 21504
    s_add_u32 s85, s85, 65536
    v_add_u32_e64 v4, s85, v4
    s_mul_i32 s85, s68, 5376
    s_add_u32 s85, s85, 65536
    s_lshl_b32 s95, s73, 2
    s_add_u32 s95, s95, s68
    s_mul_i32 s95, s95, 20480
    s_mul_i32 s87, s74, 160
    s_add_u32 s95, s95, s87
    v_add_u32 v5, 0, v1
    v_mul_u32_u24 v6, 3277, v5
    v_lshrrev_b32 v6, 16, v6
    v_mul_u32_u24 v7, 20, v6
    v_sub_u32_e64 v7, v5, v7
    v_mul_u32_u24 v16, 336, v6
    v_lshl_add_u32 v16, v7, 4, v16
    v_add_u32_e64 v16, s85, v16
    v_mul_u32_u24 v24, 1280, v6
    v_lshl_add_u32 v24, v7, 3, v24
    v_add_u32_e64 v5, 64, v1
    v_mul_u32_u24 v6, 3277, v5
    v_lshrrev_b32 v6, 16, v6
    v_mul_u32_u24 v7, 20, v6
    v_sub_u32_e64 v7, v5, v7
    v_mul_u32_u24 v17, 336, v6
    v_lshl_add_u32 v17, v7, 4, v17
    v_add_u32_e64 v17, s85, v17
    v_mul_u32_u24 v25, 1280, v6
    v_lshl_add_u32 v25, v7, 3, v25
    v_add_u32 v5, 128, v1
    v_mul_u32_u24 v6, 3277, v5
    v_lshrrev_b32 v6, 16, v6
    v_mul_u32_u24 v7, 20, v6
    v_sub_u32_e64 v7, v5, v7
    v_mul_u32_u24 v18, 336, v6
    v_lshl_add_u32 v18, v7, 4, v18
    v_add_u32_e64 v18, s85, v18
    v_mul_u32_u24 v26, 1280, v6
    v_lshl_add_u32 v26, v7, 3, v26
    v_add_u32 v5, 192, v1
    v_mul_u32_u24 v6, 3277, v5
    v_lshrrev_b32 v6, 16, v6
    v_mul_u32_u24 v7, 20, v6
    v_sub_u32_e64 v7, v5, v7
    v_mul_u32_u24 v19, 336, v6
    v_lshl_add_u32 v19, v7, 4, v19
    v_add_u32_e64 v19, s85, v19
    v_mul_u32_u24 v27, 1280, v6
    v_lshl_add_u32 v27, v7, 3, v27
    v_add_u32 v5, 256, v1
    v_mul_u32_u24 v6, 3277, v5
    v_lshrrev_b32 v6, 16, v6
    v_mul_u32_u24 v7, 20, v6
    v_sub_u32_e64 v7, v5, v7
    v_mul_u32_u24 v20, 336, v6
    v_lshl_add_u32 v20, v7, 4, v20
    v_add_u32_e64 v20, s85, v20
    v_mul_u32_u24 v28, 1280, v6
    v_lshl_add_u32 v28, v7, 3, v28
    s_mul_i32 s85, s68, 21504
    s_add_u32 s85, s85, 65536
    v_add_u32 v250, s85, v37
    s_sub_u32 s85, s85, s6
    v_add_u32 v246, s85, v39
    v_add_u32 v247, s85, v40
    v_add_u32 v248, s85, v41
    v_add_u32_e64 v249, s85, v42
    s_mov_b32 s75, 3
    s_mov_b32 s3, 0
    s_waitcnt vmcnt(10)
    ds_read_b64_tr_b16 a[80:81], v39 offset:0
    ds_read_b64_tr_b16 a[82:83], v39 offset:2048
    ds_read_b64_tr_b16 a[84:85], v40 offset:0
    ds_read_b64_tr_b16 a[86:87], v40 offset:2048
    ds_read_b64_tr_b16 a[88:89], v41 offset:0
    ds_read_b64_tr_b16 a[90:91], v41 offset:2048
    ds_read_b64_tr_b16 a[92:93], v42 offset:0
    ds_read_b64_tr_b16 a[94:95], v42 offset:2048
    s_branch g1_loop
r_q:
    s_sub_u32 s87, s82, 16
    s_and_b32 s85, s87, 3
    s_lshl_b32 s86, s83, 2
    s_add_u32 s69, s85, s86
    s_lshr_b32 s85, s87, 2
    s_lshl_b32 s86, s84, 1
    s_add_u32 s70, s85, s86
    s_lshl_b32 s94, s70, 2
    s_and_b32 s85, s69, 3
    s_add_u32 s94, s94, s85
    s_lshr_b32 s95, s69, 2
    s_lshr_b32 s96, s68, 1
    s_and_b32 s97, s68, 1
    v_lshrrev_b32 v2, 3, v1
    s_lshl_b32 s85, s68, 5
    v_add_u32_e64 v2, s85, v2
    v_mul_u32_u24 v2, 1280, v2
    v_lshrrev_b32 v3, 4, v1
    v_and_b32 v4, 7, v1
    v_xor_b32_e64 v4, v4, v3
    v_lshl_add_u32 v16, v4, 4, v2
    v_xor_b32_e64 v4, 4, v4
    v_lshl_add_u32 v6, v4, 4, v2
    v_add_u32 v17, 9216, v6
    v_add_u32 v18, 18432, v16
    v_add_u32 v19, 27648, v6
    s_mul_i32 s76, s69, 163840
    s_mov_b32 s77, 0
    s_and_b32 s85, s82, 3
    s_lshl_b32 s85, s85, 2
    s_lshr_b32 s85, 0x8530, s85
    s_and_b32 s85, s85, 15
    s_and_b32 s86, s82, 12
    s_lshr_b32 s86, 0x8530, s86
    s_and_b32 s86, s86, 15
    s_add_u32 s85, s85, s86
    s_add_u32 s85, s85, s83
    s_add_u32 s85, s85, s84
    s_add_u32 s85, s85, 1
    s_mul_i32 s86, s85, 26
    s_lshr_b32 s86, s86, 8
    s_mul_i32 s86, s86, 10
    s_sub_u32 s85, s85, s86
    s_mul_i32 s77, s85, 245760
    s_lshl_b32 s85, s85, 7
    s_add_u32 s76, s76, s85
    s_lshl_b32 s80, s68, 12
    s_mul_i32 s98, s68, 5120
    s_add_u32 s98, s98, 16384
    s_mov_b32 s79, 73728
    s_waitcnt lgkmcnt(0)
    s_mov_b64 s[28:29], s[4:5]
    s_mov_b32 s30, 0x280000
    s_mov_b32 s31, 0x20000
    s_mov_b64 s[32:33], s[6:7]
    s_mov_b32 s34, 0x258000
    s_mov_b32 s35, 0x20000
    s_add_u32 m0, s79, s80
    s_nop 0
    buffer_load_dwordx4 v16, s[28:31], s76 offen offset:0 lds
    buffer_load_dwordx4 v17, s[28:31], s76 offen offset:1024 lds
    buffer_load_dwordx4 v18, s[28:31], s76 offen offset:2048 lds
    buffer_load_dwordx4 v19, s[28:31], s76 offen offset:3072 lds
    s_mul_i32 s86, s70, 320
    s_mul_i32 s85, s68, 61440
    s_add_u32 s85, s85, s86
    s_movk_i32 s89, -20
    v_mul_u32_u24 v3, 3277, v1
    v_lshrrev_b32_e64 v3, 16, v3
    v_mad_i32_i24 v4, v3, s89, v1
    v_lshrrev_b32 v5, 2, v3
    v_and_b32 v5, 2, v5
    v_xor_b32 v4, v4, v5
    s_mov_b32 s87, s85
    v_mul_u32_u24 v3, 3840, v3
    v_lshl_add_u32 v3, v4, 4, v3
    v_add_u32 v20, s87, v3
    v_add_u32 v2, 64, v1
    v_mul_u32_u24 v3, 3277, v2
    v_lshrrev_b32_e64 v3, 16, v3
    v_mad_i32_i24 v4, v3, s89, v2
    v_lshrrev_b32 v5, 2, v3
    v_and_b32 v5, 2, v5
    v_xor_b32_e64 v4, v4, v5
    s_sub_u32 s87, s85, 1024
    v_mul_u32_u24 v3, 3840, v3
    v_lshl_add_u32 v3, v4, 4, v3
    v_add_u32_e64 v21, s87, v3
    v_add_u32 v2, 128, v1
    v_mul_u32_u24 v3, 3277, v2
    v_lshrrev_b32_e64 v3, 16, v3
    v_mad_i32_i24 v4, v3, s89, v2
    v_lshrrev_b32 v5, 2, v3
    v_and_b32 v5, 2, v5
    v_xor_b32_e64 v4, v4, v5
    s_sub_u32 s87, s85, 2048
    v_mul_u32_u24 v3, 3840, v3
    v_lshl_add_u32 v3, v4, 4, v3
    v_add_u32_e64 v22, s87, v3
    v_add_u32 v2, 192, v1
    v_mul_u32_u24 v3, 3277, v2
    v_lshrrev_b32_e64 v3, 16, v3
    v_mad_i32_i24 v4, v3, s89, v2
    v_lshrrev_b32 v5, 2, v3
    v_and_b32 v5, 2, v5
    v_xor_b32_e64 v4, v4, v5
    s_sub_u32 s87, s85, 3072
    v_mul_u32_u24 v3, 3840, v3
    v_lshl_add_u32 v3, v4, 4, v3
    v_add_u32_e64 v23, s87, v3
    v_add_u32 v2, 256, v1
    v_mul_u32_u24 v3, 3277, v2
    v_lshrrev_b32_e64 v3, 16, v3
    v_mad_i32_i24 v4, v3, s89, v2
    v_lshrrev_b32 v5, 2, v3
    v_and_b32 v5, 2, v5
    v_xor_b32 v4, v4, v5
    s_mov_b32 s87, s85
    v_mul_u32_u24 v3, 3840, v3
    v_lshl_add_u32 v3, v4, 4, v3
    v_add_u32_e64 v24, s87, v3
    s_add_u32 m0, s79, s98
    s_nop 0
    buffer_load_dwordx4 v20, s[32:35], s77 offen offset:0 lds
    buffer_load_dwordx4 v21, s[32:35], s77 offen offset:1024 lds
    buffer_load_dwordx4 v22, s[32:35], s77 offen offset:2048 lds
    buffer_load_dwordx4 v23, s[32:35], s77 offen offset:3072 lds
    s_add_u32 m0, m0, 4096
    s_nop 0
    s_nop 0
    buffer_load_dwordx4 v24, s[32:35], s77 offen lds
    s_add_u32 s76, s76, 128
    s_add_u32 s77, s77, 245760
    s_cmp_eq_u32 s77, 2457600
    s_cselect_b32 s85, 1280, 0
    s_cselect_b32 s77, 0, s77
    s_sub_u32 s76, s76, s85
    s_add_u32 s79, s79, 36864
    s_cmp_eq_u32 s79, 147456
    s_cselect_b32 s79, 0, s79
    s_add_u32 s86, s26, 0x974000
    s_addc_u32 s87, s27, 0
    s_load_dword s3, s[86:87], 0
    s_lshr_b32 s85, s82, 2
    s_lshl_b32 s88, s83, 3
    s_add_u32 s73, s85, s88
    s_and_b32 s85, s82, 3
    s_lshl_b32 s88, s84, 2
    s_add_u32 s74, s85, s88
    s_lshr_b32 s85, s82, 3
    s_lshl_b32 s85, s85, 3
    s_add_u32 s73, s85, s81
    s_and_b32 s74, s82, 7
    s_sub_u32 s85, s82, 8
    s_cmp_lt_u32 s82, 16
    s_cselect_b32 s85, s82, s85
    s_and_b32 s89, s85, 3
    s_add_u32 s71, s89, s88
    s_lshr_b32 s85, s85, 2
    s_lshl_b32 s88, s85, 2
    s_add_u32 s72, s83, s88
    s_lshr_b32 s88, s85, 2
    s_lshl_b32 s85, s85, 1
    s_add_u32 s85, s85, s88
    s_lshl_b32 s85, s85, 1
    s_mul_i32 s89, s89, 4
    s_add_u32 s85, s85, s89
    s_and_b32 s99, s85, 15
    s_mov_b64 s[36:37], s[26:27]
    s_mov_b32 s38, 0x982080
    s_mov_b32 s39, 0x20000
    s_mov_b64 s[40:41], s[12:13]
    s_mov_b32 s42, 0x600000
    s_mov_b32 s43, 0x20000
    s_mov_b64 s[52:53], s[8:9]
    s_mov_b32 s54, 0xc8000
    s_mov_b32 s55, 0x20000
    s_mov_b64 s[44:45], s[16:17]
    s_mov_b32 s46, 0x600000
    s_mov_b32 s47, 0x20000
    s_mov_b64 s[60:61], s[18:19]
    s_mov_b32 s62, 0x1000
    s_mov_b32 s63, 0x20000
    s_mov_b64 s[48:49], s[22:23]
    s_mov_b32 s50, 0x280000
    s_mov_b32 s51, 0x20000
    s_mov_b64 s[12:13], s[40:41]
    s_mov_b64 s[14:15], s[42:43]
    s_mul_i32 s7, s68, 1572864
    s_lshl_b32 s85, s72, 7
    s_add_u32 s7, s7, s85
    s_add_u32 s8, s7, 1572864
    s_mul_i32 s85, s99, 98304
    s_add_u32 s4, s7, s85
    s_mul_i32 s9, s68, 655360
    s_mul_i32 s85, s71, 5120
    s_add_u32 s9, s9, s85
    s_add_u32 s10, s9, 655360
    s_mul_i32 s85, s99, 40960
    s_add_u32 s5, s9, s85
    s_mov_b32 s11, 98304
    s_lshl_b32 s6, s68, 14
    s_and_b32 s85, s82, 3
    s_mul_i32 s85, s85, 3
    s_lshr_b32 s86, s82, 2
    s_mul_i32 s86, s86, 3
    s_lshr_b32 s86, s86, 1
    s_add_u32 s85, s85, s86
    s_cmp_ge_u32 s85, 12
    s_cselect_b32 s86, 12, 0
    s_sub_u32 s85, s85, s86
    s_add_u32 s85, s73, s74
    s_and_b32 s85, s85, 1
    s_mul_i32 s85, s85, 6
    s_mul_i32 s18, s68, 1572864
    s_lshl_b32 s86, s73, 7
    s_add_u32 s18, s18, s86
    s_add_u32 s19, s18, 1572864
    s_lshl_b32 s86, s85, 17
    s_add_u32 s17, s18, s86
    s_mul_i32 s21, s68, 491520
    s_mul_i32 s86, s74, 5120
    s_add_u32 s21, s21, s86
    s_add_u32 s21, s21, 0x280000
    s_add_u32 s22, s21, 491520
    s_mul_i32 s86, s85, 40960
    s_add_u32 s20, s21, s86
    v_lshlrev_b32 v37, 4, v1
    v_add_u32 v38, 4096, v37
    v_lshrrev_b32 v2, 2, v1
    v_lshrrev_b32 v3, 1, v2
    v_and_b32 v3, 3, v3
    v_lshlrev_b32 v2, 7, v2
    v_lshl_add_u32 v2, v3, 5, v2
    v_and_b32_e64 v3, 3, v1
    v_lshl_add_u32 v2, v3, 3, v2
    v_add_u32 v39, s6, v2
    v_xor_b32 v40, 32, v39
    v_xor_b32_e64 v41, 64, v39
    v_xor_b32 v42, 96, v39
    v_lshrrev_b32 v2, 3, v1
    v_lshrrev_b32 v3, 4, v1
    v_lshlrev_b32 v3, 1, v3
    v_and_b32 v4, 7, v1
    v_xor_b32 v3, v3, v4
    v_lshlrev_b32 v3, 4, v3
    v_mul_u32_u24 v4, 3072, v2
    v_add_u32_e64 v33, v3, v4
    v_add_u32 v34, 23552, v33
    v_add_u32 v35, 47104, v33
    v_add_u32 v36, 70656, v33
    v_mul_u32_u24 v4, 4096, v2
    v_add_u32_e64 v43, v3, v4
    v_add_u32 v44, 31744, v43
    v_add_u32 v45, 63488, v43
    v_add_u32 v46, 95232, v43
    v_and_b32 v13, 15, v1
    s_mul_i32 s85, s68, 16
    v_add_lshl_u32 v13, v13, s85, 7
    v_lshlrev_b32_e64 v15, 7, v1
    s_mov_b32 s24, 0x974080
    s_mov_b32 s25, 0x97a080
    s_waitcnt lgkmcnt(0)
    s_mul_i32 s16, s3, 0x41C64E6D
    s_add_u32 s16, s16, 0x3C6EF35F
    s_sub_u32 s88, s82, 16
    s_lshl_b32 s88, s88, 2
    s_add_u32 s88, s88, s68
    v_and_b32_e64 v12, 31, v1
    v_mul_u32_u24 v12, 3072, v12
    v_lshrrev_b32_e64 v3, 5, v1
    v_lshl_add_u32 v12, v3, 9, v12
    s_mul_i32 s85, s88, 98304
    s_lshl_b32 s86, s83, 7
    s_add_u32 s85, s85, s86
    s_mul_i32 s86, s84, 3145728
    s_add_u32 s26, s86, s85
    s_xor_b32 s87, s84, 1
    s_mul_i32 s87, s87, 3145728
    s_add_u32 s27, s87, s85
    s_mul_i32 s67, s94, 51200
    s_mul_i32 s86, s95, 320
    s_add_u32 s67, s67, s86
    s_lshl_b32 s86, s68, 8
    v_add_u32 v2, 0, v1
    v_add_u32_e64 v2, s86, v2
    v_mul_u32_u24 v3, 3277, v2
    v_lshrrev_b32 v3, 16, v3
    v_mul_u32_u24 v4, 20, v3
    v_sub_u32_e64 v4, v2, v4
    v_mul_u32_u24 v3, 1280, v3
    v_lshl_add_u32 v248, v4, 4, v3
    v_add_u32 v2, 64, v1
    v_add_u32 v2, s86, v2
    v_mul_u32_u24 v3, 3277, v2
    v_lshrrev_b32 v3, 16, v3
    v_mul_u32_u24 v4, 20, v3
    v_sub_u32_e64 v4, v2, v4
    v_mul_u32_u24 v3, 1280, v3
    v_lshl_add_u32 v249, v4, 4, v3
    v_subrev_u32 v249, 1024, v249
    v_add_u32 v2, 128, v1
    v_add_u32_e64 v2, s86, v2
    v_mul_u32_u24 v3, 3277, v2
    v_lshrrev_b32 v3, 16, v3
    v_mul_u32_u24 v4, 20, v3
    v_sub_u32_e64 v4, v2, v4
    v_mul_u32_u24 v3, 1280, v3
    v_lshl_add_u32 v250, v4, 4, v3
    v_subrev_u32 v250, 2048, v250
    v_add_u32 v2, 192, v1
    v_add_u32_e64 v2, s86, v2
    v_mul_u32_u24 v3, 3277, v2
    v_lshrrev_b32 v3, 16, v3
    v_mul_u32_u24 v4, 20, v3
    v_sub_u32_e64 v4, v2, v4
    v_mul_u32_u24 v3, 1280, v3
    v_lshl_add_u32 v251, v4, 4, v3
    v_subrev_u32 v251, 3072, v251
    v_and_b32 v3, 15, v1
    v_lshrrev_b32 v4, 4, v1
    v_lshlrev_b32 v25, 2, v3
    s_lshl_b32 s86, s69, 9
    s_lshl_b32 s87, s96, 8
    s_add_u32 s86, s86, s87
    s_add_u32 s23, s86, 0x972000
    v_bfe_u32 v5, v1, 1, 2
    s_lshl_b32 s85, s68, 2
    v_add_lshl_u32 v5, v5, s85, 3
    v_and_b32_e64 v6, 1, v1
    s_lshl_b32 s85, s70, 1
    v_add3_u32 v5, v5, v6, s85
    v_lshlrev_b32 v245, 7, v5
    v_lshrrev_b32 v5, 2, v3
    v_lshl_add_u32 v5, v4, 2, v5
    v_and_b32_e64 v6, 7, v5
    v_mul_u32_u24 v6, 320, v6
    v_mul_u32_u24 v5, 320, v5
    v_and_b32 v7, 3, v1
    v_lshlrev_b32 v7, 3, v7
    s_lshl_b32 s86, s68, 5
    v_add_u32 v7, s86, v7
    v_add_u32 v246, v6, v7
    v_add_u32 v247, v5, v7
    s_lshr_b32 s86, s94, 2
    s_mul_i32 s86, s86, 5
    s_bfe_u32 s87, s94, 0x10001
    s_and_b32 s88, s94, 1
    s_mul_i32 s89, s87, 3
    s_add_u32 s89, s89, s88
    s_add_u32 s89, s89, s86
    s_mul_i32 s56, s89, 40960
    s_add_u32 s86, s86, 2
    s_mul_i32 s57, s86, 40960
    s_lshl_b32 s87, s87, 3
    s_lshl_b32 s88, s88, 9
    s_add_u32 s57, s57, s87
    s_add_u32 s57, s57, s88
    s_mul_i32 s86, s95, 10240
    s_lshl_b32 s87, s68, 10
    s_add_u32 s86, s86, s87
    s_add_u32 s86, s86, 0x6e0000
    s_add_u32 s56, s56, s86
    s_add_u32 s57, s57, s86
    s_lshl_b32 s85, s69, 1
    s_add_u32 s85, s85, s96
    s_mul_i32 s85, s85, 20
    s_mul_i32 s86, s70, 5
    s_add_u32 s85, s85, s86
    s_lshl_b32 s85, s85, 12
    s_add_u32 s85, s85, 0x460000
    s_mul_i32 s86, s97, 12288
    s_add_u32 s64, s86, s85
    s_add_u32 s65, s64, 4096
    s_lshl_b32 s88, s97, 3
    s_add_u32 s88, s88, s85
    s_add_u32 s66, s88, 8192
    v_add_u32 v5, s68, v1
    s_mul_i32 s85, s68, 9
    v_add_u32 v5, s85, v5
    v_lshrrev_b32 v6, 2, v5
    v_and_b32 v5, 3, v5
    v_lshlrev_b32 v5, 7, v5
    v_lshl_add_u32 v5, v6, 10, v5
    s_sub_u32 s85, s57, s87
    s_and_b32 s85, s85, 0xffffff80
    v_add_u32 v5, s85, v5
    s_and_b32 s85, s66, 0xffffff80
    s_lshl_b32 s86, s97, 11
    s_add_u32 s85, s85, s86
    v_lshlrev_b32 v6, 7, v3
    v_add_u32 v6, s85, v6
    v_cmp_gt_u32 vcc, 10, v1
    s_nop 1
    v_cndmask_b32_e64 v244, v6, v5, vcc
    v_mov_b32 v128, 67136
    s_mov_b32 s85, 0x0
    s_mov_b32 s86, 0xffffffff
    v_mbcnt_lo_u32_b32 v26, s85, 0
    v_mbcnt_hi_u32_b32 v26, s86, v26
    v_lshlrev_b32_e64 v26, 3, v26
    v_add_u32 v26, 65536, v26
    s_mov_b32 s92, s85
    s_mov_b32 s93, s86
    v_cndmask_b32 v26, v128, v26, s[92:93]
    s_mov_b32 s85, 0xffffffff
    s_mov_b32 s86, 0xffff
    v_mbcnt_lo_u32_b32 v27, s85, 32
    v_mbcnt_hi_u32_b32 v27, s86, v27
    v_lshlrev_b32 v27, 3, v27
    v_add_u32 v27, 65536, v27
    s_mov_b32 s92, s85
    s_mov_b32 s93, s86
    v_cndmask_b32 v27, v128, v27, s[92:93]
    s_mov_b32 s85, 0x0
    s_mov_b32 s86, 0xf000f
    v_mov_b32 v28, 80
    v_mbcnt_lo_u32_b32 v28, s85, v28
    v_mbcnt_hi_u32_b32 v28, s86, v28
    v_lshlrev_b32 v28, 3, v28
    v_add_u32 v28, 65536, v28
    s_mov_b32 s92, s85
    s_mov_b32 s93, s86
    v_cndmask_b32 v28, v128, v28, s[92:93]
    s_mov_b32 s85, 0xf000f
    s_mov_b32 s86, 0xfff0000f
    v_mov_b32 v29, 88
    v_mbcnt_lo_u32_b32 v29, s85, v29
    v_mbcnt_hi_u32_b32 v29, s86, v29
    v_lshlrev_b32_e64 v29, 3, v29
    v_add_u32 v29, 65536, v29
    s_mov_b32 s92, s85
    s_mov_b32 s93, s86
    v_cndmask_b32 v29, v128, v29, s[92:93]
    s_mov_b32 s85, 0xfff0fff0
    s_mov_b32 s86, 0xfff0fff0
    v_mov_b32 v30, 112
    v_mbcnt_lo_u32_b32 v30, s85, v30
    v_mbcnt_hi_u32_b32 v30, s86, v30
    v_lshlrev_b32_e64 v30, 3, v30
    v_add_u32 v30, 65536, v30
    s_mov_b32 s92, s85
    s_mov_b32 s93, s86
    v_cndmask_b32 v30, v128, v30, s[92:93]
    s_mov_b32 s85, 0x0
    s_mov_b32 s86, 0xff0000
    v_mov_b32 v31, 160
    v_mbcnt_lo_u32_b32 v31, s85, v31
    v_mbcnt_hi_u32_b32 v31, s86, v31
    v_lshlrev_b32 v31, 3, v31
    v_add_u32 v31, 65536, v31
    s_mov_b32 s92, s85
    s_mov_b32 s93, s86
    v_cndmask_b32 v31, v128, v31, s[92:93]
    s_mov_b32 s85, 0xff00ff
    s_mov_b32 s86, 0xff00ff
    v_mov_b32 v32, 168
    v_mbcnt_lo_u32_b32 v32, s85, v32
    v_mbcnt_hi_u32_b32 v32, s86, v32
    v_lshlrev_b32_e64 v32, 3, v32
    v_add_u32 v32, 65536, v32
    s_mov_b32 s92, s85
    s_mov_b32 s93, s86
    v_cndmask_b32 v32, v128, v32, s[92:93]
    v_lshl_add_u32 v128, v4, 2, 0
    v_add_u32_e64 v133, 0, v3
    v_mul_u32_u24 v128, 205, v128
    v_lshrrev_b32_e64 v128, 12, v128
    v_mul_u32_u24 v133, 205, v133
    v_lshrrev_b32_e64 v133, 12, v133
    v_lshl_add_u32 v129, v4, 2, 16
    v_add_u32_e64 v134, 16, v3
    v_mul_u32_u24 v129, 205, v129
    v_lshrrev_b32_e64 v129, 12, v129
    v_mul_u32_u24 v134, 205, v134
    v_lshrrev_b32_e64 v134, 12, v134
    v_lshl_add_u32 v130, v4, 2, 32
    v_add_u32 v135, 32, v3
    v_lshrrev_b32 v5, 1, v4
    v_lshl_add_u32 v130, v5, 5, v130
    v_mul_u32_u24 v7, 4064, v5
    v_lshrrev_b32_e64 v5, 3, v3
    v_lshl_add_u32 v135, v5, 5, v135
    v_mul_u32_u24 v130, 205, v130
    v_lshrrev_b32_e64 v130, 12, v130
    v_mul_u32_u24 v135, 205, v135
    v_lshrrev_b32_e64 v135, 12, v135
    v_lshl_add_u32 v131, v4, 2, 40
    v_add_u32_e64 v136, 40, v3
    v_mul_u32_u24 v131, 205, v131
    v_lshrrev_b32_e64 v131, 12, v131
    v_mul_u32_u24 v136, 205, v136
    v_lshrrev_b32_e64 v136, 12, v136
    v_lshl_add_u32 v132, v4, 2, 56
    v_add_u32_e64 v137, 56, v3
    v_mul_u32_u24 v132, 205, v132
    v_lshrrev_b32_e64 v132, 12, v132
    v_mul_u32_u24 v137, 205, v137
    v_lshrrev_b32 v137, 12, v137
    v_cmp_eq_u32_e64 vcc, v128, v133
    s_nop 1
    v_cndmask_b32 v194, 0, -1, vcc
    v_cmp_eq_u32 vcc, v129, v133
    s_nop 1
    v_cndmask_b32 v195, 0, -1, vcc
    v_cmp_eq_u32 vcc, v128, v134
    s_nop 1
    v_cndmask_b32 v196, 0, -1, vcc
    v_cmp_eq_u32 vcc, v129, v134
    s_nop 1
    v_cndmask_b32 v197, 0, -1, vcc
    v_cmp_eq_u32 vcc, v130, v134
    s_nop 1
    v_cndmask_b32 v198, 0, -1, vcc
    v_cmp_eq_u32 vcc, v129, v135
    s_nop 1
    v_cndmask_b32 v199, 0, -1, vcc
    v_cmp_eq_u32 vcc, v130, v135
    s_nop 1
    v_cndmask_b32 v200, 0, -1, vcc
    v_cmp_eq_u32 vcc, v132, v135
    s_nop 1
    v_cndmask_b32 v201, 0, -1, vcc
    v_cmp_eq_u32 vcc, v131, v136
    s_nop 1
    v_cndmask_b32 v202, 0, -1, vcc
    v_cmp_eq_u32 vcc, v132, v136
    s_nop 1
    v_cndmask_b32 v203, 0, -1, vcc
    v_cmp_eq_u32 vcc, v130, v137
    s_nop 1
    v_cndmask_b32 v204, 0, -1, vcc
    v_cmp_eq_u32 vcc, v131, v137
    s_nop 1
    v_cndmask_b32 v205, 0, -1, vcc
    v_cmp_eq_u32 vcc, v132, v137
    s_nop 1
    v_cndmask_b32 v206, 0, -1, vcc
    v_lshlrev_b32_e64 v5, 8, v3
    v_lshl_add_u32 v252, v4, 4, v5
    v_add_u32_e64 v254, v7, v252
    v_add_u32 v253, 4096, v252
    s_lshl_b32 s86, s70, 14
    s_lshl_b32 s87, s97, 13
    s_add_u32 s86, s86, s87
    s_add_u32 s58, s86, 0x880000
    s_mul_i32 s89, s94, 51200
    s_mul_i32 s87, s68, 800
    s_add_u32 s87, s87, s89
    s_add_u32 s59, s87, 0x7a8000
    v_and_b32 v2, 15, v1
    v_lshrrev_b32 v3, 4, v1
    v_lshrrev_b32 v4, 1, v2
    v_xor_b32 v4, v4, v3
    v_lshlrev_b32_e64 v4, 4, v4
    v_lshl_add_u32 v4, v2, 7, v4
    s_lshl_b32 s85, s96, 13
    v_add_u32 v208, s85, v4
    v_xor_b32 v209, 64, v208
    v_lshrrev_b32 v4, 2, v2
    v_lshl_add_u32 v4, v3, 3, v4
    v_mul_u32_u24 v4, 320, v4
    v_and_b32_e64 v5, 1, v1
    v_lshl_add_u32 v4, v5, 3, v4
    v_add_u32 v4, 16384, v4
    v_bfe_u32 v5, v1, 1, 1
    v_and_b32 v6, 1, v3
    v_lshlrev_b32 v6, 1, v6
    s_mul_i32 s85, s97, 10
    s_add_u32 s86, s85, 0
    v_add_u32 v7, s86, v5
    v_xor_b32 v7, v7, v6
    v_lshl_add_u32 v210, v7, 4, v4
    s_add_u32 s86, s85, 2
    v_add_u32 v7, s86, v5
    v_xor_b32_e64 v7, v7, v6
    v_lshl_add_u32 v211, v7, 4, v4
    s_add_u32 s86, s85, 4
    v_mad_u32_u24 v7, v5, 5, s86
    v_xor_b32 v7, v7, v6
    v_lshl_add_u32 v212, v7, 4, v4
    s_add_u32 s86, s85, 5
    v_add_u32 v7, s86, v5
    v_xor_b32_e64 v7, v7, v6
    v_lshl_add_u32 v213, v7, 4, v4
    s_add_u32 s86, s85, 7
    v_add_u32 v7, s86, v5
    v_xor_b32_e64 v7, v7, v6
    v_lshl_add_u32 v214, v7, 4, v4
    v_mov_b64 v[48:49], 0
    v_mov_b64 v[50:51], 0
    v_mov_b64 v[52:53], 0
    v_mov_b64 v[54:55], 0
    v_mov_b64 v[56:57], 0
    v_mov_b64 v[58:59], 0
    v_mov_b64 v[60:61], 0
    v_mov_b64 v[62:63], 0
    v_mov_b64 v[64:65], 0
    v_mov_b64 v[66:67], 0
    v_mov_b64 v[68:69], 0
    v_mov_b64 v[70:71], 0
    v_mov_b64 v[72:73], 0
    v_mov_b64 v[74:75], 0
    v_mov_b64 v[76:77], 0
    v_mov_b64 v[78:79], 0
    v_mov_b64 v[80:81], 0
    v_mov_b64 v[82:83], 0
    v_mov_b64 v[84:85], 0
    v_mov_b64 v[86:87], 0
    v_mov_b64 v[88:89], 0
    v_mov_b64 v[90:91], 0
    v_mov_b64 v[92:93], 0
    v_mov_b64 v[94:95], 0
    v_mov_b64 v[96:97], 0
    v_mov_b64 v[98:99], 0
    v_mov_b64 v[100:101], 0
    v_mov_b64 v[102:103], 0
    v_mov_b64 v[104:105], 0
    v_mov_b64 v[106:107], 0
    v_mov_b64 v[108:109], 0
    v_mov_b64 v[110:111], 0
    v_mov_b64 v[112:113], 0
    v_mov_b64 v[114:115], 0
    v_mov_b64 v[116:117], 0
    v_mov_b64 v[118:119], 0
    v_mov_b64 v[120:121], 0
    v_mov_b64 v[122:123], 0
    v_mov_b64 v[124:125], 0
    v_mov_b64 v[126:127], 0
    s_mov_b32 s78, 73728
    s_mov_b32 s75, 0
    v_add_u32 v215, s78, v208
    v_add_u32 v216, s78, v209
    v_add_u32 v217, s78, v210
    v_add_u32 v218, s78, v211
    v_add_u32 v219, s78, v212
    v_add_u32 v220, s78, v213
    v_add_u32 v221, s78, v214
    s_add_u32 m0, s79, s80
    s_nop 0
    buffer_load_dwordx4 v16, s[28:31], s76 offen offset:0 lds
    buffer_load_dwordx4 v17, s[28:31], s76 offen offset:1024 lds
    buffer_load_dwordx4 v18, s[28:31], s76 offen offset:2048 lds
    buffer_load_dwordx4 v19, s[28:31], s76 offen offset:3072 lds
    s_add_u32 m0, s79, s98
    s_nop 0
    buffer_load_dwordx4 v20, s[32:35], s77 offen offset:0 lds
    buffer_load_dwordx4 v21, s[32:35], s77 offen offset:1024 lds
    buffer_load_dwordx4 v22, s[32:35], s77 offen offset:2048 lds
    buffer_load_dwordx4 v23, s[32:35], s77 offen offset:3072 lds
    s_add_u32 m0, m0, 4096
    s_nop 0
    s_nop 0
    buffer_load_dwordx4 v24, s[32:35], s77 offen lds
    s_add_u32 s76, s76, 128
    s_add_u32 s77, s77, 245760
    s_cmp_eq_u32 s77, 2457600
    s_cselect_b32 s85, 1280, 0
    s_cselect_b32 s77, 0, s77
    s_sub_u32 s76, s76, s85
    s_add_u32 s79, s79, 36864
    s_cmp_eq_u32 s79, 147456
    s_cselect_b32 s79, 0, s79
    s_waitcnt vmcnt(9)
    s_barrier
    s_nop 0
    ds_read_b64_tr_b16 a[128:129], v217 offset:0
    ds_read_b64_tr_b16 a[130:131], v217 offset:1280
    ds_read_b128 a[112:115], v215 offset:0
    ds_read_b128 a[116:119], v215 offset:2048
    ds_read_b128 a[120:123], v215 offset:4096
    ds_read_b128 a[124:127], v215 offset:6144
    ds_read_b64_tr_b16 a[132:133], v218 offset:0
    ds_read_b64_tr_b16 a[134:135], v218 offset:1280
    ds_read_b64_tr_b16 a[136:137], v219 offset:0
    ds_read_b64_tr_b16 a[138:139], v219 offset:1280
    ds_read_b64_tr_b16 a[140:141], v220 offset:0
    ds_read_b64_tr_b16 a[142:143], v220 offset:1280
    ds_read_b64_tr_b16 a[144:145], v221 offset:0
    ds_read_b64_tr_b16 a[146:147], v221 offset:1280
    s_add_u32 m0, s79, s80
    s_nop 0
    buffer_load_dwordx4 v16, s[28:31], s76 offen offset:0 lds
    buffer_load_dwordx4 v17, s[28:31], s76 offen offset:1024 lds
    buffer_load_dwordx4 v18, s[28:31], s76 offen offset:2048 lds
    buffer_load_dwordx4 v19, s[28:31], s76 offen offset:3072 lds
    s_add_u32 m0, s79, s98
    s_nop 0
    buffer_load_dwordx4 v20, s[32:35], s77 offen offset:0 lds
    s_branch q_mid
.p2align 3
q_loop:
    s_cmp_eq_u32 s75, 1
    s_cbranch_scc1 q_blk0
q_noblk:
    s_waitcnt vmcnt(9) lgkmcnt(0)
    s_barrier
    v_mfma_f32_16x16x32_bf16 v[48:51], a[164:167], a[148:151], v[48:51]
    ds_read_b64_tr_b16 a[128:129], v217 offset:0
    ds_read_b64_tr_b16 a[130:131], v217 offset:1280
    v_mfma_f32_16x16x32_bf16 v[68:71], a[164:167], a[152:155], v[68:71]
    ds_read_b128 a[112:115], v215 offset:0
    ds_read_b128 a[116:119], v215 offset:2048
    v_mfma_f32_16x16x32_bf16 v[88:91], a[164:167], a[156:159], v[88:91]
    ds_read_b128 a[120:123], v215 offset:4096
    ds_read_b128 a[124:127], v215 offset:6144
    s_add_u32 m0, s79, s80
    s_nop 0
    v_mfma_f32_16x16x32_bf16 v[108:111], a[164:167], a[160:163], v[108:111]
    ds_read_b64_tr_b16 a[132:133], v218 offset:0
    ds_read_b64_tr_b16 a[134:135], v218 offset:1280
    buffer_load_dwordx4 v16, s[28:31], s76 offen offset:0 lds
    v_mfma_f32_16x16x32_bf16 v[52:55], a[168:171], a[148:151], v[52:55]
    ds_read_b64_tr_b16 a[136:137], v219 offset:0
    ds_read_b64_tr_b16 a[138:139], v219 offset:1280
    v_mfma_f32_16x16x32_bf16 v[72:75], a[168:171], a[152:155], v[72:75]
    ds_read_b64_tr_b16 a[140:141], v220 offset:0
    v_mfma_f32_16x16x32_bf16 v[92:95], a[168:171], a[156:159], v[92:95]
    ds_read_b64_tr_b16 a[142:143], v220 offset:1280
    v_mfma_f32_16x16x32_bf16 v[112:115], a[168:171], a[160:163], v[112:115]
    ds_read_b64_tr_b16 a[144:145], v221 offset:0
    buffer_load_dwordx4 v17, s[28:31], s76 offen offset:1024 lds
    v_mfma_f32_16x16x32_bf16 v[56:59], a[172:175], a[148:151], v[56:59]
    ds_read_b64_tr_b16 a[146:147], v221 offset:1280
    v_mfma_f32_16x16x32_bf16 v[76:79], a[172:175], a[152:155], v[76:79]
    v_mfma_f32_16x16x32_bf16 v[96:99], a[172:175], a[156:159], v[96:99]
    v_mfma_f32_16x16x32_bf16 v[116:119], a[172:175], a[160:163], v[116:119]
    buffer_load_dwordx4 v18, s[28:31], s76 offen offset:2048 lds
    v_mfma_f32_16x16x32_bf16 v[60:63], a[176:179], a[148:151], v[60:63]
    v_mfma_f32_16x16x32_bf16 v[80:83], a[176:179], a[152:155], v[80:83]
    v_mfma_f32_16x16x32_bf16 v[100:103], a[176:179], a[156:159], v[100:103]
    v_mfma_f32_16x16x32_bf16 v[120:123], a[176:179], a[160:163], v[120:123]
    buffer_load_dwordx4 v19, s[28:31], s76 offen offset:3072 lds
    v_mfma_f32_16x16x32_bf16 v[64:67], a[180:183], a[148:151], v[64:67]
    v_mfma_f32_16x16x32_bf16 v[84:87], a[180:183], a[152:155], v[84:87]
    v_mfma_f32_16x16x32_bf16 v[104:107], a[180:183], a[156:159], v[104:107]
    s_add_u32 m0, s79, s98
    v_mfma_f32_16x16x32_bf16 v[124:127], a[180:183], a[160:163], v[124:127]
    buffer_load_dwordx4 v20, s[32:35], s77 offen offset:0 lds
q_mid:
    s_waitcnt lgkmcnt(0)
    v_mfma_f32_16x16x32_bf16 v[48:51], a[128:131], a[112:115], v[48:51]
    ds_read_b64_tr_b16 a[164:165], v217 offset:10240
    ds_read_b64_tr_b16 a[166:167], v217 offset:11520
    v_mfma_f32_16x16x32_bf16 v[68:71], a[128:131], a[116:119], v[68:71]
    ds_read_b128 a[148:151], v216 offset:0
    ds_read_b128 a[152:155], v216 offset:2048
    v_mfma_f32_16x16x32_bf16 v[88:91], a[128:131], a[120:123], v[88:91]
    ds_read_b128 a[156:159], v216 offset:4096
    ds_read_b128 a[160:163], v216 offset:6144
    buffer_load_dwordx4 v21, s[32:35], s77 offen offset:1024 lds
    v_mfma_f32_16x16x32_bf16 v[108:111], a[128:131], a[124:127], v[108:111]
    ds_read_b64_tr_b16 a[168:169], v218 offset:10240
    ds_read_b64_tr_b16 a[170:171], v218 offset:11520
    v_mfma_f32_16x16x32_bf16 v[52:55], a[132:135], a[112:115], v[52:55]
    ds_read_b64_tr_b16 a[172:173], v219 offset:10240
    ds_read_b64_tr_b16 a[174:175], v219 offset:11520
    v_mfma_f32_16x16x32_bf16 v[72:75], a[132:135], a[116:119], v[72:75]
    ds_read_b64_tr_b16 a[176:177], v220 offset:10240
    v_mfma_f32_16x16x32_bf16 v[92:95], a[132:135], a[120:123], v[92:95]
    ds_read_b64_tr_b16 a[178:179], v220 offset:11520
    buffer_load_dwordx4 v22, s[32:35], s77 offen offset:2048 lds
    v_mfma_f32_16x16x32_bf16 v[112:115], a[132:135], a[124:127], v[112:115]
    ds_read_b64_tr_b16 a[180:181], v221 offset:10240
    v_mfma_f32_16x16x32_bf16 v[56:59], a[136:139], a[112:115], v[56:59]
    ds_read_b64_tr_b16 a[182:183], v221 offset:11520
    v_mfma_f32_16x16x32_bf16 v[76:79], a[136:139], a[116:119], v[76:79]
    s_add_u32 s78, s78, 36864
    s_cmp_eq_u32 s78, 147456
    v_mfma_f32_16x16x32_bf16 v[96:99], a[136:139], a[120:123], v[96:99]
    buffer_load_dwordx4 v23, s[32:35], s77 offen offset:3072 lds
    s_cselect_b32 s78, 0, s78
    v_mfma_f32_16x16x32_bf16 v[116:119], a[136:139], a[124:127], v[116:119]
    v_add_u32 v215, s78, v208
    v_add_u32_e64 v216, s78, v209
    v_mfma_f32_16x16x32_bf16 v[60:63], a[140:143], a[112:115], v[60:63]
    s_add_u32 m0, m0, 4096
    v_add_u32_e64 v217, s78, v210
    v_mfma_f32_16x16x32_bf16 v[80:83], a[140:143], a[116:119], v[80:83]
    buffer_load_dwordx4 v24, s[32:35], s77 offen lds
    v_add_u32_e64 v218, s78, v211
    v_mfma_f32_16x16x32_bf16 v[100:103], a[140:143], a[120:123], v[100:103]
    v_add_u32 v219, s78, v212
    v_add_u32 v220, s78, v213
    v_mfma_f32_16x16x32_bf16 v[120:123], a[140:143], a[124:127], v[120:123]
    v_add_u32_e64 v221, s78, v214
    s_add_u32 s76, s76, 128
    v_mfma_f32_16x16x32_bf16 v[64:67], a[144:147], a[112:115], v[64:67]
    s_add_u32 s77, s77, 245760
    s_cmp_eq_u32 s77, 2457600
    v_mfma_f32_16x16x32_bf16 v[84:87], a[144:147], a[116:119], v[84:87]
    s_cselect_b32 s85, 1280, 0
    s_cselect_b32 s77, 0, s77
    v_mfma_f32_16x16x32_bf16 v[104:107], a[144:147], a[120:123], v[104:107]
    s_sub_u32 s76, s76, s85
    s_add_u32 s79, s79, 36864
    v_mfma_f32_16x16x32_bf16 v[124:127], a[144:147], a[124:127], v[124:127]
    s_cmp_eq_u32 s79, 147456
    s_cselect_b32 s79, 0, s79
    s_add_u32 s75, s75, 1
    s_cmp_lt_u32 s75, 6
    s_cbranch_scc1 q_loop
.p2align 3
q_loop2:
    s_waitcnt vmcnt(9) lgkmcnt(0)
    s_barrier
    v_mfma_f32_16x16x32_bf16 v[48:51], a[164:167], a[148:151], v[48:51]
    ds_read_b64_tr_b16 a[128:129], v217 offset:0
    ds_read_b64_tr_b16 a[130:131], v217 offset:1280
    v_mfma_f32_16x16x32_bf16 v[68:71], a[164:167], a[152:155], v[68:71]
    ds_read_b128 a[112:115], v215 offset:0
    ds_read_b128 a[116:119], v215 offset:2048
    v_mfma_f32_16x16x32_bf16 v[88:91], a[164:167], a[156:159], v[88:91]
    ds_read_b128 a[120:123], v215 offset:4096
    ds_read_b128 a[124:127], v215 offset:6144
    s_add_u32 m0, s79, s80
    s_nop 0
    v_mfma_f32_16x16x32_bf16 v[108:111], a[164:167], a[160:163], v[108:111]
    ds_read_b64_tr_b16 a[132:133], v218 offset:0
    ds_read_b64_tr_b16 a[134:135], v218 offset:1280
    buffer_load_dwordx4 v16, s[28:31], s76 offen offset:0 nt lds
    v_mfma_f32_16x16x32_bf16 v[52:55], a[168:171], a[148:151], v[52:55]
    ds_read_b64_tr_b16 a[136:137], v219 offset:0
    ds_read_b64_tr_b16 a[138:139], v219 offset:1280
    v_mfma_f32_16x16x32_bf16 v[72:75], a[168:171], a[152:155], v[72:75]
    ds_read_b64_tr_b16 a[140:141], v220 offset:0
    v_mfma_f32_16x16x32_bf16 v[92:95], a[168:171], a[156:159], v[92:95]
    ds_read_b64_tr_b16 a[142:143], v220 offset:1280
    v_mfma_f32_16x16x32_bf16 v[112:115], a[168:171], a[160:163], v[112:115]
    ds_read_b64_tr_b16 a[144:145], v221 offset:0
    buffer_load_dwordx4 v17, s[28:31], s76 offen offset:1024 nt lds
    v_mfma_f32_16x16x32_bf16 v[56:59], a[172:175], a[148:151], v[56:59]
    ds_read_b64_tr_b16 a[146:147], v221 offset:1280
    v_mfma_f32_16x16x32_bf16 v[76:79], a[172:175], a[152:155], v[76:79]
    v_mfma_f32_16x16x32_bf16 v[96:99], a[172:175], a[156:159], v[96:99]
    v_mfma_f32_16x16x32_bf16 v[116:119], a[172:175], a[160:163], v[116:119]
    buffer_load_dwordx4 v18, s[28:31], s76 offen offset:2048 nt lds
    v_mfma_f32_16x16x32_bf16 v[60:63], a[176:179], a[148:151], v[60:63]
    v_mfma_f32_16x16x32_bf16 v[80:83], a[176:179], a[152:155], v[80:83]
    v_mfma_f32_16x16x32_bf16 v[100:103], a[176:179], a[156:159], v[100:103]
    v_mfma_f32_16x16x32_bf16 v[120:123], a[176:179], a[160:163], v[120:123]
    buffer_load_dwordx4 v19, s[28:31], s76 offen offset:3072 nt lds
    v_mfma_f32_16x16x32_bf16 v[64:67], a[180:183], a[148:151], v[64:67]
    v_mfma_f32_16x16x32_bf16 v[84:87], a[180:183], a[152:155], v[84:87]
    v_mfma_f32_16x16x32_bf16 v[104:107], a[180:183], a[156:159], v[104:107]
    s_add_u32 m0, s79, s98
    v_mfma_f32_16x16x32_bf16 v[124:127], a[180:183], a[160:163], v[124:127]
    buffer_load_dwordx4 v20, s[32:35], s77 offen offset:0 nt lds
    s_waitcnt lgkmcnt(0)
    v_mfma_f32_16x16x32_bf16 v[48:51], a[128:131], a[112:115], v[48:51]
    ds_read_b64_tr_b16 a[164:165], v217 offset:10240
    ds_read_b64_tr_b16 a[166:167], v217 offset:11520
    v_mfma_f32_16x16x32_bf16 v[68:71], a[128:131], a[116:119], v[68:71]
    ds_read_b128 a[148:151], v216 offset:0
    ds_read_b128 a[152:155], v216 offset:2048
    v_mfma_f32_16x16x32_bf16 v[88:91], a[128:131], a[120:123], v[88:91]
    ds_read_b128 a[156:159], v216 offset:4096
    ds_read_b128 a[160:163], v216 offset:6144
    buffer_load_dwordx4 v21, s[32:35], s77 offen offset:1024 nt lds
    v_mfma_f32_16x16x32_bf16 v[108:111], a[128:131], a[124:127], v[108:111]
    ds_read_b64_tr_b16 a[168:169], v218 offset:10240
    ds_read_b64_tr_b16 a[170:171], v218 offset:11520
    v_mfma_f32_16x16x32_bf16 v[52:55], a[132:135], a[112:115], v[52:55]
    ds_read_b64_tr_b16 a[172:173], v219 offset:10240
    ds_read_b64_tr_b16 a[174:175], v219 offset:11520
    v_mfma_f32_16x16x32_bf16 v[72:75], a[132:135], a[116:119], v[72:75]
    ds_read_b64_tr_b16 a[176:177], v220 offset:10240
    v_mfma_f32_16x16x32_bf16 v[92:95], a[132:135], a[120:123], v[92:95]
    ds_read_b64_tr_b16 a[178:179], v220 offset:11520
    buffer_load_dwordx4 v22, s[32:35], s77 offen offset:2048 nt lds
    v_mfma_f32_16x16x32_bf16 v[112:115], a[132:135], a[124:127], v[112:115]
    ds_read_b64_tr_b16 a[180:181], v221 offset:10240
    v_mfma_f32_16x16x32_bf16 v[56:59], a[136:139], a[112:115], v[56:59]
    ds_read_b64_tr_b16 a[182:183], v221 offset:11520
    v_mfma_f32_16x16x32_bf16 v[76:79], a[136:139], a[116:119], v[76:79]
    s_add_u32 s78, s78, 36864
    s_cmp_eq_u32 s78, 147456
    v_mfma_f32_16x16x32_bf16 v[96:99], a[136:139], a[120:123], v[96:99]
    buffer_load_dwordx4 v23, s[32:35], s77 offen offset:3072 nt lds
    s_cselect_b32 s78, 0, s78
    v_mfma_f32_16x16x32_bf16 v[116:119], a[136:139], a[124:127], v[116:119]
    v_add_u32 v215, s78, v208
    v_add_u32_e64 v216, s78, v209
    v_mfma_f32_16x16x32_bf16 v[60:63], a[140:143], a[112:115], v[60:63]
    s_add_u32 m0, m0, 4096
    v_add_u32_e64 v217, s78, v210
    v_mfma_f32_16x16x32_bf16 v[80:83], a[140:143], a[116:119], v[80:83]
    buffer_load_dwordx4 v24, s[32:35], s77 offen nt lds
    v_add_u32_e64 v218, s78, v211
    v_mfma_f32_16x16x32_bf16 v[100:103], a[140:143], a[120:123], v[100:103]
    v_add_u32 v219, s78, v212
    v_add_u32 v220, s78, v213
    v_mfma_f32_16x16x32_bf16 v[120:123], a[140:143], a[124:127], v[120:123]
    v_add_u32_e64 v221, s78, v214
    s_add_u32 s76, s76, 128
    v_mfma_f32_16x16x32_bf16 v[64:67], a[144:147], a[112:115], v[64:67]
    s_add_u32 s77, s77, 245760
    s_cmp_eq_u32 s77, 2457600
    v_mfma_f32_16x16x32_bf16 v[84:87], a[144:147], a[116:119], v[84:87]
    s_cselect_b32 s85, 1280, 0
    s_cselect_b32 s77, 0, s77
    v_mfma_f32_16x16x32_bf16 v[104:107], a[144:147], a[120:123], v[104:107]
    s_sub_u32 s76, s76, s85
    s_add_u32 s79, s79, 36864
    v_mfma_f32_16x16x32_bf16 v[124:127], a[144:147], a[124:127], v[124:127]
    s_cmp_eq_u32 s79, 147456
    s_cselect_b32 s79, 0, s79
    s_add_u32 s75, s75, 1
    s_cmp_lt_u32 s75, 8
    s_cbranch_scc1 q_loop2
    s_waitcnt vmcnt(9) lgkmcnt(0)
    s_barrier
    v_mfma_f32_16x16x32_bf16 v[48:51], a[164:167], a[148:151], v[48:51]
    ds_read_b64_tr_b16 a[128:129], v217 offset:0
    ds_read_b64_tr_b16 a[130:131], v217 offset:1280
    v_mfma_f32_16x16x32_bf16 v[68:71], a[164:167], a[152:155], v[68:71]
    ds_read_b128 a[112:115], v215 offset:0
    ds_read_b128 a[116:119], v215 offset:2048
    v_mfma_f32_16x16x32_bf16 v[88:91], a[164:167], a[156:159], v[88:91]
    ds_read_b128 a[120:123], v215 offset:4096
    ds_read_b128 a[124:127], v215 offset:6144
    buffer_load_dword v14, v13, s[36:39], s24 offen sc1
    v_mfma_f32_16x16x32_bf16 v[108:111], a[164:167], a[160:163], v[108:111]
    ds_read_b64_tr_b16 a[132:133], v218 offset:0
    ds_read_b64_tr_b16 a[134:135], v218 offset:1280
    v_mfma_f32_16x16x32_bf16 v[52:55], a[168:171], a[148:151], v[52:55]
    ds_read_b64_tr_b16 a[136:137], v219 offset:0
    ds_read_b64_tr_b16 a[138:139], v219 offset:1280
    s_lshl_b32 m0, s68, 12
    s_nop 0
    v_mfma_f32_16x16x32_bf16 v[72:75], a[168:171], a[152:155], v[72:75]
    ds_read_b64_tr_b16 a[140:141], v220 offset:0
    buffer_load_dwordx4 v248, s[52:55], s67 offen offset:0 lds
    v_mfma_f32_16x16x32_bf16 v[92:95], a[168:171], a[156:159], v[92:95]
    ds_read_b64_tr_b16 a[142:143], v220 offset:1280
    v_mfma_f32_16x16x32_bf16 v[112:115], a[168:171], a[160:163], v[112:115]
    ds_read_b64_tr_b16 a[144:145], v221 offset:0
    v_mfma_f32_16x16x32_bf16 v[56:59], a[172:175], a[148:151], v[56:59]
    ds_read_b64_tr_b16 a[146:147], v221 offset:1280
    buffer_load_dwordx4 v249, s[52:55], s67 offen offset:1024 lds
    v_mfma_f32_16x16x32_bf16 v[76:79], a[172:175], a[152:155], v[76:79]
    v_mfma_f32_16x16x32_bf16 v[96:99], a[172:175], a[156:159], v[96:99]
    v_mfma_f32_16x16x32_bf16 v[116:119], a[172:175], a[160:163], v[116:119]
    buffer_load_dwordx4 v250, s[52:55], s67 offen offset:2048 lds
    v_mfma_f32_16x16x32_bf16 v[60:63], a[176:179], a[148:151], v[60:63]
    v_mfma_f32_16x16x32_bf16 v[80:83], a[176:179], a[152:155], v[80:83]
    v_mfma_f32_16x16x32_bf16 v[100:103], a[176:179], a[156:159], v[100:103]
    buffer_load_dwordx4 v251, s[52:55], s67 offen offset:3072 lds
    v_mfma_f32_16x16x32_bf16 v[120:123], a[176:179], a[160:163], v[120:123]
    v_mfma_f32_16x16x32_bf16 v[64:67], a[180:183], a[148:151], v[64:67]
    v_mfma_f32_16x16x32_bf16 v[84:87], a[180:183], a[152:155], v[84:87]
    v_mfma_f32_16x16x32_bf16 v[104:107], a[180:183], a[156:159], v[104:107]
    v_mfma_f32_16x16x32_bf16 v[124:127], a[180:183], a[160:163], v[124:127]
    s_waitcnt lgkmcnt(0)
    s_nop 0
    v_mfma_f32_16x16x32_bf16 v[48:51], a[128:131], a[112:115], v[48:51]
    ds_read_b64_tr_b16 a[164:165], v217 offset:10240
    ds_read_b64_tr_b16 a[166:167], v217 offset:11520
    v_mfma_f32_16x16x32_bf16 v[68:71], a[128:131], a[116:119], v[68:71]
    ds_read_b128 a[148:151], v216 offset:0
    ds_read_b128 a[152:155], v216 offset:2048
    v_mfma_f32_16x16x32_bf16 v[88:91], a[128:131], a[120:123], v[88:91]
    ds_read_b128 a[156:159], v216 offset:4096
    ds_read_b128 a[160:163], v216 offset:6144
    v_mfma_f32_16x16x32_bf16 v[108:111], a[128:131], a[124:127], v[108:111]
    ds_read_b64_tr_b16 a[168:169], v218 offset:10240
    ds_read_b64_tr_b16 a[170:171], v218 offset:11520
    v_mfma_f32_16x16x32_bf16 v[52:55], a[132:135], a[112:115], v[52:55]
    ds_read_b64_tr_b16 a[172:173], v219 offset:10240
    ds_read_b64_tr_b16 a[174:175], v219 offset:11520
    v_mfma_f32_16x16x32_bf16 v[72:75], a[132:135], a[116:119], v[72:75]
    ds_read_b64_tr_b16 a[176:177], v220 offset:10240
    v_mfma_f32_16x16x32_bf16 v[92:95], a[132:135], a[120:123], v[92:95]
    ds_read_b64_tr_b16 a[178:179], v220 offset:11520
    v_mfma_f32_16x16x32_bf16 v[112:115], a[132:135], a[124:127], v[112:115]
    ds_read_b64_tr_b16 a[180:181], v221 offset:10240
    v_mfma_f32_16x16x32_bf16 v[56:59], a[136:139], a[112:115], v[56:59]
    ds_read_b64_tr_b16 a[182:183], v221 offset:11520
    v_mfma_f32_16x16x32_bf16 v[76:79], a[136:139], a[116:119], v[76:79]
    s_add_u32 s78, s78, 36864
    s_cmp_eq_u32 s78, 147456
    v_mfma_f32_16x16x32_bf16 v[96:99], a[136:139], a[120:123], v[96:99]
    s_cselect_b32 s78, 0, s78
    v_add_u32 v215, s78, v208
    v_mfma_f32_16x16x32_bf16 v[116:119], a[136:139], a[124:127], v[116:119]
    v_add_u32 v216, s78, v209
    v_add_u32 v217, s78, v210
    v_mfma_f32_16x16x32_bf16 v[60:63], a[140:143], a[112:115], v[60:63]
    v_add_u32 v218, s78, v211
    v_add_u32 v219, s78, v212
    v_mfma_f32_16x16x32_bf16 v[80:83], a[140:143], a[116:119], v[80:83]
    v_add_u32 v220, s78, v213
    v_add_u32 v221, s78, v214
    v_mfma_f32_16x16x32_bf16 v[100:103], a[140:143], a[120:123], v[100:103]
    v_mfma_f32_16x16x32_bf16 v[120:123], a[140:143], a[124:127], v[120:123]
    v_mfma_f32_16x16x32_bf16 v[64:67], a[144:147], a[112:115], v[64:67]
    v_mfma_f32_16x16x32_bf16 v[84:87], a[144:147], a[116:119], v[84:87]
    v_mfma_f32_16x16x32_bf16 v[104:107], a[144:147], a[120:123], v[104:107]
    v_mfma_f32_16x16x32_bf16 v[124:127], a[144:147], a[124:127], v[124:127]
    s_waitcnt vmcnt(0) lgkmcnt(0)
    v_cmp_ne_u32_e64 vcc, s16, v14
    s_cbranch_vccz pln3_ok
    s_mov_b32 s98, 0
pln3_spin:
    s_add_u32 s98, s98, 1
    s_cmp_gt_u32 s98, 0x80000
    s_cbranch_scc1 pln3_ok
    s_sleep 1
    buffer_load_dword v14, v13, s[36:39], s24 offen sc1
    s_waitcnt vmcnt(0)
    v_cmp_ne_u32 vcc, s16, v14
    s_cbranch_vccnz pln3_spin
pln3_ok:
    s_barrier
    v_mfma_f32_16x16x32_bf16 v[48:51], a[164:167], a[148:151], v[48:51]
    ds_read_b64_tr_b16 a[128:129], v217 offset:0
    ds_read_b64_tr_b16 a[130:131], v217 offset:1280
    v_mfma_f32_16x16x32_bf16 v[68:71], a[164:167], a[152:155], v[68:71]
    ds_read_b128 a[112:115], v215 offset:0
    ds_read_b128 a[116:119], v215 offset:2048
    v_mfma_f32_16x16x32_bf16 v[88:91], a[164:167], a[156:159], v[88:91]
    ds_read_b128 a[120:123], v215 offset:4096
    ds_read_b128 a[124:127], v215 offset:6144
    buffer_load_dword v8, v25, s[36:39], s23 offen offset:0 sc1
    v_mfma_f32_16x16x32_bf16 v[108:111], a[164:167], a[160:163], v[108:111]
    ds_read_b64_tr_b16 a[132:133], v218 offset:0
    ds_read_b64_tr_b16 a[134:135], v218 offset:1280
    v_mfma_f32_16x16x32_bf16 v[52:55], a[168:171], a[148:151], v[52:55]
    ds_read_b64_tr_b16 a[136:137], v219 offset:0
    ds_read_b64_tr_b16 a[138:139], v219 offset:1280
    v_mfma_f32_16x16x32_bf16 v[72:75], a[168:171], a[152:155], v[72:75]
    ds_read_b64_tr_b16 a[140:141], v220 offset:0
    buffer_load_dword v9, v25, s[36:39], s23 offen offset:64 sc1
    v_mfma_f32_16x16x32_bf16 v[92:95], a[168:171], a[156:159], v[92:95]
    ds_read_b64_tr_b16 a[142:143], v220 offset:1280
    v_mfma_f32_16x16x32_bf16 v[112:115], a[168:171], a[160:163], v[112:115]
    ds_read_b64_tr_b16 a[144:145], v221 offset:0
    v_mfma_f32_16x16x32_bf16 v[56:59], a[172:175], a[148:151], v[56:59]
    ds_read_b64_tr_b16 a[146:147], v221 offset:1280
    buffer_load_dword v10, v25, s[36:39], s23 offen offset:128 sc1
    v_mfma_f32_16x16x32_bf16 v[76:79], a[172:175], a[152:155], v[76:79]
    v_mfma_f32_16x16x32_bf16 v[96:99], a[172:175], a[156:159], v[96:99]
    v_mfma_f32_16x16x32_bf16 v[116:119], a[172:175], a[160:163], v[116:119]
    buffer_load_dword v11, v25, s[36:39], s23 offen offset:192 sc1
    v_mfma_f32_16x16x32_bf16 v[60:63], a[176:179], a[148:151], v[60:63]
    v_mfma_f32_16x16x32_bf16 v[80:83], a[176:179], a[152:155], v[80:83]
    v_mfma_f32_16x16x32_bf16 v[100:103], a[176:179], a[156:159], v[100:103]
    v_mfma_f32_16x16x32_bf16 v[120:123], a[176:179], a[160:163], v[120:123]
    v_mfma_f32_16x16x32_bf16 v[64:67], a[180:183], a[148:151], v[64:67]
    v_mfma_f32_16x16x32_bf16 v[84:87], a[180:183], a[152:155], v[84:87]
    v_mfma_f32_16x16x32_bf16 v[104:107], a[180:183], a[156:159], v[104:107]
    v_mfma_f32_16x16x32_bf16 v[124:127], a[180:183], a[160:163], v[124:127]
    s_waitcnt lgkmcnt(0)
    s_nop 0
    v_mfma_f32_16x16x32_bf16 v[48:51], a[128:131], a[112:115], v[48:51]
    ds_read_b64_tr_b16 a[164:165], v217 offset:10240
    ds_read_b64_tr_b16 a[166:167], v217 offset:11520
    v_mfma_f32_16x16x32_bf16 v[68:71], a[128:131], a[116:119], v[68:71]
    ds_read_b128 a[148:151], v216 offset:0
    ds_read_b128 a[152:155], v216 offset:2048
    v_mfma_f32_16x16x32_bf16 v[88:91], a[128:131], a[120:123], v[88:91]
    ds_read_b128 a[156:159], v216 offset:4096
    ds_read_b128 a[160:163], v216 offset:6144
    v_mfma_f32_16x16x32_bf16 v[108:111], a[128:131], a[124:127], v[108:111]
    ds_read_b64_tr_b16 a[168:169], v218 offset:10240
    ds_read_b64_tr_b16 a[170:171], v218 offset:11520
    v_mfma_f32_16x16x32_bf16 v[52:55], a[132:135], a[112:115], v[52:55]
    ds_read_b64_tr_b16 a[172:173], v219 offset:10240
    ds_read_b64_tr_b16 a[174:175], v219 offset:11520
    v_mfma_f32_16x16x32_bf16 v[72:75], a[132:135], a[116:119], v[72:75]
    ds_read_b64_tr_b16 a[176:177], v220 offset:10240
    v_mfma_f32_16x16x32_bf16 v[92:95], a[132:135], a[120:123], v[92:95]
    ds_read_b64_tr_b16 a[178:179], v220 offset:11520
    v_mfma_f32_16x16x32_bf16 v[112:115], a[132:135], a[124:127], v[112:115]
    ds_read_b64_tr_b16 a[180:181], v221 offset:10240
    v_mfma_f32_16x16x32_bf16 v[56:59], a[136:139], a[112:115], v[56:59]
    ds_read_b64_tr_b16 a[182:183], v221 offset:11520
    v_mfma_f32_16x16x32_bf16 v[76:79], a[136:139], a[116:119], v[76:79]
    s_add_u32 s78, s78, 36864
    s_cmp_eq_u32 s78, 147456
    v_mfma_f32_16x16x32_bf16 v[96:99], a[136:139], a[120:123], v[96:99]
    s_cselect_b32 s78, 0, s78
    v_add_u32 v215, s78, v208
    v_mfma_f32_16x16x32_bf16 v[116:119], a[136:139], a[124:127], v[116:119]
    v_add_u32 v216, s78, v209
    v_add_u32 v217, s78, v210
    v_mfma_f32_16x16x32_bf16 v[60:63], a[140:143], a[112:115], v[60:63]
    v_add_u32 v218, s78, v211
    v_add_u32 v219, s78, v212
    v_mfma_f32_16x16x32_bf16 v[80:83], a[140:143], a[116:119], v[80:83]
    v_add_u32 v220, s78, v213
    v_add_u32 v221, s78, v214
    v_mfma_f32_16x16x32_bf16 v[100:103], a[140:143], a[120:123], v[100:103]
    v_mfma_f32_16x16x32_bf16 v[120:123], a[140:143], a[124:127], v[120:123]
    v_mfma_f32_16x16x32_bf16 v[64:67], a[144:147], a[112:115], v[64:67]
    v_mfma_f32_16x16x32_bf16 v[84:87], a[144:147], a[116:119], v[84:87]
    v_mfma_f32_16x16x32_bf16 v[104:107], a[144:147], a[120:123], v[104:107]
    v_mfma_f32_16x16x32_bf16 v[124:127], a[144:147], a[124:127], v[124:127]
    s_waitcnt lgkmcnt(0)
    s_nop 0
    s_mov_b32 s24, 0x976080
    ds_read_b64_tr_b16 a[0:1], v246 offset:0
    ds_read_b64_tr_b16 a[2:3], v247 offset:2560
    ds_read_b64_tr_b16 a[4:5], v247 offset:7680
    ds_read_b64_tr_b16 a[6:7], v246 offset:128
    ds_read_b64_tr_b16 a[8:9], v247 offset:2688
    ds_read_b64_tr_b16 a[10:11], v247 offset:7808
    ds_read_b64_tr_b16 a[12:13], v246 offset:256
    ds_read_b64_tr_b16 a[14:15], v247 offset:2816
    ds_read_b64_tr_b16 a[16:17], v247 offset:7936
    v_mov_b32 v2, 67136
    v_mov_b64_e64 v[4:5], 0
    ds_write_b64 v2, v[4:5]
    s_mov_b32 s88, 0x3fb8aa3b
    s_mov_b32 s89, 0x3fb8aa3b
    v_mfma_f32_16x16x32_bf16 v[48:51], a[164:167], a[148:151], v[48:51]
    v_mfma_f32_16x16x32_bf16 v[52:55], a[168:171], a[148:151], v[52:55]
    v_mfma_f32_16x16x32_bf16 v[56:59], a[172:175], a[148:151], v[56:59]
    v_mfma_f32_16x16x32_bf16 v[60:63], a[176:179], a[148:151], v[60:63]
    v_mfma_f32_16x16x32_bf16 v[64:67], a[180:183], a[148:151], v[64:67]
    v_mfma_f32_16x16x32_bf16 v[68:71], a[164:167], a[152:155], v[68:71]
    v_mfma_f32_16x16x32_bf16 v[72:75], a[168:171], a[152:155], v[72:75]
    v_mfma_f32_16x16x32_bf16 v[76:79], a[172:175], a[152:155], v[76:79]
    v_mfma_f32_16x16x32_bf16 v[80:83], a[176:179], a[152:155], v[80:83]
    v_mfma_f32_16x16x32_bf16 v[84:87], a[180:183], a[152:155], v[84:87]
    v_pk_mul_f32 v[208:209], v[48:49], s[88:89]
    v_pk_mul_f32 v[210:211], v[50:51], s[88:89]
    v_mfma_f32_16x16x32_bf16 v[88:91], a[164:167], a[156:159], v[88:91]
    v_exp_f32 v208, v208 clamp
    v_exp_f32 v209, v209 clamp
    v_mfma_f32_16x16x32_bf16 v[92:95], a[168:171], a[156:159], v[92:95]
    v_exp_f32 v210, v210 clamp
    v_exp_f32 v211, v211 clamp
    v_mfma_f32_16x16x32_bf16 v[96:99], a[172:175], a[156:159], v[96:99]
    v_max_f32 v48, 0x358637bd, v48
    v_max_f32 v49, 0x358637bd, v49
    v_mfma_f32_16x16x32_bf16 v[100:103], a[176:179], a[156:159], v[100:103]
    v_max_f32 v50, 0x358637bd, v50
    v_max_f32 v51, 0x358637bd, v51
    v_mfma_f32_16x16x32_bf16 v[104:107], a[180:183], a[156:159], v[104:107]
    v_pk_add_f32 v[48:49], v[48:49], v[208:209]
    v_pk_add_f32 v[50:51], v[50:51], v[210:211]
    v_mfma_f32_16x16x32_bf16 v[108:111], a[164:167], a[160:163], v[108:111]
    v_cvt_pk_bf16_f32 v128, v48, v49
    v_cvt_pk_bf16_f32 v129, v50, v51
    v_mfma_f32_16x16x32_bf16 v[112:115], a[168:171], a[160:163], v[112:115]
    v_pk_mul_f32 v[208:209], v[52:53], s[88:89]
    v_pk_mul_f32 v[210:211], v[54:55], s[88:89]
    v_mfma_f32_16x16x32_bf16 v[116:119], a[172:175], a[160:163], v[116:119]
    v_exp_f32 v208, v208 clamp
    v_exp_f32 v209, v209 clamp
    v_mfma_f32_16x16x32_bf16 v[120:123], a[176:179], a[160:163], v[120:123]
    v_exp_f32 v210, v210 clamp
    v_exp_f32 v211, v211 clamp
    v_mfma_f32_16x16x32_bf16 v[124:127], a[180:183], a[160:163], v[124:127]
    v_max_f32 v52, 0x358637bd, v52
    v_max_f32 v53, 0x358637bd, v53
    v_max_f32 v54, 0x358637bd, v54
    v_max_f32 v55, 0x358637bd, v55
    v_pk_add_f32 v[52:53], v[52:53], v[208:209]
    v_pk_add_f32 v[54:55], v[54:55], v[210:211]
    v_cvt_pk_bf16_f32 v130, v52, v53
    v_cvt_pk_bf16_f32 v131, v54, v55
    v_pk_mul_f32 v[208:209], v[56:57], s[88:89]
    v_pk_mul_f32 v[210:211], v[58:59], s[88:89]
    v_exp_f32 v208, v208 clamp
    v_exp_f32 v209, v209 clamp
    v_exp_f32 v210, v210 clamp
    v_exp_f32 v211, v211 clamp
    v_max_f32 v56, 0x358637bd, v56
    v_max_f32 v57, 0x358637bd, v57
    v_max_f32 v58, 0x358637bd, v58
    v_max_f32 v59, 0x358637bd, v59
    v_pk_add_f32 v[56:57], v[56:57], v[208:209]
    v_pk_add_f32 v[58:59], v[58:59], v[210:211]
    v_cvt_pk_bf16_f32 v132, v56, v57
    v_cvt_pk_bf16_f32 v133, v58, v59
    v_pk_mul_f32 v[208:209], v[60:61], s[88:89]
    v_pk_mul_f32 v[210:211], v[62:63], s[88:89]
    v_exp_f32 v208, v208 clamp
    v_exp_f32 v209, v209 clamp
    v_exp_f32 v210, v210 clamp
    v_exp_f32 v211, v211 clamp
    v_max_f32 v60, 0x358637bd, v60
    v_max_f32 v61, 0x358637bd, v61
    v_max_f32 v62, 0x358637bd, v62
    v_max_f32 v63, 0x358637bd, v63
    v_pk_add_f32 v[60:61], v[60:61], v[208:209]
    v_pk_add_f32 v[62:63], v[62:63], v[210:211]
    v_cvt_pk_bf16_f32 v134, v60, v61
    v_cvt_pk_bf16_f32 v135, v62, v63
    v_pk_mul_f32 v[208:209], v[64:65], s[88:89]
    v_pk_mul_f32 v[210:211], v[66:67], s[88:89]
    v_exp_f32 v208, v208 clamp
    v_exp_f32 v209, v209 clamp
    v_exp_f32 v210, v210 clamp
    v_exp_f32 v211, v211 clamp
    v_max_f32 v64, 0x358637bd, v64
    v_max_f32 v65, 0x358637bd, v65
    v_max_f32 v66, 0x358637bd, v66
    v_max_f32 v67, 0x358637bd, v67
    v_pk_add_f32 v[64:65], v[64:65], v[208:209]
    v_pk_add_f32 v[66:67], v[66:67], v[210:211]
    v_cvt_pk_bf16_f32 v136, v64, v65
    v_cvt_pk_bf16_f32 v137, v66, v67
    v_pk_mul_f32 v[208:209], v[68:69], s[88:89]
    v_pk_mul_f32 v[210:211], v[70:71], s[88:89]
    v_exp_f32 v208, v208 clamp
    v_exp_f32 v209, v209 clamp
    v_exp_f32 v210, v210 clamp
    v_exp_f32 v211, v211 clamp
    v_max_f32 v68, 0x358637bd, v68
    v_max_f32 v69, 0x358637bd, v69
    v_max_f32 v70, 0x358637bd, v70
    v_max_f32 v71, 0x358637bd, v71
    v_pk_add_f32 v[68:69], v[68:69], v[208:209]
    v_pk_add_f32 v[70:71], v[70:71], v[210:211]
    v_cvt_pk_bf16_f32 v138, v68, v69
    v_cvt_pk_bf16_f32 v139, v70, v71
    v_pk_mul_f32 v[208:209], v[72:73], s[88:89]
    v_pk_mul_f32 v[210:211], v[74:75], s[88:89]
    v_exp_f32 v208, v208 clamp
    v_exp_f32 v209, v209 clamp
    v_exp_f32 v210, v210 clamp
    v_exp_f32 v211, v211 clamp
    v_max_f32 v72, 0x358637bd, v72
    v_max_f32 v73, 0x358637bd, v73
    v_max_f32 v74, 0x358637bd, v74
    v_max_f32 v75, 0x358637bd, v75
    v_pk_add_f32 v[72:73], v[72:73], v[208:209]
    v_pk_add_f32 v[74:75], v[74:75], v[210:211]
    v_cvt_pk_bf16_f32 v140, v72, v73
    v_cvt_pk_bf16_f32 v141, v74, v75
    v_pk_mul_f32 v[208:209], v[76:77], s[88:89]
    v_pk_mul_f32 v[210:211], v[78:79], s[88:89]
    v_exp_f32 v208, v208 clamp
    v_exp_f32 v209, v209 clamp
    v_exp_f32 v210, v210 clamp
    v_exp_f32 v211, v211 clamp
    v_max_f32 v76, 0x358637bd, v76
    v_max_f32 v77, 0x358637bd, v77
    v_max_f32 v78, 0x358637bd, v78
    v_max_f32 v79, 0x358637bd, v79
    v_pk_add_f32 v[76:77], v[76:77], v[208:209]
    v_pk_add_f32 v[78:79], v[78:79], v[210:211]
    v_cvt_pk_bf16_f32 v142, v76, v77
    v_cvt_pk_bf16_f32 v143, v78, v79
    v_pk_mul_f32 v[208:209], v[80:81], s[88:89]
    v_pk_mul_f32 v[210:211], v[82:83], s[88:89]
    v_exp_f32 v208, v208 clamp
    v_exp_f32 v209, v209 clamp
    v_exp_f32 v210, v210 clamp
    v_exp_f32 v211, v211 clamp
    v_max_f32 v80, 0x358637bd, v80
    v_max_f32 v81, 0x358637bd, v81
    v_max_f32 v82, 0x358637bd, v82
    v_max_f32 v83, 0x358637bd, v83
    v_pk_add_f32 v[80:81], v[80:81], v[208:209]
    v_pk_add_f32 v[82:83], v[82:83], v[210:211]
    v_cvt_pk_bf16_f32 v144, v80, v81
    v_cvt_pk_bf16_f32 v145, v82, v83
    v_pk_mul_f32 v[208:209], v[84:85], s[88:89]
    v_pk_mul_f32 v[210:211], v[86:87], s[88:89]
    v_exp_f32 v208, v208 clamp
    v_exp_f32 v209, v209 clamp
    v_exp_f32 v210, v210 clamp
    v_exp_f32 v211, v211 clamp
    v_max_f32 v84, 0x358637bd, v84
    v_max_f32 v85, 0x358637bd, v85
    v_max_f32 v86, 0x358637bd, v86
    v_max_f32 v87, 0x358637bd, v87
    v_pk_add_f32 v[84:85], v[84:85], v[208:209]
    v_pk_add_f32 v[86:87], v[86:87], v[210:211]
    v_cvt_pk_bf16_f32 v146, v84, v85
    v_cvt_pk_bf16_f32 v147, v86, v87
    v_pk_mul_f32 v[208:209], v[88:89], s[88:89]
    v_pk_mul_f32 v[210:211], v[90:91], s[88:89]
    v_exp_f32 v208, v208 clamp
    v_exp_f32 v209, v209 clamp
    v_exp_f32 v210, v210 clamp
    v_exp_f32 v211, v211 clamp
    v_max_f32 v88, 0x358637bd, v88
    v_max_f32 v89, 0x358637bd, v89
    v_max_f32 v90, 0x358637bd, v90
    v_max_f32 v91, 0x358637bd, v91
    v_pk_add_f32 v[88:89], v[88:89], v[208:209]
    v_pk_add_f32 v[90:91], v[90:91], v[210:211]
    v_cvt_pk_bf16_f32 v148, v88, v89
    v_cvt_pk_bf16_f32 v149, v90, v91
    v_pk_mul_f32 v[208:209], v[92:93], s[88:89]
    v_pk_mul_f32 v[210:211], v[94:95], s[88:89]
    v_exp_f32 v208, v208 clamp
    v_exp_f32 v209, v209 clamp
    v_exp_f32 v210, v210 clamp
    v_exp_f32 v211, v211 clamp
    v_max_f32 v92, 0x358637bd, v92
    v_max_f32 v93, 0x358637bd, v93
    v_max_f32 v94, 0x358637bd, v94
    v_max_f32 v95, 0x358637bd, v95
    v_pk_add_f32 v[92:93], v[92:93], v[208:209]
    v_pk_add_f32 v[94:95], v[94:95], v[210:211]
    v_cvt_pk_bf16_f32 v150, v92, v93
    v_cvt_pk_bf16_f32 v151, v94, v95
    buffer_load_dword v14, v245, s[36:39], s24 offen sc1
    v_pk_mul_f32 v[208:209], v[96:97], s[88:89]
    v_pk_mul_f32 v[210:211], v[98:99], s[88:89]
    v_exp_f32 v208, v208 clamp
    v_exp_f32 v209, v209 clamp
    v_exp_f32 v210, v210 clamp
    v_exp_f32 v211, v211 clamp
    v_max_f32 v96, 0x358637bd, v96
    v_max_f32 v97, 0x358637bd, v97
    v_max_f32 v98, 0x358637bd, v98
    v_max_f32 v99, 0x358637bd, v99
    v_pk_add_f32 v[96:97], v[96:97], v[208:209]
    v_pk_add_f32 v[98:99], v[98:99], v[210:211]
    v_cvt_pk_bf16_f32 v152, v96, v97
    v_cvt_pk_bf16_f32 v153, v98, v99
    v_pk_mul_f32 v[208:209], v[100:101], s[88:89]
    v_pk_mul_f32 v[210:211], v[102:103], s[88:89]
    v_exp_f32 v208, v208 clamp
    v_exp_f32 v209, v209 clamp
    v_exp_f32 v210, v210 clamp
    v_exp_f32 v211, v211 clamp
    v_max_f32 v100, 0x358637bd, v100
    v_max_f32 v101, 0x358637bd, v101
    v_max_f32 v102, 0x358637bd, v102
    v_max_f32 v103, 0x358637bd, v103
    v_pk_add_f32 v[100:101], v[100:101], v[208:209]
    v_pk_add_f32 v[102:103], v[102:103], v[210:211]
    v_cvt_pk_bf16_f32 v154, v100, v101
    v_cvt_pk_bf16_f32 v155, v102, v103
    v_pk_mul_f32 v[208:209], v[104:105], s[88:89]
    v_pk_mul_f32 v[210:211], v[106:107], s[88:89]
    v_exp_f32 v208, v208 clamp
    v_exp_f32 v209, v209 clamp
    v_exp_f32 v210, v210 clamp
    v_exp_f32 v211, v211 clamp
    v_max_f32 v104, 0x358637bd, v104
    v_max_f32 v105, 0x358637bd, v105
    v_max_f32 v106, 0x358637bd, v106
    v_max_f32 v107, 0x358637bd, v107
    v_pk_add_f32 v[104:105], v[104:105], v[208:209]
    v_pk_add_f32 v[106:107], v[106:107], v[210:211]
    v_cvt_pk_bf16_f32 v156, v104, v105
    v_cvt_pk_bf16_f32 v157, v106, v107
    v_pk_mul_f32 v[208:209], v[108:109], s[88:89]
    v_pk_mul_f32 v[210:211], v[110:111], s[88:89]
    v_exp_f32 v208, v208 clamp
    v_exp_f32 v209, v209 clamp
    v_exp_f32 v210, v210 clamp
    v_exp_f32 v211, v211 clamp
    v_max_f32 v108, 0x358637bd, v108
    v_max_f32 v109, 0x358637bd, v109
    v_max_f32 v110, 0x358637bd, v110
    v_max_f32 v111, 0x358637bd, v111
    v_pk_add_f32 v[108:109], v[108:109], v[208:209]
    v_pk_add_f32 v[110:111], v[110:111], v[210:211]
    v_cvt_pk_bf16_f32 v158, v108, v109
    v_cvt_pk_bf16_f32 v159, v110, v111
    v_pk_mul_f32 v[208:209], v[112:113], s[88:89]
    v_pk_mul_f32 v[210:211], v[114:115], s[88:89]
    v_exp_f32 v208, v208 clamp
    v_exp_f32 v209, v209 clamp
    v_exp_f32 v210, v210 clamp
    v_exp_f32 v211, v211 clamp
    v_max_f32 v112, 0x358637bd, v112
    v_max_f32 v113, 0x358637bd, v113
    v_max_f32 v114, 0x358637bd, v114
    v_max_f32 v115, 0x358637bd, v115
    v_pk_add_f32 v[112:113], v[112:113], v[208:209]
    v_pk_add_f32 v[114:115], v[114:115], v[210:211]
    v_cvt_pk_bf16_f32 v160, v112, v113
    v_cvt_pk_bf16_f32 v161, v114, v115
    v_pk_mul_f32 v[208:209], v[116:117], s[88:89]
    v_pk_mul_f32 v[210:211], v[118:119], s[88:89]
    v_exp_f32 v208, v208 clamp
    v_exp_f32 v209, v209 clamp
    v_exp_f32 v210, v210 clamp
    v_exp_f32 v211, v211 clamp
    v_max_f32 v116, 0x358637bd, v116
    v_max_f32 v117, 0x358637bd, v117
    v_max_f32 v118, 0x358637bd, v118
    v_max_f32 v119, 0x358637bd, v119
    v_pk_add_f32 v[116:117], v[116:117], v[208:209]
    v_pk_add_f32 v[118:119], v[118:119], v[210:211]
    v_cvt_pk_bf16_f32 v162, v116, v117
    v_cvt_pk_bf16_f32 v163, v118, v119
    v_pk_mul_f32 v[208:209], v[120:121], s[88:89]
    v_pk_mul_f32 v[210:211], v[122:123], s[88:89]
    v_exp_f32 v208, v208 clamp
    v_exp_f32 v209, v209 clamp
    v_exp_f32 v210, v210 clamp
    v_exp_f32 v211, v211 clamp
    v_max_f32 v120, 0x358637bd, v120
    v_max_f32 v121, 0x358637bd, v121
    v_max_f32 v122, 0x358637bd, v122
    v_max_f32 v123, 0x358637bd, v123
    v_pk_add_f32 v[120:121], v[120:121], v[208:209]
    v_pk_add_f32 v[122:123], v[122:123], v[210:211]
    v_cvt_pk_bf16_f32 v164, v120, v121
    v_cvt_pk_bf16_f32 v165, v122, v123
    v_pk_mul_f32 v[208:209], v[124:125], s[88:89]
    v_pk_mul_f32 v[210:211], v[126:127], s[88:89]
    v_exp_f32 v208, v208 clamp
    v_exp_f32 v209, v209 clamp
    v_exp_f32 v210, v210 clamp
    v_exp_f32 v211, v211 clamp
    v_max_f32 v124, 0x358637bd, v124
    v_max_f32 v125, 0x358637bd, v125
    v_max_f32 v126, 0x358637bd, v126
    v_max_f32 v127, 0x358637bd, v127
    v_pk_add_f32 v[124:125], v[124:125], v[208:209]
    v_pk_add_f32 v[126:127], v[126:127], v[210:211]
    v_cvt_pk_bf16_f32 v166, v124, v125
    v_cvt_pk_bf16_f32 v167, v126, v127
    s_waitcnt vmcnt(0) lgkmcnt(0)
    v_cmp_ne_u32_e64 vcc, s16, v14
    s_cbranch_vccz pkv_ok
    s_mov_b32 s98, 0
pkv_spin:
    s_add_u32 s98, s98, 1
    s_cmp_gt_u32 s98, 0x80000
    s_cbranch_scc1 pkv_ok
    s_sleep 1
    buffer_load_dword v14, v245, s[36:39], s24 offen sc1
    s_waitcnt vmcnt(0)
    v_cmp_ne_u32 vcc, s16, v14
    s_cbranch_vccnz pkv_spin
pkv_ok:
    s_barrier
    buffer_load_dwordx4 v[168:171], v252, s[36:39], s58 offen offset:0 sc1
    buffer_load_dwordx4 v[172:175], v252, s[36:39], s58 offen offset:64 sc1
    buffer_load_dwordx4 v[176:179], v254, s[36:39], s58 offen offset:128 sc1
    buffer_load_dwordx4 v[180:183], v253, s[36:39], s58 offen offset:0 sc1
    buffer_load_dwordx4 v[184:187], v253, s[36:39], s58 offen offset:64 sc1
    s_mov_b32 exec_hi, 0x3ffff
    buffer_load_dwordx4 v[48:51], v37, s[36:39], s59 offen sc1
    buffer_load_dwordx4 v[52:55], v37, s[36:39], s59 offen offset:3200 sc1
    s_mov_b32 exec_hi, -1
    s_add_u32 s59, s59, 6400
    s_mov_b32 exec_hi, 0x3ffff
    buffer_load_dwordx4 v[56:59], v37, s[36:39], s59 offen sc1
    buffer_load_dwordx4 v[60:63], v37, s[36:39], s59 offen offset:3200 sc1
    s_mov_b32 exec_hi, -1
    s_add_u32 s59, s59, 6400
    s_waitcnt vmcnt(4)
    s_mov_b32 exec_hi, 0x3ffff
    buffer_load_dwordx4 v[64:67], v37, s[36:39], s59 offen sc1
    buffer_load_dwordx4 v[68:71], v37, s[36:39], s59 offen offset:3200 sc1
    s_mov_b32 exec_hi, -1
    s_add_u32 s59, s59, 6400
    v_add_f32_dpp v168, v168, v168 row_ror:8 row_mask:0xf bank_mask:0xf
    v_add_f32_dpp v169, v169, v169 row_ror:8 row_mask:0xf bank_mask:0xf
    v_add_f32_dpp v170, v170, v170 row_ror:8 row_mask:0xf bank_mask:0xf
    v_add_f32_dpp v171, v171, v171 row_ror:8 row_mask:0xf bank_mask:0xf
    v_add_f32_dpp v172, v172, v172 row_ror:8 row_mask:0xf bank_mask:0xf
    v_add_f32_dpp v173, v173, v173 row_ror:8 row_mask:0xf bank_mask:0xf
    v_add_f32_dpp v174, v174, v174 row_ror:8 row_mask:0xf bank_mask:0xf
    v_add_f32_dpp v175, v175, v175 row_ror:8 row_mask:0xf bank_mask:0xf
    v_add_f32_dpp v176, v176, v176 row_ror:8 row_mask:0xf bank_mask:0xf
    v_add_f32_dpp v177, v177, v177 row_ror:8 row_mask:0xf bank_mask:0xf
    v_add_f32_dpp v178, v178, v178 row_ror:8 row_mask:0xf bank_mask:0xf
    v_add_f32_dpp v179, v179, v179 row_ror:8 row_mask:0xf bank_mask:0xf
    v_add_f32_dpp v180, v180, v180 row_ror:8 row_mask:0xf bank_mask:0xf
    v_add_f32_dpp v181, v181, v181 row_ror:8 row_mask:0xf bank_mask:0xf
    v_add_f32_dpp v182, v182, v182 row_ror:8 row_mask:0xf bank_mask:0xf
    v_add_f32_dpp v183, v183, v183 row_ror:8 row_mask:0xf bank_mask:0xf
    v_add_f32_dpp v184, v184, v184 row_ror:8 row_mask:0xf bank_mask:0xf
    v_add_f32_dpp v185, v185, v185 row_ror:8 row_mask:0xf bank_mask:0xf
    v_add_f32_dpp v186, v186, v186 row_ror:8 row_mask:0xf bank_mask:0xf
    v_add_f32_dpp v187, v187, v187 row_ror:8 row_mask:0xf bank_mask:0xf
    s_mov_b32 exec_hi, 0x3ffff
    buffer_load_dwordx4 v[72:75], v37, s[36:39], s59 offen sc1
    buffer_load_dwordx4 v[76:79], v37, s[36:39], s59 offen offset:3200 sc1
    s_mov_b32 exec_hi, -1
    s_nop 0
    s_add_u32 s59, s59, 6400
    v_add_f32_dpp v168, v168, v168 row_ror:4 row_mask:0xf bank_mask:0xf
    v_add_f32_dpp v169, v169, v169 row_ror:4 row_mask:0xf bank_mask:0xf
    v_add_f32_dpp v170, v170, v170 row_ror:4 row_mask:0xf bank_mask:0xf
    v_add_f32_dpp v171, v171, v171 row_ror:4 row_mask:0xf bank_mask:0xf
    v_add_f32_dpp v172, v172, v172 row_ror:4 row_mask:0xf bank_mask:0xf
    v_add_f32_dpp v173, v173, v173 row_ror:4 row_mask:0xf bank_mask:0xf
    v_add_f32_dpp v174, v174, v174 row_ror:4 row_mask:0xf bank_mask:0xf
    v_add_f32_dpp v175, v175, v175 row_ror:4 row_mask:0xf bank_mask:0xf
    v_add_f32_dpp v176, v176, v176 row_ror:4 row_mask:0xf bank_mask:0xf
    v_add_f32_dpp v177, v177, v177 row_ror:4 row_mask:0xf bank_mask:0xf
    v_add_f32_dpp v178, v178, v178 row_ror:4 row_mask:0xf bank_mask:0xf
    v_add_f32_dpp v179, v179, v179 row_ror:4 row_mask:0xf bank_mask:0xf
    v_add_f32_dpp v180, v180, v180 row_ror:4 row_mask:0xf bank_mask:0xf
    v_add_f32_dpp v181, v181, v181 row_ror:4 row_mask:0xf bank_mask:0xf
    v_add_f32_dpp v182, v182, v182 row_ror:4 row_mask:0xf bank_mask:0xf
    v_add_f32_dpp v183, v183, v183 row_ror:4 row_mask:0xf bank_mask:0xf
    v_add_f32_dpp v184, v184, v184 row_ror:4 row_mask:0xf bank_mask:0xf
    v_add_f32_dpp v185, v185, v185 row_ror:4 row_mask:0xf bank_mask:0xf
    v_add_f32_dpp v186, v186, v186 row_ror:4 row_mask:0xf bank_mask:0xf
    v_add_f32_dpp v187, v187, v187 row_ror:4 row_mask:0xf bank_mask:0xf
    s_mov_b32 exec_hi, 0x3ffff
    buffer_load_dwordx4 v[80:83], v37, s[36:39], s59 offen sc1
    buffer_load_dwordx4 v[84:87], v37, s[36:39], s59 offen offset:3200 sc1
    s_mov_b32 exec_hi, -1
    s_nop 0
    s_add_u32 s59, s59, 6400
    v_add_f32_dpp v168, v168, v168 row_ror:2 row_mask:0xf bank_mask:0xf
    v_add_f32_dpp v169, v169, v169 row_ror:2 row_mask:0xf bank_mask:0xf
    v_add_f32_dpp v170, v170, v170 row_ror:2 row_mask:0xf bank_mask:0xf
    v_add_f32_dpp v171, v171, v171 row_ror:2 row_mask:0xf bank_mask:0xf
    v_add_f32_dpp v172, v172, v172 row_ror:2 row_mask:0xf bank_mask:0xf
    v_add_f32_dpp v173, v173, v173 row_ror:2 row_mask:0xf bank_mask:0xf
    v_add_f32_dpp v174, v174, v174 row_ror:2 row_mask:0xf bank_mask:0xf
    v_add_f32_dpp v175, v175, v175 row_ror:2 row_mask:0xf bank_mask:0xf
    v_add_f32_dpp v176, v176, v176 row_ror:2 row_mask:0xf bank_mask:0xf
    v_add_f32_dpp v177, v177, v177 row_ror:2 row_mask:0xf bank_mask:0xf
    v_add_f32_dpp v178, v178, v178 row_ror:2 row_mask:0xf bank_mask:0xf
    v_add_f32_dpp v179, v179, v179 row_ror:2 row_mask:0xf bank_mask:0xf
    v_add_f32_dpp v180, v180, v180 row_ror:2 row_mask:0xf bank_mask:0xf
    v_add_f32_dpp v181, v181, v181 row_ror:2 row_mask:0xf bank_mask:0xf
    v_add_f32_dpp v182, v182, v182 row_ror:2 row_mask:0xf bank_mask:0xf
    v_add_f32_dpp v183, v183, v183 row_ror:2 row_mask:0xf bank_mask:0xf
    v_add_f32_dpp v184, v184, v184 row_ror:2 row_mask:0xf bank_mask:0xf
    v_add_f32_dpp v185, v185, v185 row_ror:2 row_mask:0xf bank_mask:0xf
    v_add_f32_dpp v186, v186, v186 row_ror:2 row_mask:0xf bank_mask:0xf
    v_add_f32_dpp v187, v187, v187 row_ror:2 row_mask:0xf bank_mask:0xf
    s_mov_b32 exec_hi, 0x3ffff
    buffer_load_dwordx4 v[88:91], v37, s[36:39], s59 offen sc1
    buffer_load_dwordx4 v[92:95], v37, s[36:39], s59 offen offset:3200 sc1
    s_mov_b32 exec_hi, -1
    s_nop 0
    s_add_u32 s59, s59, 6400
    v_add_f32_dpp v168, v168, v168 row_ror:1 row_mask:0xf bank_mask:0xf
    v_add_f32_dpp v169, v169, v169 row_ror:1 row_mask:0xf bank_mask:0xf
    v_add_f32_dpp v170, v170, v170 row_ror:1 row_mask:0xf bank_mask:0xf
    v_add_f32_dpp v171, v171, v171 row_ror:1 row_mask:0xf bank_mask:0xf
    v_add_f32_dpp v172, v172, v172 row_ror:1 row_mask:0xf bank_mask:0xf
    v_add_f32_dpp v173, v173, v173 row_ror:1 row_mask:0xf bank_mask:0xf
    v_add_f32_dpp v174, v174, v174 row_ror:1 row_mask:0xf bank_mask:0xf
    v_add_f32_dpp v175, v175, v175 row_ror:1 row_mask:0xf bank_mask:0xf
    v_add_f32_dpp v176, v176, v176 row_ror:1 row_mask:0xf bank_mask:0xf
    v_add_f32_dpp v177, v177, v177 row_ror:1 row_mask:0xf bank_mask:0xf
    v_add_f32_dpp v178, v178, v178 row_ror:1 row_mask:0xf bank_mask:0xf
    v_add_f32_dpp v179, v179, v179 row_ror:1 row_mask:0xf bank_mask:0xf
    v_add_f32_dpp v180, v180, v180 row_ror:1 row_mask:0xf bank_mask:0xf
    v_add_f32_dpp v181, v181, v181 row_ror:1 row_mask:0xf bank_mask:0xf
    v_add_f32_dpp v182, v182, v182 row_ror:1 row_mask:0xf bank_mask:0xf
    v_add_f32_dpp v183, v183, v183 row_ror:1 row_mask:0xf bank_mask:0xf
    v_add_f32_dpp v184, v184, v184 row_ror:1 row_mask:0xf bank_mask:0xf
    v_add_f32_dpp v185, v185, v185 row_ror:1 row_mask:0xf bank_mask:0xf
    v_add_f32_dpp v186, v186, v186 row_ror:1 row_mask:0xf bank_mask:0xf
    v_add_f32_dpp v187, v187, v187 row_ror:1 row_mask:0xf bank_mask:0xf
    v_cvt_pk_bf16_f32 v16, v168, v169
    v_cvt_pk_bf16_f32 v17, v170, v171
    v_cvt_pk_bf16_f32 v18, v172, v173
    v_cvt_pk_bf16_f32 v19, v174, v175
    v_cvt_pk_bf16_f32 v20, v176, v177
    v_cvt_pk_bf16_f32 v21, v178, v179
    v_cvt_pk_bf16_f32 v22, v180, v181
    v_cvt_pk_bf16_f32 v23, v182, v183
    v_cvt_pk_bf16_f32 v24, v184, v185
    v_cvt_pk_bf16_f32 v25, v186, v187
    s_mov_b32 exec_hi, 0x3ffff
    buffer_load_dwordx4 v[96:99], v37, s[36:39], s59 offen sc1
    buffer_load_dwordx4 v[100:103], v37, s[36:39], s59 offen offset:3200 sc1
    s_mov_b32 exec_hi, -1
    s_add_u32 s59, s59, 6400
    s_mov_b32 exec_hi, 0x3ffff
    buffer_load_dwordx4 v[104:107], v37, s[36:39], s59 offen sc1
    buffer_load_dwordx4 v[108:111], v37, s[36:39], s59 offen offset:3200 sc1
    s_mov_b32 exec_hi, -1
    s_add_u32 s59, s59, 6400
    v_and_b32 v168, v194, v16
    v_and_b32 v169, v194, v17
    v_and_b32 v170, v195, v18
    v_and_b32 v171, v195, v19
    v_and_b32 v172, v196, v16
    v_and_b32 v173, v196, v17
    v_and_b32 v174, v197, v18
    v_and_b32 v175, v197, v19
    v_and_b32 v176, v198, v20
    v_and_b32 v177, v198, v21
    v_and_b32 v178, v199, v18
    v_and_b32 v179, v199, v19
    v_and_b32 v180, v200, v20
    v_and_b32 v181, v200, v21
    v_and_b32 v182, v201, v24
    v_and_b32 v183, v201, v25
    v_and_b32 v184, v202, v22
    v_and_b32 v185, v202, v23
    v_and_b32 v186, v203, v24
    v_and_b32 v187, v203, v25
    v_and_b32 v188, v204, v20
    v_and_b32 v189, v204, v21
    v_and_b32 v190, v205, v22
    v_and_b32 v191, v205, v23
    v_and_b32 v192, v206, v24
    v_and_b32_e64 v193, v206, v25
    s_nop 0
    v_mfma_f32_16x16x16_bf16 v[204:207], v[168:169], v[128:129], 0
    v_mfma_f32_16x16x16_bf16 v[204:207], v[170:171], v[130:131], v[204:207]
    v_mfma_f32_16x16x16_bf16 v[208:211], v[172:173], v[128:129], 0
    v_mfma_f32_16x16x16_bf16 v[208:211], v[174:175], v[130:131], v[208:211]
    v_mfma_f32_16x16x16_bf16 v[208:211], v[176:177], v[132:133], v[208:211]
    v_mfma_f32_16x16x16_bf16 v[212:215], v[178:179], v[130:131], 0
    v_mfma_f32_16x16x16_bf16 v[212:215], v[180:181], v[132:133], v[212:215]
    v_mfma_f32_16x16x16_bf16 v[212:215], v[182:183], v[136:137], v[212:215]
    v_mfma_f32_16x16x16_bf16 v[216:219], v[184:185], v[134:135], 0
    v_mfma_f32_16x16x16_bf16 v[216:219], v[186:187], v[136:137], v[216:219]
    v_mfma_f32_16x16x16_bf16 v[220:223], v[188:189], v[132:133], 0
    v_mfma_f32_16x16x16_bf16 v[220:223], v[190:191], v[134:135], v[220:223]
    v_mfma_f32_16x16x16_bf16 v[220:223], v[192:193], v[136:137], v[220:223]
    v_mfma_f32_16x16x16_bf16 v[224:227], v[168:169], v[138:139], 0
    v_mfma_f32_16x16x16_bf16 v[224:227], v[170:171], v[140:141], v[224:227]
    v_mfma_f32_16x16x16_bf16 v[228:231], v[172:173], v[138:139], 0
    v_mfma_f32_16x16x16_bf16 v[228:231], v[174:175], v[140:141], v[228:231]
    v_mfma_f32_16x16x16_bf16 v[228:231], v[176:177], v[142:143], v[228:231]
    v_mfma_f32_16x16x16_bf16 v[232:235], v[178:179], v[140:141], 0
    v_mfma_f32_16x16x16_bf16 v[232:235], v[180:181], v[142:143], v[232:235]
    v_mfma_f32_16x16x16_bf16 v[232:235], v[182:183], v[146:147], v[232:235]
    v_mfma_f32_16x16x16_bf16 v[236:239], v[184:185], v[144:145], 0
    v_mfma_f32_16x16x16_bf16 v[236:239], v[186:187], v[146:147], v[236:239]
    v_mfma_f32_16x16x16_bf16 v[240:243], v[188:189], v[142:143], 0
    v_mfma_f32_16x16x16_bf16 v[240:243], v[190:191], v[144:145], v[240:243]
    v_mfma_f32_16x16x16_bf16 v[240:243], v[192:193], v[146:147], v[240:243]
    v_add_f32 v112, 0x358637bd, v204
    v_add_f32 v114, 0x358637bd, v208
    v_add_f32 v116, 0x358637bd, v212
    v_add_f32 v118, 0x358637bd, v216
    v_add_f32 v120, 0x358637bd, v220
    v_rcp_f32 v112, v112
    v_rcp_f32 v114, v114
    v_rcp_f32 v116, v116
    v_rcp_f32 v118, v118
    v_rcp_f32 v120, v120
    s_nop 0
    v_mul_f32 v112, v112, v8
    v_mul_f32 v114, v114, v8
    v_mul_f32 v116, v116, v8
    v_mul_f32 v118, v118, v8
    v_mul_f32 v120, v120, v8
    v_lshlrev_b32 v122, 16, v128
    v_and_b32 v123, 0xffff0000, v128
    v_lshlrev_b32_e64 v124, 16, v129
    v_and_b32 v125, 0xffff0000, v129
    v_pk_mul_f32 v[122:123], v[122:123], v[112:113] op_sel_hi:[1,0]
    v_pk_mul_f32 v[124:125], v[124:125], v[112:113] op_sel_hi:[1,0]
    v_cvt_pk_bf16_f32 v128, v122, v123
    v_cvt_pk_bf16_f32 v129, v124, v125
    v_lshlrev_b32_e64 v122, 16, v130
    v_and_b32 v123, 0xffff0000, v130
    v_lshlrev_b32_e64 v124, 16, v131
    v_and_b32 v125, 0xffff0000, v131
    v_pk_mul_f32 v[122:123], v[122:123], v[114:115] op_sel_hi:[1,0]
    v_pk_mul_f32 v[124:125], v[124:125], v[114:115] op_sel_hi:[1,0]
    v_cvt_pk_bf16_f32 v130, v122, v123
    v_cvt_pk_bf16_f32 v131, v124, v125
    v_lshlrev_b32_e64 v122, 16, v132
    v_and_b32 v123, 0xffff0000, v132
    v_lshlrev_b32_e64 v124, 16, v133
    v_and_b32 v125, 0xffff0000, v133
    v_pk_mul_f32 v[122:123], v[122:123], v[116:117] op_sel_hi:[1,0]
    v_pk_mul_f32 v[124:125], v[124:125], v[116:117] op_sel_hi:[1,0]
    v_cvt_pk_bf16_f32 v132, v122, v123
    v_cvt_pk_bf16_f32 v133, v124, v125
    v_lshlrev_b32_e64 v122, 16, v134
    v_and_b32 v123, 0xffff0000, v134
    v_lshlrev_b32_e64 v124, 16, v135
    v_and_b32 v125, 0xffff0000, v135
    v_pk_mul_f32 v[122:123], v[122:123], v[118:119] op_sel_hi:[1,0]
    v_pk_mul_f32 v[124:125], v[124:125], v[118:119] op_sel_hi:[1,0]
    v_cvt_pk_bf16_f32 v134, v122, v123
    v_cvt_pk_bf16_f32 v135, v124, v125
    v_lshlrev_b32_e64 v122, 16, v136
    v_and_b32 v123, 0xffff0000, v136
    v_lshlrev_b32_e64 v124, 16, v137
    v_and_b32 v125, 0xffff0000, v137
    v_pk_mul_f32 v[122:123], v[122:123], v[120:121] op_sel_hi:[1,0]
    v_pk_mul_f32 v[124:125], v[124:125], v[120:121] op_sel_hi:[1,0]
    v_cvt_pk_bf16_f32 v136, v122, v123
    v_cvt_pk_bf16_f32 v137, v124, v125
    buffer_store_dwordx4 v[128:131], v37, s[36:39], s64 offen offset:0 sc1
    buffer_store_dwordx4 v[134:137], v37, s[36:39], s65 offen offset:0 sc1
    buffer_store_dwordx2 v[132:133], v37, s[36:39], s66 offen offset:0 sc1
    v_mfma_f32_16x16x16_bf16 v[204:207], v[168:169], v[148:149], 0
    v_mfma_f32_16x16x16_bf16 v[204:207], v[170:171], v[150:151], v[204:207]
    v_mfma_f32_16x16x16_bf16 v[208:211], v[172:173], v[148:149], 0
    v_mfma_f32_16x16x16_bf16 v[208:211], v[174:175], v[150:151], v[208:211]
    v_mfma_f32_16x16x16_bf16 v[208:211], v[176:177], v[152:153], v[208:211]
    v_mfma_f32_16x16x16_bf16 v[212:215], v[178:179], v[150:151], 0
    v_mfma_f32_16x16x16_bf16 v[212:215], v[180:181], v[152:153], v[212:215]
    v_mfma_f32_16x16x16_bf16 v[212:215], v[182:183], v[156:157], v[212:215]
    v_mfma_f32_16x16x16_bf16 v[216:219], v[184:185], v[154:155], 0
    v_mfma_f32_16x16x16_bf16 v[216:219], v[186:187], v[156:157], v[216:219]
    v_mfma_f32_16x16x16_bf16 v[220:223], v[188:189], v[152:153], 0
    v_mfma_f32_16x16x16_bf16 v[220:223], v[190:191], v[154:155], v[220:223]
    v_mfma_f32_16x16x16_bf16 v[220:223], v[192:193], v[156:157], v[220:223]
    v_add_f32 v112, 0x358637bd, v224
    v_add_f32 v114, 0x358637bd, v228
    v_add_f32 v116, 0x358637bd, v232
    v_add_f32 v118, 0x358637bd, v236
    v_add_f32 v120, 0x358637bd, v240
    v_rcp_f32 v112, v112
    v_rcp_f32 v114, v114
    v_rcp_f32 v116, v116
    v_rcp_f32 v118, v118
    v_rcp_f32 v120, v120
    s_nop 0
    v_mul_f32 v112, v112, v9
    v_mul_f32 v114, v114, v9
    v_mul_f32 v116, v116, v9
    v_mul_f32 v118, v118, v9
    v_mul_f32 v120, v120, v9
    v_lshlrev_b32 v122, 16, v138
    v_and_b32 v123, 0xffff0000, v138
    v_lshlrev_b32_e64 v124, 16, v139
    v_and_b32 v125, 0xffff0000, v139
    v_pk_mul_f32 v[122:123], v[122:123], v[112:113] op_sel_hi:[1,0]
    v_pk_mul_f32 v[124:125], v[124:125], v[112:113] op_sel_hi:[1,0]
    v_cvt_pk_bf16_f32 v138, v122, v123
    v_cvt_pk_bf16_f32 v139, v124, v125
    v_lshlrev_b32_e64 v122, 16, v140
    v_and_b32 v123, 0xffff0000, v140
    v_lshlrev_b32_e64 v124, 16, v141
    v_and_b32 v125, 0xffff0000, v141
    v_pk_mul_f32 v[122:123], v[122:123], v[114:115] op_sel_hi:[1,0]
    v_pk_mul_f32 v[124:125], v[124:125], v[114:115] op_sel_hi:[1,0]
    v_cvt_pk_bf16_f32 v140, v122, v123
    v_cvt_pk_bf16_f32 v141, v124, v125
    v_lshlrev_b32_e64 v122, 16, v142
    v_and_b32 v123, 0xffff0000, v142
    v_lshlrev_b32_e64 v124, 16, v143
    v_and_b32 v125, 0xffff0000, v143
    v_pk_mul_f32 v[122:123], v[122:123], v[116:117] op_sel_hi:[1,0]
    v_pk_mul_f32 v[124:125], v[124:125], v[116:117] op_sel_hi:[1,0]
    v_cvt_pk_bf16_f32 v142, v122, v123
    v_cvt_pk_bf16_f32 v143, v124, v125
    v_lshlrev_b32_e64 v122, 16, v144
    v_and_b32 v123, 0xffff0000, v144
    v_lshlrev_b32_e64 v124, 16, v145
    v_and_b32 v125, 0xffff0000, v145
    v_pk_mul_f32 v[122:123], v[122:123], v[118:119] op_sel_hi:[1,0]
    v_pk_mul_f32 v[124:125], v[124:125], v[118:119] op_sel_hi:[1,0]
    v_cvt_pk_bf16_f32 v144, v122, v123
    v_cvt_pk_bf16_f32 v145, v124, v125
    v_lshlrev_b32_e64 v122, 16, v146
    v_and_b32 v123, 0xffff0000, v146
    v_lshlrev_b32_e64 v124, 16, v147
    v_and_b32 v125, 0xffff0000, v147
    v_pk_mul_f32 v[122:123], v[122:123], v[120:121] op_sel_hi:[1,0]
    v_pk_mul_f32 v[124:125], v[124:125], v[120:121] op_sel_hi:[1,0]
    v_cvt_pk_bf16_f32 v146, v122, v123
    v_cvt_pk_bf16_f32 v147, v124, v125
    buffer_store_dwordx4 v[138:141], v37, s[36:39], s64 offen offset:1024 sc1
    buffer_store_dwordx4 v[144:147], v37, s[36:39], s65 offen offset:1024 sc1
    buffer_store_dwordx2 v[142:143], v37, s[36:39], s66 offen offset:1024 sc1
    v_mfma_f32_16x16x16_bf16 v[224:227], v[168:169], v[158:159], 0
    v_mfma_f32_16x16x16_bf16 v[224:227], v[170:171], v[160:161], v[224:227]
    v_mfma_f32_16x16x16_bf16 v[228:231], v[172:173], v[158:159], 0
    v_mfma_f32_16x16x16_bf16 v[228:231], v[174:175], v[160:161], v[228:231]
    v_mfma_f32_16x16x16_bf16 v[228:231], v[176:177], v[162:163], v[228:231]
    v_mfma_f32_16x16x16_bf16 v[232:235], v[178:179], v[160:161], 0
    v_mfma_f32_16x16x16_bf16 v[232:235], v[180:181], v[162:163], v[232:235]
    v_mfma_f32_16x16x16_bf16 v[232:235], v[182:183], v[166:167], v[232:235]
    v_mfma_f32_16x16x16_bf16 v[236:239], v[184:185], v[164:165], 0
    v_mfma_f32_16x16x16_bf16 v[236:239], v[186:187], v[166:167], v[236:239]
    v_mfma_f32_16x16x16_bf16 v[240:243], v[188:189], v[162:163], 0
    v_mfma_f32_16x16x16_bf16 v[240:243], v[190:191], v[164:165], v[240:243]
    v_mfma_f32_16x16x16_bf16 v[240:243], v[192:193], v[166:167], v[240:243]
    v_add_f32 v112, 0x358637bd, v204
    v_add_f32 v114, 0x358637bd, v208
    v_add_f32 v116, 0x358637bd, v212
    v_add_f32 v118, 0x358637bd, v216
    v_add_f32 v120, 0x358637bd, v220
    v_rcp_f32 v112, v112
    v_rcp_f32 v114, v114
    v_rcp_f32 v116, v116
    v_rcp_f32 v118, v118
    v_rcp_f32 v120, v120
    s_nop 0
    v_mul_f32 v112, v112, v10
    v_mul_f32 v114, v114, v10
    v_mul_f32 v116, v116, v10
    v_mul_f32 v118, v118, v10
    v_mul_f32 v120, v120, v10
    v_lshlrev_b32 v122, 16, v148
    v_and_b32 v123, 0xffff0000, v148
    v_lshlrev_b32_e64 v124, 16, v149
    v_and_b32 v125, 0xffff0000, v149
    v_pk_mul_f32 v[122:123], v[122:123], v[112:113] op_sel_hi:[1,0]
    v_pk_mul_f32 v[124:125], v[124:125], v[112:113] op_sel_hi:[1,0]
    v_cvt_pk_bf16_f32 v148, v122, v123
    v_cvt_pk_bf16_f32 v149, v124, v125
    v_lshlrev_b32_e64 v122, 16, v150
    v_and_b32 v123, 0xffff0000, v150
    v_lshlrev_b32_e64 v124, 16, v151
    v_and_b32 v125, 0xffff0000, v151
    v_pk_mul_f32 v[122:123], v[122:123], v[114:115] op_sel_hi:[1,0]
    v_pk_mul_f32 v[124:125], v[124:125], v[114:115] op_sel_hi:[1,0]
    v_cvt_pk_bf16_f32 v150, v122, v123
    v_cvt_pk_bf16_f32 v151, v124, v125
    v_lshlrev_b32_e64 v122, 16, v152
    v_and_b32 v123, 0xffff0000, v152
    v_lshlrev_b32_e64 v124, 16, v153
    v_and_b32 v125, 0xffff0000, v153
    v_pk_mul_f32 v[122:123], v[122:123], v[116:117] op_sel_hi:[1,0]
    v_pk_mul_f32 v[124:125], v[124:125], v[116:117] op_sel_hi:[1,0]
    v_cvt_pk_bf16_f32 v152, v122, v123
    v_cvt_pk_bf16_f32 v153, v124, v125
    v_lshlrev_b32_e64 v122, 16, v154
    v_and_b32 v123, 0xffff0000, v154
    v_lshlrev_b32_e64 v124, 16, v155
    v_and_b32 v125, 0xffff0000, v155
    v_pk_mul_f32 v[122:123], v[122:123], v[118:119] op_sel_hi:[1,0]
    v_pk_mul_f32 v[124:125], v[124:125], v[118:119] op_sel_hi:[1,0]
    v_cvt_pk_bf16_f32 v154, v122, v123
    v_cvt_pk_bf16_f32 v155, v124, v125
    v_lshlrev_b32_e64 v122, 16, v156
    v_and_b32 v123, 0xffff0000, v156
    v_lshlrev_b32_e64 v124, 16, v157
    v_and_b32 v125, 0xffff0000, v157
    v_pk_mul_f32 v[122:123], v[122:123], v[120:121] op_sel_hi:[1,0]
    v_pk_mul_f32 v[124:125], v[124:125], v[120:121] op_sel_hi:[1,0]
    v_cvt_pk_bf16_f32 v156, v122, v123
    v_cvt_pk_bf16_f32 v157, v124, v125
    buffer_store_dwordx4 v[148:151], v37, s[36:39], s64 offen offset:2048 sc1
    buffer_store_dwordx4 v[154:157], v37, s[36:39], s65 offen offset:2048 sc1
    buffer_store_dwordx2 v[152:153], v37, s[36:39], s66 offen offset:2048 sc1
    s_nop 7
    s_nop 0
    v_add_f32 v112, 0x358637bd, v224
    v_add_f32 v114, 0x358637bd, v228
    v_add_f32 v116, 0x358637bd, v232
    v_add_f32 v118, 0x358637bd, v236
    v_add_f32 v120, 0x358637bd, v240
    v_rcp_f32 v112, v112
    v_rcp_f32 v114, v114
    v_rcp_f32 v116, v116
    v_rcp_f32 v118, v118
    v_rcp_f32 v120, v120
    s_nop 0
    v_mul_f32 v112, v112, v11
    v_mul_f32 v114, v114, v11
    v_mul_f32 v116, v116, v11
    v_mul_f32 v118, v118, v11
    v_mul_f32 v120, v120, v11
    v_lshlrev_b32 v122, 16, v158
    v_and_b32 v123, 0xffff0000, v158
    v_lshlrev_b32_e64 v124, 16, v159
    v_and_b32 v125, 0xffff0000, v159
    v_pk_mul_f32 v[122:123], v[122:123], v[112:113] op_sel_hi:[1,0]
    v_pk_mul_f32 v[124:125], v[124:125], v[112:113] op_sel_hi:[1,0]
    v_cvt_pk_bf16_f32 v158, v122, v123
    v_cvt_pk_bf16_f32 v159, v124, v125
    v_lshlrev_b32_e64 v122, 16, v160
    v_and_b32 v123, 0xffff0000, v160
    v_lshlrev_b32_e64 v124, 16, v161
    v_and_b32 v125, 0xffff0000, v161
    v_pk_mul_f32 v[122:123], v[122:123], v[114:115] op_sel_hi:[1,0]
    v_pk_mul_f32 v[124:125], v[124:125], v[114:115] op_sel_hi:[1,0]
    v_cvt_pk_bf16_f32 v160, v122, v123
    v_cvt_pk_bf16_f32 v161, v124, v125
    v_lshlrev_b32_e64 v122, 16, v162
    v_and_b32 v123, 0xffff0000, v162
    v_lshlrev_b32_e64 v124, 16, v163
    v_and_b32 v125, 0xffff0000, v163
    v_pk_mul_f32 v[122:123], v[122:123], v[116:117] op_sel_hi:[1,0]
    v_pk_mul_f32 v[124:125], v[124:125], v[116:117] op_sel_hi:[1,0]
    v_cvt_pk_bf16_f32 v162, v122, v123
    v_cvt_pk_bf16_f32 v163, v124, v125
    v_lshlrev_b32_e64 v122, 16, v164
    v_and_b32 v123, 0xffff0000, v164
    v_lshlrev_b32_e64 v124, 16, v165
    v_and_b32 v125, 0xffff0000, v165
    v_pk_mul_f32 v[122:123], v[122:123], v[118:119] op_sel_hi:[1,0]
    v_pk_mul_f32 v[124:125], v[124:125], v[118:119] op_sel_hi:[1,0]
    v_cvt_pk_bf16_f32 v164, v122, v123
    v_cvt_pk_bf16_f32 v165, v124, v125
    v_lshlrev_b32_e64 v122, 16, v166
    v_and_b32 v123, 0xffff0000, v166
    v_lshlrev_b32_e64 v124, 16, v167
    v_and_b32 v125, 0xffff0000, v167
    v_pk_mul_f32 v[122:123], v[122:123], v[120:121] op_sel_hi:[1,0]
    v_pk_mul_f32 v[124:125], v[124:125], v[120:121] op_sel_hi:[1,0]
    v_cvt_pk_bf16_f32 v166, v122, v123
    v_cvt_pk_bf16_f32 v167, v124, v125
    buffer_store_dwordx4 v[158:161], v37, s[36:39], s64 offen offset:3072 sc1
    buffer_store_dwordx4 v[164:167], v37, s[36:39], s65 offen offset:3072 sc1
    buffer_store_dwordx2 v[162:163], v37, s[36:39], s66 offen offset:3072 sc1
    s_waitcnt vmcnt(12)
    s_nop 0
    v_pk_add_f32 v[48:49], v[48:49], v[80:81]
    v_pk_add_f32 v[50:51], v[50:51], v[82:83]
    v_pk_add_f32 v[52:53], v[52:53], v[84:85]
    v_pk_add_f32 v[54:55], v[54:55], v[86:87]
    v_pk_add_f32 v[56:57], v[56:57], v[88:89]
    v_pk_add_f32 v[58:59], v[58:59], v[90:91]
    v_pk_add_f32 v[60:61], v[60:61], v[92:93]
    v_pk_add_f32 v[62:63], v[62:63], v[94:95]
    v_pk_add_f32 v[64:65], v[64:65], v[96:97]
    v_pk_add_f32 v[66:67], v[66:67], v[98:99]
    v_pk_add_f32 v[68:69], v[68:69], v[100:101]
    v_pk_add_f32 v[70:71], v[70:71], v[102:103]
    v_pk_add_f32 v[72:73], v[72:73], v[104:105]
    v_pk_add_f32 v[74:75], v[74:75], v[106:107]
    v_pk_add_f32 v[76:77], v[76:77], v[108:109]
    v_pk_add_f32 v[78:79], v[78:79], v[110:111]
    v_pk_add_f32 v[48:49], v[48:49], v[64:65]
    v_pk_add_f32 v[50:51], v[50:51], v[66:67]
    v_pk_add_f32 v[52:53], v[52:53], v[68:69]
    v_pk_add_f32 v[54:55], v[54:55], v[70:71]
    v_pk_add_f32 v[56:57], v[56:57], v[72:73]
    v_pk_add_f32 v[58:59], v[58:59], v[74:75]
    v_pk_add_f32 v[60:61], v[60:61], v[76:77]
    v_pk_add_f32 v[62:63], v[62:63], v[78:79]
    v_pk_add_f32 v[48:49], v[48:49], v[56:57]
    v_pk_add_f32 v[50:51], v[50:51], v[58:59]
    v_pk_add_f32 v[52:53], v[52:53], v[60:61]
    v_pk_add_f32 v[54:55], v[54:55], v[62:63]
    v_pk_add_f32 v[48:49], v[48:49], v[52:53]
    v_pk_add_f32 v[50:51], v[50:51], v[54:55]
    s_mul_i32 s86, s68, 400
    s_add_u32 s86, s86, 65536
    v_lshlrev_b32 v7, 3, v1
    v_add_u32 v7, s86, v7
    v_cvt_pk_bf16_f32 v48, v48, v49
    v_cvt_pk_bf16_f32 v49, v50, v51
    s_mov_b32 exec_hi, 0x3ffff
    ds_write_b64 v7, v[48:49]
    s_mov_b32 exec_hi, -1
    s_waitcnt lgkmcnt(0)
    s_barrier
    s_nop 0
    ds_read_b64 a[20:21], v26
    ds_read_b64 a[22:23], v27
    ds_read_b64 a[24:25], v28
    ds_read_b64 a[26:27], v29
    ds_read_b64 a[28:29], v30
    ds_read_b64 a[30:31], v31
    ds_read_b64 a[32:33], v32
    s_waitcnt lgkmcnt(0)
    s_nop 0
    v_mfma_f32_16x16x16_bf16 v[64:67], a[20:21], a[0:1], 0
    v_mfma_f32_16x16x16_bf16 v[64:67], a[22:23], a[2:3], v[64:67]
    v_mfma_f32_16x16x16_bf16 v[68:71], a[24:25], a[0:1], 0
    v_mfma_f32_16x16x16_bf16 v[68:71], a[26:27], a[2:3], v[68:71]
    v_mfma_f32_16x16x16_bf16 v[68:71], a[28:29], a[4:5], v[68:71]
    v_mfma_f32_16x16x16_bf16 v[72:75], a[30:31], a[2:3], 0
    v_mfma_f32_16x16x16_bf16 v[72:75], a[32:33], a[4:5], v[72:75]
    v_mfma_f32_16x16x16_bf16 v[76:79], a[20:21], a[6:7], 0
    v_mfma_f32_16x16x16_bf16 v[76:79], a[22:23], a[8:9], v[76:79]
    v_mfma_f32_16x16x16_bf16 v[80:83], a[24:25], a[6:7], 0
    v_mfma_f32_16x16x16_bf16 v[80:83], a[26:27], a[8:9], v[80:83]
    v_mfma_f32_16x16x16_bf16 v[80:83], a[28:29], a[10:11], v[80:83]
    v_mfma_f32_16x16x16_bf16 v[84:87], a[30:31], a[8:9], 0
    v_mfma_f32_16x16x16_bf16 v[84:87], a[32:33], a[10:11], v[84:87]
    v_mfma_f32_16x16x16_bf16 v[88:91], a[20:21], a[12:13], 0
    v_mfma_f32_16x16x16_bf16 v[88:91], a[22:23], a[14:15], v[88:91]
    v_mfma_f32_16x16x16_bf16 v[92:95], a[24:25], a[12:13], 0
    v_mfma_f32_16x16x16_bf16 v[92:95], a[26:27], a[14:15], v[92:95]
    v_mfma_f32_16x16x16_bf16 v[92:95], a[28:29], a[16:17], v[92:95]
    v_mfma_f32_16x16x16_bf16 v[96:99], a[30:31], a[14:15], 0
    v_mfma_f32_16x16x16_bf16 v[96:99], a[32:33], a[16:17], v[96:99]
    v_cvt_pk_bf16_f32 v64, v64, v65
    v_cvt_pk_bf16_f32 v65, v66, v67
    v_cvt_pk_bf16_f32 v66, v68, v69
    v_cvt_pk_bf16_f32 v67, v70, v71
    v_cvt_pk_bf16_f32 v68, v72, v73
    v_cvt_pk_bf16_f32 v69, v74, v75
    buffer_store_dwordx4 v[64:67], v37, s[36:39], s56 offen sc1
    s_mov_b32 exec_hi, 0
    buffer_store_dwordx2 v[68:69], v37, s[36:39], s57 offen sc1
    s_mov_b32 exec_hi, -1
    s_add_u32 s56, s56, 4096
    s_add_u32 s57, s57, 4096
    v_cvt_pk_bf16_f32 v76, v76, v77
    v_cvt_pk_bf16_f32 v77, v78, v79
    v_cvt_pk_bf16_f32 v78, v80, v81
    v_cvt_pk_bf16_f32 v79, v82, v83
    v_cvt_pk_bf16_f32 v80, v84, v85
    v_cvt_pk_bf16_f32 v81, v86, v87
    buffer_store_dwordx4 v[76:79], v37, s[36:39], s56 offen sc1
    s_mov_b32 exec_hi, 0
    buffer_store_dwordx2 v[80:81], v37, s[36:39], s57 offen sc1
    s_mov_b32 exec_hi, -1
    s_add_u32 s56, s56, 4096
    s_add_u32 s57, s57, 4096
    s_cmp_ge_u32 s68, 2
    s_cbranch_scc1 q_m_done
    s_nop 2
    s_nop 0
    v_cvt_pk_bf16_f32 v88, v88, v89
    v_cvt_pk_bf16_f32 v89, v90, v91
    v_cvt_pk_bf16_f32 v90, v92, v93
    v_cvt_pk_bf16_f32 v91, v94, v95
    v_cvt_pk_bf16_f32 v92, v96, v97
    v_cvt_pk_bf16_f32 v93, v98, v99
    buffer_store_dwordx4 v[88:91], v37, s[36:39], s56 offen sc1
    s_mov_b32 exec_hi, 0
    buffer_store_dwordx2 v[92:93], v37, s[36:39], s57 offen sc1
    s_mov_b32 exec_hi, -1
    s_add_u32 s56, s56, 4096
    s_add_u32 s57, s57, 4096
q_m_done:
    s_lshl_b32 s88, s81, 3
    s_add_u32 s88, s88, s82
    s_sub_u32 s88, s88, 16
    s_waitcnt vmcnt(0)
    s_barrier
    s_cmp_lg_u32 s68, 0
    s_cbranch_scc1 pub_q_np
    s_lshl_b32 s85, s88, 7
    s_add_u32 s85, s85, 0x97a080
    v_mov_b32 v2, s16
    v_lshlrev_b32_e64 v3, 2, v1
    s_mov_b32 exec_hi, 0
    buffer_store_dword v2, v3, s[36:39], s85 offen sc1
    s_mov_b32 exec_hi, -1
pub_q_np:
    v_and_b32 v5, 15, v1
    v_lshlrev_b32 v6, 2, v5
    s_lshl_b32 s23, s73, 8
    s_add_u32 s23, s23, 0x972000
    buffer_load_dword v8, v6, s[36:39], s23 offen offset:0 sc1
    buffer_load_dword v9, v6, s[36:39], s23 offen offset:64 sc1
    buffer_load_dword v10, v6, s[36:39], s23 offen offset:128 sc1
    buffer_load_dword v11, v6, s[36:39], s23 offen offset:192 sc1
    v_lshlrev_b32 v6, 1, v5
    s_lshl_b32 s23, s73, 7
    s_cmp_eq_u32 s68, 0
    s_cselect_b32 s23, s23, 0x40000000
    buffer_load_ushort v29, v6, s[60:63], s23 offen offset:0
    buffer_load_ushort v30, v6, s[60:63], s23 offen offset:32
    buffer_load_ushort v31, v6, s[60:63], s23 offen offset:64
    buffer_load_ushort v32, v6, s[60:63], s23 offen offset:96
    s_mov_b64 s[12:13], s[44:45]
    s_mov_b64 s[14:15], s[46:47]
    v_mov_b32 v33, v43
    v_mov_b32 v34, v44
    v_mov_b32 v35, v45
    v_mov_b32_e64 v36, v46
    s_mov_b32 s4, s17
    s_mov_b32 s7, s18
    s_mov_b32 s8, s19
    s_mov_b32 s11, 131072
    s_add_u32 m0, s6, 0
    s_nop 0
    buffer_load_dwordx4 v33, s[12:15], s4 offen offset:0 lds
    buffer_load_dwordx4 v34, s[12:15], s4 offen offset:1024 lds
    buffer_load_dwordx4 v35, s[12:15], s4 offen offset:2048 lds
    buffer_load_dwordx4 v36, s[12:15], s4 offen offset:3072 lds
    s_add_u32 s4, s4, s11
    s_cmp_eq_u32 s4, s8
    s_cselect_b32 s4, s7, s4
    s_add_u32 m0, s6, 4096
    s_nop 0
    buffer_load_dwordx4 v33, s[12:15], s4 offen offset:0 lds
    buffer_load_dwordx4 v34, s[12:15], s4 offen offset:1024 lds
    buffer_load_dwordx4 v35, s[12:15], s4 offen offset:2048 lds
    buffer_load_dwordx4 v36, s[12:15], s4 offen offset:3072 lds
    s_add_u32 s4, s4, s11
    s_cmp_eq_u32 s4, s8
    s_cselect_b32 s4, s7, s4
    s_add_u32 m0, s6, 8192
    s_nop 0
    buffer_load_dwordx4 v33, s[12:15], s4 offen offset:0 lds
    buffer_load_dwordx4 v34, s[12:15], s4 offen offset:1024 lds
    buffer_load_dwordx4 v35, s[12:15], s4 offen offset:2048 lds
    buffer_load_dwordx4 v36, s[12:15], s4 offen offset:3072 lds
    s_add_u32 s4, s4, s11
    s_cmp_eq_u32 s4, s8
    s_cselect_b32 s4, s7, s4
    s_add_u32 m0, s6, 12288
    s_nop 0
    buffer_load_dwordx4 v33, s[12:15], s4 offen offset:0 lds
    buffer_load_dwordx4 v34, s[12:15], s4 offen offset:1024 lds
    buffer_load_dwordx4 v35, s[12:15], s4 offen offset:2048 lds
    buffer_load_dwordx4 v36, s[12:15], s4 offen offset:3072 lds
    s_add_u32 s4, s4, s11
    s_cmp_eq_u32 s4, s8
    s_cselect_b32 s4, s7, s4
    s_mul_i32 s85, s68, 21504
    s_add_u32 s85, s85, 65536
    s_add_u32 m0, s85, 0
    s_nop 0
    buffer_load_dwordx4 v33, s[12:15], s4 offen offset:0 lds
    buffer_load_dwordx4 v34, s[12:15], s4 offen offset:1024 lds
    buffer_load_dwordx4 v35, s[12:15], s4 offen offset:2048 lds
    buffer_load_dwordx4 v36, s[12:15], s4 offen offset:3072 lds
    s_add_u32 s4, s4, s11
    s_cmp_eq_u32 s4, s8
    s_cselect_b32 s4, s7, s4
    s_add_u32 m0, s85, 4096
    s_nop 0
    buffer_load_dwordx4 v33, s[12:15], s4 offen offset:0 lds
    buffer_load_dwordx4 v34, s[12:15], s4 offen offset:1024 lds
    buffer_load_dwordx4 v35, s[12:15], s4 offen offset:2048 lds
    buffer_load_dwordx4 v36, s[12:15], s4 offen offset:3072 lds
    s_add_u32 s4, s4, s11
    s_cmp_eq_u32 s4, s8
    s_cselect_b32 s4, s7, s4
    s_add_u32 m0, s85, 8192
    s_nop 0
    buffer_load_dwordx4 v33, s[12:15], s4 offen offset:0 lds
    buffer_load_dwordx4 v34, s[12:15], s4 offen offset:1024 lds
    buffer_load_dwordx4 v35, s[12:15], s4 offen offset:2048 lds
    buffer_load_dwordx4 v36, s[12:15], s4 offen offset:3072 lds
    s_add_u32 s4, s4, s11
    s_cmp_eq_u32 s4, s8
    s_cselect_b32 s4, s7, s4
    buffer_load_dword v14, v13, s[36:39], s25 offen sc1
    s_waitcnt vmcnt(29)
    v_sub_f32 v8, 1.0, v8
    v_sub_f32 v9, 1.0, v9
    v_sub_f32 v10, 1.0, v10
    v_sub_f32 v11, 1.0, v11
    v_min_u32 v12, 23, v1
    v_lshlrev_b32_e64 v12, 7, v12
    s_mul_i32 s23, s74, 3072
    s_add_u32 s23, s23, 0x97c080
    v_and_b32 v5, 15, v1
    v_lshrrev_b32 v6, 4, v1
    v_mul_u32_u24 v4, 336, v5
    v_lshl_add_u32 v4, v6, 4, v4
    s_mul_i32 s85, s68, 21504
    s_add_u32 s85, s85, 65536
    v_add_u32_e64 v4, s85, v4
    s_mul_i32 s85, s68, 5376
    s_add_u32 s85, s85, 65536
    s_lshl_b32 s95, s73, 2
    s_add_u32 s95, s95, s68
    s_mul_i32 s95, s95, 20480
    s_mul_i32 s87, s74, 160
    s_add_u32 s95, s95, s87
    v_add_u32 v5, 0, v1
    v_mul_u32_u24 v6, 3277, v5
    v_lshrrev_b32 v6, 16, v6
    v_mul_u32_u24 v7, 20, v6
    v_sub_u32_e64 v7, v5, v7
    v_mul_u32_u24 v16, 336, v6
    v_lshl_add_u32 v16, v7, 4, v16
    v_add_u32_e64 v16, s85, v16
    v_mul_u32_u24 v24, 1280, v6
    v_lshl_add_u32 v24, v7, 3, v24
    v_add_u32_e64 v5, 64, v1
    v_mul_u32_u24 v6, 3277, v5
    v_lshrrev_b32 v6, 16, v6
    v_mul_u32_u24 v7, 20, v6
    v_sub_u32_e64 v7, v5, v7
    v_mul_u32_u24 v17, 336, v6
    v_lshl_add_u32 v17, v7, 4, v17
    v_add_u32_e64 v17, s85, v17
    v_mul_u32_u24 v25, 1280, v6
    v_lshl_add_u32 v25, v7, 3, v25
    v_add_u32 v5, 128, v1
    v_mul_u32_u24 v6, 3277, v5
    v_lshrrev_b32 v6, 16, v6
    v_mul_u32_u24 v7, 20, v6
    v_sub_u32_e64 v7, v5, v7
    v_mul_u32_u24 v18, 336, v6
    v_lshl_add_u32 v18, v7, 4, v18
    v_add_u32_e64 v18, s85, v18
    v_mul_u32_u24 v26, 1280, v6
    v_lshl_add_u32 v26, v7, 3, v26
    v_add_u32 v5, 192, v1
    v_mul_u32_u24 v6, 3277, v5
    v_lshrrev_b32 v6, 16, v6
    v_mul_u32_u24 v7, 20, v6
    v_sub_u32_e64 v7, v5, v7
    v_mul_u32_u24 v19, 336, v6
    v_lshl_add_u32 v19, v7, 4, v19
    v_add_u32_e64 v19, s85, v19
    v_mul_u32_u24 v27, 1280, v6
    v_lshl_add_u32 v27, v7, 3, v27
    v_add_u32 v5, 256, v1
    v_mul_u32_u24 v6, 3277, v5
    v_lshrrev_b32 v6, 16, v6
    v_mul_u32_u24 v7, 20, v6
    v_sub_u32_e64 v7, v5, v7
    v_mul_u32_u24 v20, 336, v6
    v_lshl_add_u32 v20, v7, 4, v20
    v_add_u32_e64 v20, s85, v20
    v_mul_u32_u24 v28, 1280, v6
    v_lshl_add_u32 v28, v7, 3, v28
    s_mul_i32 s85, s68, 21504
    s_add_u32 s85, s85, 65536
    v_add_u32 v250, s85, v37
    s_sub_u32 s85, s85, s6
    v_add_u32 v246, s85, v39
    v_add_u32 v247, s85, v40
    v_add_u32 v248, s85, v41
    v_add_u32 v249, s85, v42
    s_waitcnt vmcnt(0)
    v_cmp_ne_u32_e64 vcc, s16, v14
    s_cbranch_vccz pq2_ok
    s_mov_b32 s98, 0
pq2_spin:
    s_add_u32 s98, s98, 1
    s_cmp_gt_u32 s98, 0x80000
    s_cbranch_scc1 pq2_ok
    s_sleep 1
    buffer_load_dword v14, v13, s[36:39], s25 offen sc1
    s_waitcnt vmcnt(0)
    v_cmp_ne_u32 vcc, s16, v14
    s_cbranch_vccnz pq2_spin
pq2_ok:
    s_barrier
    s_and_b32 s94, s74, 3
    s_lshl_b32 s94, s94, 1
    s_and_b32 s89, s73, 7
    s_add_u32 s94, s94, s89
    s_mul_i32 s89, s94, 52
    s_lshr_b32 s89, s89, 8
    s_mul_i32 s89, s89, 5
    s_sub_u32 s94, s94, s89
    s_add_u32 s94, s73, s74
    s_and_b32 s94, s94, 1
    s_mul_i32 s94, s94, 3
    s_mul_i32 s86, s68, 5
    s_add_u32 s86, s86, s94
    s_mul_i32 s54, s73, 20
    s_add_u32 s54, s54, s86
    s_lshl_b32 s54, s54, 12
    s_add_u32 s54, s54, 0x460000
    s_mul_i32 s55, s86, 40960
    s_mul_i32 s89, s74, 5120
    s_add_u32 s55, s55, s89
    s_add_u32 s55, s55, 0x6e0000
    s_branch f_entry
q_blk0:
    buffer_load_dword a255, v12, s[40:43], s26 offen offset:1024
    buffer_load_dword a255, v12, s[40:43], s26 offen offset:2048
    s_branch q_noblk
k_codeend:
.section .rodata,"a"
.p2align 6
.amdhsa_kernel gated_mix__linear_attn_block__mixer_token_mlp__prompt_kernel
  .amdhsa_next_free_vgpr 512
  .amdhsa_next_free_sgpr 102
  .amdhsa_accum_offset 256
  .amdhsa_group_segment_fixed_size 0
  .amdhsa_kernarg_size 96
  .amdhsa_user_sgpr_count 2
  .amdhsa_user_sgpr_kernarg_segment_ptr 1
  .amdhsa_system_sgpr_workgroup_id_x 1
.end_amdhsa_kernel
```
